```python
import torch

def _softmax(x, axis=-1):
    return torch.softmax(x, dim=axis)
def _gelu(x):
    return torch.nn.functional.gelu(x, approximate="tanh")
def _silu(x):
    return torch.nn.functional.silu(x)
def _sigmoid(x):
    return torch.sigmoid(x)
def _layernorm(x, axis=-1, eps=1e-5):
    m = x.mean(dim=axis, keepdim=True)
    v = x.var(dim=axis, keepdim=True, unbiased=False)
    return (x - m) / torch.sqrt(v + eps)
def _scatter_add(tgt, idx, src, axis=0):
    return tgt.clone().index_add_(axis, idx, src)
def _segment_sum(src, seg, n):
    out = torch.zeros((n,) + src.shape[1:], dtype=src.dtype)
    return out.index_add_(0, seg, src)
def _pad(x, pw):
    flat = tuple(v for pair in reversed(pw) for v in pair)
    return torch.nn.functional.pad(x, flat)

kernel_name = 'parallel_sum__mha_block__mixer_s_mlp__prompt'

def setup_inputs():

    _w = (lambda a: (lambda t: t.to(torch.bfloat16) if t.is_floating_point() else t)(torch.as_tensor(a)))
    def _A_setup():
        B, S, D, H = 1, 2048, 448, 16
        return {
            "x": _w((lambda *s: torch.randn(*s, dtype=torch.bfloat16) * 0.05)(B, S, D)),
            "wqkv": _w((lambda *s: torch.randn(*s, dtype=torch.bfloat16) * 0.1)(D, 3 * D)),
            "wo": _w((lambda *s: torch.randn(*s, dtype=torch.bfloat16) * 0.05)(D, D)),
        }
    _A_in = _A_setup()

    def _B_setup():
        B, S, D, F = 1, 2048, 448, 1792
        return {
            "x":  _w((lambda *s: torch.randn(*s, dtype=torch.bfloat16) * 0.05)(B, S, D)),
            "w1": _w((lambda *s: torch.randn(*s, dtype=torch.bfloat16) * 1.6)(D, D) * (D ** -0.5)),
            "w2": _w((lambda *s: torch.randn(*s, dtype=torch.bfloat16) * 1.6)(D, D) * (D ** -0.5)),
            "w3": _w((lambda *s: torch.randn(*s, dtype=torch.bfloat16) * 1.6)(D, F) * (D ** -0.5)),
            "w4": _w((lambda *s: torch.randn(*s, dtype=torch.bfloat16) * 1.6)(F, D) * (F ** -0.5)),
        }
    _B_in = _B_setup()

    return {
        "A_x": _A_in["x"],
        "A_wqkv": _A_in["wqkv"],
        "A_wo": _A_in["wo"],
        "B_x": _B_in["x"],
        "B_w1": _B_in["w1"],
        "B_w2": _B_in["w2"],
        "B_w3": _B_in["w3"],
        "B_w4": _B_in["w4"],
    }

def reference(A_x, A_wqkv, A_wo, B_x, B_w1, B_w2, B_w3, B_w4):
    def _A_ref(x, wqkv, wo):
        B, S, D = x.shape
        H = 16
        Dh = D // H
        qkv = (lambda x, *d: x.permute(*d))((x @ wqkv).reshape(B, S, 3, H, Dh), 2, 0, 3, 1, 4)
        q, k, v = qkv[0], qkv[1], qkv[2]
        scores = torch.einsum("bhqd,bhkd->bhqk", q, k) * (Dh ** -0.5)
        p = _softmax(scores, axis=-1)
        o = torch.einsum("bhqk,bhkd->bhqd", p, v)
        return (lambda x, *d: x.permute(*d))(o, 0, 2, 1, 3).reshape(B, S, D) @ wo

    def _B_ref(x, w1, w2, w3, w4):
        B, S, D = x.shape
        h = _gelu(_layernorm(x, axis=-1) @ w1)
        c = D // 4
        g0 = _pad(h[:, :, 0*c:1*c], ((0, 0), (1, 0), (0, 0)))[:, :S, :]
        g1 = _pad(h[:, :, 1*c:2*c], ((0, 0), (0, 1), (0, 0)))[:, 1:, :]
        g2 = _pad(h[:, :, 2*c:3*c], ((0, 0), (2, 0), (0, 0)))[:, :S, :]
        g3 = _pad(h[:, :, 3*c:   ], ((0, 0), (0, 2), (0, 0)))[:, 2:, :]
        hs = torch.concatenate([g0, g1, g2, g3], axis=-1) @ w2
        x1 = x + hs
        h2 = _gelu(_layernorm(x1, axis=-1) @ w3) @ w4
        return x1 + h2

    x = A_x
    xn = _layernorm(x, axis=-1)
    return x + _A_ref(xn, A_wqkv, A_wo) + _B_ref(xn, B_w1, B_w2, B_w3, B_w4)
```

```asm
; @launch grid=(512,1,1) block=(256,1,1) lds=81920
.amdgcn_target "amdgcn-amd-amdhsa--gfx950"
.text
.globl parallel_sum__mha_block__mixer_s_mlp__prompt_kernel
.p2align 8
.type parallel_sum__mha_block__mixer_s_mlp__prompt_kernel,@function
parallel_sum__mha_block__mixer_s_mlp__prompt_kernel:
  s_cmp_ge_u32 s2, 512
  s_cbranch_scc1 L_end
  s_load_dwordx16 s[4:19], s[0:1], 0
  s_load_dwordx4 s[20:23], s[0:1], 64
  s_load_dwordx2 s[24:25], s[0:1], 80
  s_memrealtime s[98:99]
  v_lshrrev_b32 v8, 6, v0
  v_and_b32 v1, 63, v0
  v_readfirstlane_b32 s64, v8
  v_and_b32_e64 v2, 31, v0
  v_bfe_u32 v3, v0, 5, 1
  v_mov_b32 v4, 0
  v_lshlrev_b32 v11, 4, v1
  s_mov_b32 s26, 0
  s_mov_b32 s27, -1
  s_mov_b32 s67, 0x3f803f80
  s_and_b32 s65, s2, 7
  s_bfe_u32 s66, s2, 327683
  s_or_b32 s72, s2, s64
  s_cmp_lg_u32 s72, 0
  s_cbranch_scc1 L_notag
  s_waitcnt lgkmcnt(0)
  s_mov_b32 s32, s22
  s_mov_b32 s33, s23
  s_mov_b32 s34, 0x100
  s_mov_b32 s35, 0x20000
  s_or_b32 s98, s98, 1
  v_mov_b32 v6, s98
  v_mov_b32 v7, s99
  s_mov_b64 exec, 1
  buffer_store_dwordx2 v[6:7], v4, s[32:35], 0 offen sc1
  s_mov_b64 exec, -1
L_notag:
  s_cmp_ge_u32 s2, 256
  s_cbranch_scc0 L_roleB
  s_setprio 2
  s_lshr_b32 s68, s66, 3
  s_lshr_b32 s70, s65, 1
  s_lshl_b32 s70, s70, 2
  s_add_u32 s75, s70, s68
  s_and_b32 s70, s65, 1
  s_lshl_b32 s70, s70, 3
  s_and_b32 s69, s66, 7
  s_add_u32 s76, s70, s69
  s_lshr_b32 s94, s76, 2
  s_and_b32 s95, s76, 3
  s_cmp_eq_u32 s94, 3
  s_movk_i32 s96, 2688
  s_cselect_b32 s96, 896, s96
  s_cselect_b32 s97, 64, 56
  s_cselect_b32 s71, s95, s76
  s_mul_i32 s68, s66, 37
  s_lshr_b32 s68, s68, 8
  s_mul_i32 s68, s68, 7
  s_sub_u32 s77, s66, s68
  s_lshl_b32 s68, s75, 2
  s_add_u32 s68, s68, s64
  s_mul_i32 s68, s68, 28672
  s_lshl_b32 s69, s64, 4
  s_mul_i32 s69, s69, s96
  s_mul_i32 s70, s71, 224
  s_add_u32 s69, s69, s70
  s_lshl_b32 s70, s96, 6
  s_add_u32 s78, s77, 0
  s_sub_u32 s73, s78, 7
  s_cselect_b32 s78, s78, s73
  s_mul_i32 s85, s78, s70
  s_add_u32 s85, s85, s69
  s_lshl_b32 s78, s78, 7
  s_add_u32 s78, s78, s68
  s_add_u32 s79, s77, 1
  s_sub_u32 s73, s79, 7
  s_cselect_b32 s79, s79, s73
  s_mul_i32 s86, s79, s70
  s_add_u32 s86, s86, s69
  s_lshl_b32 s79, s79, 7
  s_add_u32 s79, s79, s68
  s_lshl_b32 s92, s64, 12
  s_lshl_b32 s93, s64, 13
  s_add_u32 s93, s93, 49152
  v_lshrrev_b32 v190, 3, v1
  v_add_u32 v190, 0, v190
  v_bfe_u32 v191, v190, 1, 3
  v_and_b32 v192, 7, v1
  v_xor_b32 v191, v191, v192
  v_mul_u32_u24 v190, 896, v190
  v_lshl_add_u32 v190, v191, 4, v190
  v_subrev_u32 v148, 0, v190
  v_lshrrev_b32 v190, 3, v1
  v_add_u32 v190, 8, v190
  v_bfe_u32 v191, v190, 1, 3
  v_and_b32 v192, 7, v1
  v_xor_b32 v191, v191, v192
  v_mul_u32_u24 v190, 896, v190
  v_lshl_add_u32 v190, v191, 4, v190
  v_subrev_u32 v149, 1024, v190
  v_lshrrev_b32 v190, 3, v1
  v_add_u32 v190, 16, v190
  v_bfe_u32 v191, v190, 1, 3
  v_and_b32 v192, 7, v1
  v_xor_b32_e64 v191, v191, v192
  v_mul_u32_u24 v190, 896, v190
  v_lshl_add_u32 v190, v191, 4, v190
  v_subrev_u32 v150, 2048, v190
  v_lshrrev_b32 v190, 3, v1
  v_add_u32 v190, 24, v190
  v_bfe_u32 v191, v190, 1, 3
  v_and_b32 v192, 7, v1
  v_xor_b32 v191, v191, v192
  v_mul_u32_u24 v190, 896, v190
  v_lshl_add_u32 v190, v191, 4, v190
  v_subrev_u32 v151, 3072, v190
  v_lshrrev_b32 v190, 4, v1
  v_lshlrev_b32 v191, 2, v190
  v_sub_u32 v191, v1, v191
  v_and_b32 v191, 15, v191
  v_mul_u32_u24 v190, s96, v190
  v_lshl_add_u32 v144, v191, 4, v190
  v_mov_b32 v190, 0x7fff0000
  v_cmp_gt_u32 vcc, 14, v191
  s_nop 1
  v_cndmask_b32 v144, v190, v144, vcc
  s_lshl_b32 s73, s96, 2
  s_sub_u32 s73, s73, 1024
  v_add_u32 v145, s73, v144
  v_add_u32 v146, s73, v145
  v_add_u32 v147, s73, v146
  s_waitcnt lgkmcnt(0)
  s_mov_b32 s28, s4
  s_mov_b32 s29, s5
  s_mov_b32 s30, 0x1c0000
  s_mov_b32 s31, 0x20000
  s_cmp_eq_u32 s94, 3
  s_cselect_b32 s40, s12, s6
  s_cselect_b32 s41, s13, s7
  s_mov_b32 s42, 1204224
  s_cselect_b32 s42, 401408, s42
  s_mov_b32 s43, 0x20000
  s_mov_b32 s32, s22
  s_mov_b32 s33, s23
  s_mov_b32 s34, 0x100
  s_mov_b32 s35, 0x20000
  s_mov_b32 m0, s93
  s_nop 0
  buffer_load_dwordx4 v148, s[28:31], s78 offen offset:0 lds
  buffer_load_dwordx4 v149, s[28:31], s78 offen offset:1024 lds
  buffer_load_dwordx4 v150, s[28:31], s78 offen offset:2048 lds
  buffer_load_dwordx4 v151, s[28:31], s78 offen offset:3072 lds
  s_mov_b32 m0, s92
  s_nop 0
  buffer_load_dwordx4 v144, s[40:43], s85 offen offset:0 lds
  buffer_load_dwordx4 v145, s[40:43], s85 offen offset:1024 lds
  buffer_load_dwordx4 v146, s[40:43], s85 offen offset:2048 lds
  buffer_load_dwordx4 v147, s[40:43], s85 offen offset:3072 lds
  s_add_u32 s80, s77, 2
  s_sub_u32 s73, s80, 7
  s_cselect_b32 s80, s80, s73
  s_mul_i32 s87, s80, s70
  s_add_u32 s87, s87, s69
  s_lshl_b32 s80, s80, 7
  s_add_u32 s80, s80, s68
  s_add_u32 s81, s77, 3
  s_sub_u32 s73, s81, 7
  s_cselect_b32 s81, s81, s73
  s_mul_i32 s88, s81, s70
  s_add_u32 s88, s88, s69
  s_lshl_b32 s81, s81, 7
  s_add_u32 s81, s81, s68
  s_add_u32 s82, s77, 4
  s_sub_u32 s73, s82, 7
  s_cselect_b32 s82, s82, s73
  s_mul_i32 s89, s82, s70
  s_add_u32 s89, s89, s69
  s_lshl_b32 s82, s82, 7
  s_add_u32 s82, s82, s68
  s_add_u32 s83, s77, 5
  s_sub_u32 s73, s83, 7
  s_cselect_b32 s83, s83, s73
  s_mul_i32 s90, s83, s70
  s_add_u32 s90, s90, s69
  s_lshl_b32 s83, s83, 7
  s_add_u32 s83, s83, s68
  s_add_u32 s84, s77, 6
  s_sub_u32 s73, s84, 7
  s_cselect_b32 s84, s84, s73
  s_mul_i32 s91, s84, s70
  s_add_u32 s91, s91, s69
  s_lshl_b32 s84, s84, 7
  s_add_u32 s84, s84, s68
  s_nop 0
  v_bfe_u32 v190, v2, 1, 3
  v_xor_b32 v190, v190, v3
  v_lshlrev_b32 v190, 4, v190
  v_lshl_add_u32 v190, v2, 7, v190
  v_xor_b32 v152, 0, v190
  v_add_u32 v152, s93, v152
  v_xor_b32 v153, 32, v190
  v_add_u32 v153, s93, v153
  v_xor_b32 v154, 64, v190
  v_add_u32 v154, s93, v154
  v_xor_b32 v155, 96, v190
  v_add_u32_e64 v155, s93, v155
  v_bfe_u32 v190, v1, 2, 2
  v_and_b32 v191, 3, v1
  v_lshlrev_b32 v191, 3, v191
  v_bfe_u32 v192, v1, 4, 1
  v_lshl_add_u32 v191, v192, 5, v191
  v_lshl_add_u32 v191, v190, 6, v191
  v_lshl_add_u32 v190, v3, 3, v190
  v_lshlrev_b32 v190, 8, v190
  s_add_u32 s68, s64, 0
  s_and_b32 s68, s68, 3
  s_mul_i32 s68, s68, s97
  v_add_u32 v156, s68, v191
  v_and_b32 v156, 255, v156
  v_add_u32 v156, v156, v190
  s_add_u32 s68, s64, 1
  s_and_b32 s68, s68, 3
  s_mul_i32 s68, s68, s97
  v_add_u32 v157, s68, v191
  v_and_b32 v157, 255, v157
  v_add_u32 v157, v157, v190
  s_add_u32 s68, s64, 2
  s_and_b32 s68, s68, 3
  s_mul_i32 s68, s68, s97
  v_add_u32_e64 v158, s68, v191
  v_and_b32 v158, 255, v158
  v_add_u32 v158, v158, v190
  s_add_u32 s68, s64, 3
  s_and_b32 s68, s68, 3
  s_mul_i32 s68, s68, s97
  v_add_u32 v159, s68, v191
  v_and_b32 v159, 255, v159
  v_add_u32 v159, v159, v190
  v_bfe_u32 v190, v1, 2, 1
  v_bfe_u32 v191, v1, 4, 1
  v_cmp_eq_u32 vcc, v190, v191
  v_mov_b32 v190, s67
  s_nop 0
  v_cndmask_b32 v160, 0, v190, vcc
  v_cndmask_b32 v161, 0, v190, vcc
  v_cndmask_b32 v162, 0, v190, vcc
  v_cndmask_b32 v163, 0, v190, vcc
  s_mov_b32 s44, s24
  s_mov_b32 s45, s25
  s_mov_b32 s46, 0x135c000
  s_mov_b32 s47, 0x20000
  s_and_b32 s15, s2, 255
  s_lshl_b32 s15, s15, 6
  s_add_u32 s15, s15, 360448
  s_lshl_b32 s68, s75, 2
  s_add_u32 s72, s68, s64
  s_lshl_b32 s13, s72, 9
  s_add_u32 s13, s13, 20037632
  v_lshlrev_b32 v188, 4, v2
  s_lshl_b32 s68, s64, 7
  s_add_u32 s68, s68, 16384
  v_lshl_add_u32 v185, v2, 2, s68
  s_add_u32 s68, s64, 0
  s_and_b32 s68, s68, 3
  s_lshl_b32 s68, s68, 7
  s_add_u32 s68, s68, 16384
  v_lshl_add_u32 v172, v3, 4, s68
  s_add_u32 s68, s64, 1
  s_and_b32 s68, s68, 3
  s_lshl_b32 s68, s68, 7
  s_add_u32 s68, s68, 16384
  v_lshl_add_u32 v173, v3, 4, s68
  s_add_u32 s68, s64, 2
  s_and_b32 s68, s68, 3
  s_lshl_b32 s68, s68, 7
  s_add_u32 s68, s68, 16384
  v_lshl_add_u32 v174, v3, 4, s68
  s_add_u32 s68, s64, 3
  s_and_b32 s68, s68, 3
  s_lshl_b32 s68, s68, 7
  s_add_u32 s68, s68, 16384
  v_lshl_add_u32 v175, v3, 4, s68
  s_lshl_b32 s68, s95, 15
  s_lshl_b32 s69, s75, 9
  s_add_u32 s69, s69, s68
  v_lshrrev_b32 v190, 2, v1
  v_lshlrev_b32 v190, 13, v190
  v_and_b32 v191, 3, v1
  v_lshl_add_u32 v190, v191, 7, v190
  v_add_u32 v187, s69, v190
  v_mov_b32 v190, 0x7fff0000
  v_cmp_gt_u32 vcc, 16, v1
  s_nop 1
  v_cndmask_b32 v187, v190, v187, vcc
  s_lshr_b32 s69, s75, 2
  s_lshl_b32 s69, s69, 7
  s_add_u32 s68, s68, s69
  s_and_b32 s69, s75, 3
  s_lshl_b32 s70, s94, 2
  s_add_u32 s69, s69, s70
  s_sub_u32 s69, s69, 2
  s_lshl_b32 s69, s69, 3
  s_add_u32 s68, s68, s69
  v_lshl_add_u32 v186, v1, 9, s68
  s_cmp_eq_u32 s94, 0
  s_cselect_b64 vcc, -1, 0
  v_cndmask_b32 v186, v186, v187, vcc
  v_mul_u32_u24 v190, 37, v1
  v_lshrrev_b32 v190, 9, v190
  v_mul_u32_u24 v192, 14, v190
  v_sub_u32 v191, v1, v192
  s_lshl_b32 s68, s75, 1
  s_sub_u32 s68, s68, 1
  v_add_u32 v192, s68, v190
  v_max_i32 v192, 0, v192
  v_min_i32 v192, 31, v192
  v_mul_u32_u24 v192, 14, v192
  v_add_u32 v192, v192, v191
  v_lshlrev_b32 v192, 7, v192
  v_add_u32 v190, 1, v190
  v_bfe_u32 v190, v190, 1, 1
  v_xor_b32 v190, 1, v190
  v_lshl_add_u32 v192, v190, 3, v192
  s_lshr_b32 s68, s95, 1
  s_lshl_b32 s68, s68, 6
  s_and_b32 s69, s95, 1
  s_lshl_b32 s69, s69, 4
  s_add_u32 s68, s68, s69
  s_add_u32 s68, s68, 131072
  v_add_u32 v192, s68, v192
  v_mov_b32 v190, 0x7fff0000
  v_cmp_gt_u32 vcc, 56, v1
  s_nop 1
  v_cndmask_b32 v192, v190, v192, vcc
  s_cmp_eq_u32 s94, 3
  s_cselect_b64 vcc, -1, 0
  v_cndmask_b32 v186, v186, v192, vcc
  s_cmp_eq_u32 s94, 1
  s_cselect_b32 s68, 8, 0x7fff0000
  v_add_u32 v187, s68, v187
  s_and_b32 s68, s2, 255
  s_lshl_b32 s68, s68, 6
  s_add_u32 s68, s68, 393216
  v_mov_b32 v190, s68
  v_cmp_eq_u32 vcc, 16, v1
  s_nop 1
  v_cndmask_b32 v187, v187, v190, vcc
  s_lshl_b32 s69, s95, 8
  s_add_u32 s68, s72, s69
  s_cmp_eq_u32 s94, 0
  s_cselect_b32 s14, 11, 12
  s_mov_b32 s70, 2619392
  s_cselect_b32 s70, 524288, s70
  s_lshl_b32 s68, s68, s14
  s_lshl_b32 s69, s94, 11
  s_add_u32 s68, s68, s69
  s_add_u32 s68, s68, s70
  s_lshl_b32 s72, s72, 9
  s_nop 0
  s_mul_i32 s69, s95, 462336
  s_add_u32 s72, s72, s69
  s_add_u32 s72, s72, 6815744
  s_lshl_b32 s69, 64, s14
  s_movk_i32 s70, 1024
  s_movk_i32 s71, 512
  s_cmp_eq_u32 s94, 3
  s_cselect_b32 s68, s72, s68
  s_cselect_b32 s69, 132096, s69
  s_cselect_b32 s70, 66048, s70
  s_cselect_b32 s71, 33024, s71
  v_mul_u32_u24 v184, s71, v3
  v_lshl_add_u32 v184, v2, 4, v184
  s_add_u32 s71, s64, 0
  s_and_b32 s71, s71, 3
  s_mul_i32 s4, s71, s69
  s_add_u32 s4, s4, s68
  s_add_u32 s8, s4, s70
  s_lshl_b32 s72, s94, 2
  s_or_b32 s71, s71, s72
  s_cmp_eq_u32 s71, 15
  s_cselect_b32 s8, 0x7fff0000, s8
  s_add_u32 s71, s64, 1
  s_and_b32 s71, s71, 3
  s_mul_i32 s5, s71, s69
  s_add_u32 s5, s5, s68
  s_add_u32 s9, s5, s70
  s_lshl_b32 s72, s94, 2
  s_or_b32 s71, s71, s72
  s_cmp_eq_u32 s71, 15
  s_cselect_b32 s9, 0x7fff0000, s9
  s_add_u32 s71, s64, 2
  s_and_b32 s71, s71, 3
  s_mul_i32 s6, s71, s69
  s_add_u32 s6, s6, s68
  s_add_u32 s10, s6, s70
  s_lshl_b32 s72, s94, 2
  s_or_b32 s71, s71, s72
  s_cmp_eq_u32 s71, 15
  s_nop 0
  s_cselect_b32 s10, 0x7fff0000, s10
  s_add_u32 s71, s64, 3
  s_and_b32 s71, s71, 3
  s_mul_i32 s7, s71, s69
  s_add_u32 s7, s7, s68
  s_add_u32 s11, s7, s70
  s_lshl_b32 s72, s94, 2
  s_or_b32 s71, s71, s72
  s_cmp_eq_u32 s71, 15
  s_cselect_b32 s11, 0x7fff0000, s11
  s_cmp_eq_u32 s94, 1
  s_cselect_b32 s69, 0x3f803f80, 0
  s_nop 0
  s_cselect_b32 s70, 0x3f80, 0
  s_cmp_eq_u32 s94, 2
  s_cselect_b32 s69, 0x3f80, s69
  v_mov_b32 v182, s69
  v_mov_b32 v183, s70
  s_cmp_eq_u32 s94, 0
  s_cselect_b32 s14, 0x3e8b97f6, 1.0
  v_bfe_u32 v190, v2, 1, 3
  v_xor_b32 v190, v190, v3
  v_lshlrev_b32 v190, 3, v190
  v_lshl_add_u32 v190, v2, 6, v190
  v_xor_b32 v176, 0, v190
  v_add_u32 v176, s93, v176
  v_xor_b32 v177, 16, v190
  v_add_u32 v177, s93, v177
  v_xor_b32 v178, 32, v190
  v_add_u32 v178, s93, v178
  v_xor_b32 v179, 48, v190
  v_add_u32 v179, s93, v179
  v_bfe_u32 v190, v1, 2, 2
  v_and_b32 v191, 3, v1
  v_lshlrev_b32 v191, 3, v191
  v_bfe_u32 v192, v1, 4, 1
  v_lshl_add_u32 v191, v192, 5, v191
  v_lshl_add_u32 v192, v3, 2, v190
  v_add_u32 v192, 0, v192
  v_bfe_u32 v193, v192, 1, 3
  v_lshlrev_b32 v193, 3, v193
  v_xor_b32 v193, v193, v191
  v_lshl_add_u32 v180, v192, 6, v193
  v_add_u32 v180, s93, v180
  v_lshl_add_u32 v192, v3, 2, v190
  v_add_u32 v192, 8, v192
  v_bfe_u32 v193, v192, 1, 3
  v_lshlrev_b32 v193, 3, v193
  v_xor_b32 v193, v193, v191
  v_lshl_add_u32 v181, v192, 6, v193
  v_add_u32_e64 v181, s93, v181
  s_add_u32 m0, s93, 4096
  s_nop 0
  buffer_load_dwordx4 v148, s[28:31], s79 offen offset:0 lds
  buffer_load_dwordx4 v149, s[28:31], s79 offen offset:1024 lds
  buffer_load_dwordx4 v150, s[28:31], s79 offen offset:2048 lds
  buffer_load_dwordx4 v151, s[28:31], s79 offen offset:3072 lds
  s_add_u32 m0, s92, 16384
  s_nop 0
  buffer_load_dwordx4 v144, s[40:43], s86 offen offset:0 lds
  buffer_load_dwordx4 v145, s[40:43], s86 offen offset:1024 lds
  buffer_load_dwordx4 v146, s[40:43], s86 offen offset:2048 lds
  buffer_load_dwordx4 v147, s[40:43], s86 offen offset:3072 lds
  s_waitcnt vmcnt(12)
  s_waitcnt vmcnt(8)
  s_barrier
  ds_read_b128 v[80:83], v152 offset:0
  ds_read_b128 v[84:87], v153 offset:0
  ds_read_b128 v[88:91], v154 offset:0
  ds_read_b128 v[92:95], v155 offset:0
  ds_read_b64_tr_b16 v[112:113], v156 offset:0
  ds_read_b64_tr_b16 v[114:115], v156 offset:1024
  ds_read_b64_tr_b16 v[116:117], v157 offset:0
  ds_read_b64_tr_b16 v[118:119], v157 offset:1024
  ds_read_b64_tr_b16 v[120:121], v158 offset:0
  ds_read_b64_tr_b16 v[122:123], v158 offset:1024
  ds_read_b64_tr_b16 v[124:125], v159 offset:0
  ds_read_b64_tr_b16 v[126:127], v159 offset:1024
  s_waitcnt lgkmcnt(0)
  v_mfma_f32_32x32x16_bf16 v[16:31], v[112:115], v[80:83], 0
  ds_read_b64_tr_b16 v[128:129], v156 offset:4096
  ds_read_b64_tr_b16 v[130:131], v156 offset:5120
  ds_read_b64_tr_b16 v[132:133], v157 offset:4096
  s_nop 0
  ds_read_b64_tr_b16 v[134:135], v157 offset:5120
  v_mfma_f32_32x32x16_bf16 v[32:47], v[116:119], v[80:83], 0
  ds_read_b64_tr_b16 v[136:137], v158 offset:4096
  ds_read_b64_tr_b16 v[138:139], v158 offset:5120
  ds_read_b64_tr_b16 v[140:141], v159 offset:4096
  ds_read_b64_tr_b16 v[142:143], v159 offset:5120
  v_mfma_f32_32x32x16_bf16 v[48:63], v[120:123], v[80:83], 0
  s_add_u32 m0, s92, 32768
  s_nop 0
  buffer_load_dwordx4 v144, s[40:43], s87 offen offset:0 lds
  v_mfma_f32_32x32x16_bf16 v[64:79], v[124:127], v[80:83], 0
  buffer_load_dwordx4 v145, s[40:43], s87 offen offset:1024 lds
  v_mfma_f32_16x16x32_bf16 v[164:167], v[160:163], v[112:115], 0
  s_waitcnt lgkmcnt(0)
  v_mfma_f32_32x32x16_bf16 v[16:31], v[128:131], v[84:87], v[16:31]
  ds_read_b64_tr_b16 v[112:113], v156 offset:8192
  ds_read_b64_tr_b16 v[114:115], v156 offset:9216
  ds_read_b64_tr_b16 v[116:117], v157 offset:8192
  ds_read_b64_tr_b16 v[118:119], v157 offset:9216
  v_mfma_f32_32x32x16_bf16 v[32:47], v[132:135], v[84:87], v[32:47]
  ds_read_b64_tr_b16 v[120:121], v158 offset:8192
  ds_read_b64_tr_b16 v[122:123], v158 offset:9216
  ds_read_b64_tr_b16 v[124:125], v159 offset:8192
  ds_read_b64_tr_b16 v[126:127], v159 offset:9216
  v_mfma_f32_32x32x16_bf16 v[48:63], v[136:139], v[84:87], v[48:63]
  buffer_load_dwordx4 v146, s[40:43], s87 offen offset:2048 lds
  buffer_load_dwordx4 v147, s[40:43], s87 offen offset:3072 lds
  v_mfma_f32_32x32x16_bf16 v[64:79], v[140:143], v[84:87], v[64:79]
  s_mov_b32 m0, s93
  s_nop 0
  buffer_load_dwordx4 v148, s[28:31], s80 offen offset:0 lds
  buffer_load_dwordx4 v149, s[28:31], s80 offen offset:1024 lds
  v_mfma_f32_16x16x32_bf16 v[164:167], v[160:163], v[128:131], v[164:167]
  s_waitcnt lgkmcnt(0)
  s_nop 0
  v_mfma_f32_32x32x16_bf16 v[16:31], v[112:115], v[88:91], v[16:31]
  ds_read_b64_tr_b16 v[128:129], v156 offset:12288
  ds_read_b64_tr_b16 v[130:131], v156 offset:13312
  ds_read_b64_tr_b16 v[132:133], v157 offset:12288
  ds_read_b64_tr_b16 v[134:135], v157 offset:13312
  v_mfma_f32_32x32x16_bf16 v[32:47], v[116:119], v[88:91], v[32:47]
  ds_read_b64_tr_b16 v[136:137], v158 offset:12288
  ds_read_b64_tr_b16 v[138:139], v158 offset:13312
  ds_read_b64_tr_b16 v[140:141], v159 offset:12288
  ds_read_b64_tr_b16 v[142:143], v159 offset:13312
  v_mfma_f32_32x32x16_bf16 v[48:63], v[120:123], v[88:91], v[48:63]
  buffer_load_dwordx4 v150, s[28:31], s80 offen offset:2048 lds
  v_mfma_f32_32x32x16_bf16 v[64:79], v[124:127], v[88:91], v[64:79]
  buffer_load_dwordx4 v151, s[28:31], s80 offen offset:3072 lds
  v_mfma_f32_16x16x32_bf16 v[164:167], v[160:163], v[112:115], v[164:167]
  s_waitcnt lgkmcnt(0)
  s_waitcnt vmcnt(12)
  s_waitcnt vmcnt(8)
  s_barrier
  v_mfma_f32_32x32x16_bf16 v[16:31], v[128:131], v[92:95], v[16:31]
  ds_read_b128 v[96:99], v152 offset:4096
  ds_read_b128 v[100:103], v153 offset:4096
  ds_read_b128 v[104:107], v154 offset:4096
  ds_read_b128 v[108:111], v155 offset:4096
  ds_read_b64_tr_b16 v[112:113], v156 offset:16384
  ds_read_b64_tr_b16 v[114:115], v156 offset:17408
  v_mfma_f32_32x32x16_bf16 v[32:47], v[132:135], v[92:95], v[32:47]
  ds_read_b64_tr_b16 v[116:117], v157 offset:16384
  ds_read_b64_tr_b16 v[118:119], v157 offset:17408
  ds_read_b64_tr_b16 v[120:121], v158 offset:16384
  ds_read_b64_tr_b16 v[122:123], v158 offset:17408
  ds_read_b64_tr_b16 v[124:125], v159 offset:16384
  ds_read_b64_tr_b16 v[126:127], v159 offset:17408
  v_mfma_f32_32x32x16_bf16 v[48:63], v[136:139], v[92:95], v[48:63]
  s_mov_b32 m0, s92
  s_nop 0
  buffer_load_dwordx4 v144, s[40:43], s88 offen offset:0 lds
  v_mfma_f32_32x32x16_bf16 v[64:79], v[140:143], v[92:95], v[64:79]
  buffer_load_dwordx4 v145, s[40:43], s88 offen offset:1024 lds
  v_mfma_f32_16x16x32_bf16 v[164:167], v[160:163], v[128:131], v[164:167]
  s_waitcnt lgkmcnt(0)
  v_mfma_f32_32x32x16_bf16 v[16:31], v[112:115], v[96:99], v[16:31]
  ds_read_b64_tr_b16 v[128:129], v156 offset:20480
  s_nop 0
  ds_read_b64_tr_b16 v[130:131], v156 offset:21504
  ds_read_b64_tr_b16 v[132:133], v157 offset:20480
  ds_read_b64_tr_b16 v[134:135], v157 offset:21504
  v_mfma_f32_32x32x16_bf16 v[32:47], v[116:119], v[96:99], v[32:47]
  ds_read_b64_tr_b16 v[136:137], v158 offset:20480
  ds_read_b64_tr_b16 v[138:139], v158 offset:21504
  ds_read_b64_tr_b16 v[140:141], v159 offset:20480
  ds_read_b64_tr_b16 v[142:143], v159 offset:21504
  v_mfma_f32_32x32x16_bf16 v[48:63], v[120:123], v[96:99], v[48:63]
  buffer_load_dwordx4 v146, s[40:43], s88 offen offset:2048 lds
  v_mfma_f32_32x32x16_bf16 v[64:79], v[124:127], v[96:99], v[64:79]
  buffer_load_dwordx4 v147, s[40:43], s88 offen offset:3072 lds
  v_mfma_f32_16x16x32_bf16 v[164:167], v[160:163], v[112:115], v[164:167]
  s_waitcnt lgkmcnt(0)
  v_mfma_f32_32x32x16_bf16 v[16:31], v[128:131], v[100:103], v[16:31]
  ds_read_b64_tr_b16 v[112:113], v156 offset:24576
  s_nop 0
  ds_read_b64_tr_b16 v[114:115], v156 offset:25600
  ds_read_b64_tr_b16 v[116:117], v157 offset:24576
  ds_read_b64_tr_b16 v[118:119], v157 offset:25600
  v_mfma_f32_32x32x16_bf16 v[32:47], v[132:135], v[100:103], v[32:47]
  ds_read_b64_tr_b16 v[120:121], v158 offset:24576
  ds_read_b64_tr_b16 v[122:123], v158 offset:25600
  ds_read_b64_tr_b16 v[124:125], v159 offset:24576
  ds_read_b64_tr_b16 v[126:127], v159 offset:25600
  v_mfma_f32_32x32x16_bf16 v[48:63], v[136:139], v[100:103], v[48:63]
  s_add_u32 m0, s93, 4096
  s_nop 0
  buffer_load_dwordx4 v148, s[28:31], s81 offen offset:0 lds
  v_mfma_f32_32x32x16_bf16 v[64:79], v[140:143], v[100:103], v[64:79]
  buffer_load_dwordx4 v149, s[28:31], s81 offen offset:1024 lds
  v_mfma_f32_16x16x32_bf16 v[164:167], v[160:163], v[128:131], v[164:167]
  s_waitcnt lgkmcnt(0)
  v_mfma_f32_32x32x16_bf16 v[16:31], v[112:115], v[104:107], v[16:31]
  ds_read_b64_tr_b16 v[128:129], v156 offset:28672
  ds_read_b64_tr_b16 v[130:131], v156 offset:29696
  ds_read_b64_tr_b16 v[132:133], v157 offset:28672
  ds_read_b64_tr_b16 v[134:135], v157 offset:29696
  v_mfma_f32_32x32x16_bf16 v[32:47], v[116:119], v[104:107], v[32:47]
  ds_read_b64_tr_b16 v[136:137], v158 offset:28672
  ds_read_b64_tr_b16 v[138:139], v158 offset:29696
  ds_read_b64_tr_b16 v[140:141], v159 offset:28672
  ds_read_b64_tr_b16 v[142:143], v159 offset:29696
  v_mfma_f32_32x32x16_bf16 v[48:63], v[120:123], v[104:107], v[48:63]
  buffer_load_dwordx4 v150, s[28:31], s81 offen offset:2048 lds
  v_mfma_f32_32x32x16_bf16 v[64:79], v[124:127], v[104:107], v[64:79]
  buffer_load_dwordx4 v151, s[28:31], s81 offen offset:3072 lds
  v_mfma_f32_16x16x32_bf16 v[164:167], v[160:163], v[112:115], v[164:167]
  s_waitcnt lgkmcnt(0)
  s_waitcnt vmcnt(8)
  s_barrier
  s_nop 0
  v_mfma_f32_32x32x16_bf16 v[16:31], v[128:131], v[108:111], v[16:31]
  ds_read_b128 v[80:83], v152 offset:0
  ds_read_b128 v[84:87], v153 offset:0
  ds_read_b128 v[88:91], v154 offset:0
  ds_read_b128 v[92:95], v155 offset:0
  ds_read_b64_tr_b16 v[112:113], v156 offset:32768
  ds_read_b64_tr_b16 v[114:115], v156 offset:33792
  v_mfma_f32_32x32x16_bf16 v[32:47], v[132:135], v[108:111], v[32:47]
  ds_read_b64_tr_b16 v[116:117], v157 offset:32768
  ds_read_b64_tr_b16 v[118:119], v157 offset:33792
  ds_read_b64_tr_b16 v[120:121], v158 offset:32768
  ds_read_b64_tr_b16 v[122:123], v158 offset:33792
  ds_read_b64_tr_b16 v[124:125], v159 offset:32768
  ds_read_b64_tr_b16 v[126:127], v159 offset:33792
  v_mfma_f32_32x32x16_bf16 v[48:63], v[136:139], v[108:111], v[48:63]
  s_add_u32 m0, s92, 16384
  s_nop 0
  buffer_load_dwordx4 v144, s[40:43], s89 offen offset:0 lds
  v_mfma_f32_32x32x16_bf16 v[64:79], v[140:143], v[108:111], v[64:79]
  buffer_load_dwordx4 v145, s[40:43], s89 offen offset:1024 lds
  v_mfma_f32_16x16x32_bf16 v[164:167], v[160:163], v[128:131], v[164:167]
  s_waitcnt lgkmcnt(0)
  v_mfma_f32_32x32x16_bf16 v[16:31], v[112:115], v[80:83], v[16:31]
  ds_read_b64_tr_b16 v[128:129], v156 offset:36864
  ds_read_b64_tr_b16 v[130:131], v156 offset:37888
  ds_read_b64_tr_b16 v[132:133], v157 offset:36864
  ds_read_b64_tr_b16 v[134:135], v157 offset:37888
  v_mfma_f32_32x32x16_bf16 v[32:47], v[116:119], v[80:83], v[32:47]
  ds_read_b64_tr_b16 v[136:137], v158 offset:36864
  ds_read_b64_tr_b16 v[138:139], v158 offset:37888
  ds_read_b64_tr_b16 v[140:141], v159 offset:36864
  ds_read_b64_tr_b16 v[142:143], v159 offset:37888
  v_mfma_f32_32x32x16_bf16 v[48:63], v[120:123], v[80:83], v[48:63]
  buffer_load_dwordx4 v146, s[40:43], s89 offen offset:2048 lds
  v_mfma_f32_32x32x16_bf16 v[64:79], v[124:127], v[80:83], v[64:79]
  buffer_load_dwordx4 v147, s[40:43], s89 offen offset:3072 lds
  v_mfma_f32_16x16x32_bf16 v[164:167], v[160:163], v[112:115], v[164:167]
  s_waitcnt lgkmcnt(0)
  v_mfma_f32_32x32x16_bf16 v[16:31], v[128:131], v[84:87], v[16:31]
  ds_read_b64_tr_b16 v[112:113], v156 offset:40960
  ds_read_b64_tr_b16 v[114:115], v156 offset:41984
  s_nop 0
  ds_read_b64_tr_b16 v[116:117], v157 offset:40960
  ds_read_b64_tr_b16 v[118:119], v157 offset:41984
  v_mfma_f32_32x32x16_bf16 v[32:47], v[132:135], v[84:87], v[32:47]
  ds_read_b64_tr_b16 v[120:121], v158 offset:40960
  ds_read_b64_tr_b16 v[122:123], v158 offset:41984
  ds_read_b64_tr_b16 v[124:125], v159 offset:40960
  ds_read_b64_tr_b16 v[126:127], v159 offset:41984
  v_mfma_f32_32x32x16_bf16 v[48:63], v[136:139], v[84:87], v[48:63]
  s_mov_b32 m0, s93
  s_nop 0
  buffer_load_dwordx4 v148, s[28:31], s82 offen offset:0 lds
  v_mfma_f32_32x32x16_bf16 v[64:79], v[140:143], v[84:87], v[64:79]
  buffer_load_dwordx4 v149, s[28:31], s82 offen offset:1024 lds
  v_mfma_f32_16x16x32_bf16 v[164:167], v[160:163], v[128:131], v[164:167]
  s_waitcnt lgkmcnt(0)
  v_mfma_f32_32x32x16_bf16 v[16:31], v[112:115], v[88:91], v[16:31]
  ds_read_b64_tr_b16 v[128:129], v156 offset:45056
  s_nop 0
  ds_read_b64_tr_b16 v[130:131], v156 offset:46080
  ds_read_b64_tr_b16 v[132:133], v157 offset:45056
  ds_read_b64_tr_b16 v[134:135], v157 offset:46080
  v_mfma_f32_32x32x16_bf16 v[32:47], v[116:119], v[88:91], v[32:47]
  ds_read_b64_tr_b16 v[136:137], v158 offset:45056
  ds_read_b64_tr_b16 v[138:139], v158 offset:46080
  ds_read_b64_tr_b16 v[140:141], v159 offset:45056
  ds_read_b64_tr_b16 v[142:143], v159 offset:46080
  v_mfma_f32_32x32x16_bf16 v[48:63], v[120:123], v[88:91], v[48:63]
  buffer_load_dwordx4 v150, s[28:31], s82 offen offset:2048 lds
  buffer_load_dwordx4 v151, s[28:31], s82 offen offset:3072 lds
  v_mfma_f32_32x32x16_bf16 v[64:79], v[124:127], v[88:91], v[64:79]
  buffer_load_dwordx2 v[6:7], v4, s[32:35], 0 offen sc1
  v_mfma_f32_16x16x32_bf16 v[164:167], v[160:163], v[112:115], v[164:167]
  s_waitcnt lgkmcnt(0)
  s_waitcnt vmcnt(9)
  s_barrier
  s_nop 0
  v_mfma_f32_32x32x16_bf16 v[16:31], v[128:131], v[92:95], v[16:31]
  ds_read_b128 v[96:99], v152 offset:4096
  ds_read_b128 v[100:103], v153 offset:4096
  ds_read_b128 v[104:107], v154 offset:4096
  ds_read_b128 v[108:111], v155 offset:4096
  ds_read_b64_tr_b16 v[112:113], v156 offset:0
  ds_read_b64_tr_b16 v[114:115], v156 offset:1024
  v_mfma_f32_32x32x16_bf16 v[32:47], v[132:135], v[92:95], v[32:47]
  ds_read_b64_tr_b16 v[116:117], v157 offset:0
  ds_read_b64_tr_b16 v[118:119], v157 offset:1024
  ds_read_b64_tr_b16 v[120:121], v158 offset:0
  ds_read_b64_tr_b16 v[122:123], v158 offset:1024
  ds_read_b64_tr_b16 v[124:125], v159 offset:0
  ds_read_b64_tr_b16 v[126:127], v159 offset:1024
  v_mfma_f32_32x32x16_bf16 v[48:63], v[136:139], v[92:95], v[48:63]
  s_add_u32 m0, s92, 32768
  s_nop 0
  buffer_load_dwordx4 v144, s[40:43], s90 offen offset:0 lds
  v_mfma_f32_32x32x16_bf16 v[64:79], v[140:143], v[92:95], v[64:79]
  buffer_load_dwordx4 v145, s[40:43], s90 offen offset:1024 lds
  v_mfma_f32_16x16x32_bf16 v[164:167], v[160:163], v[128:131], v[164:167]
  s_waitcnt lgkmcnt(0)
  v_mfma_f32_32x32x16_bf16 v[16:31], v[112:115], v[96:99], v[16:31]
  ds_read_b64_tr_b16 v[128:129], v156 offset:4096
  ds_read_b64_tr_b16 v[130:131], v156 offset:5120
  ds_read_b64_tr_b16 v[132:133], v157 offset:4096
  ds_read_b64_tr_b16 v[134:135], v157 offset:5120
  v_mfma_f32_32x32x16_bf16 v[32:47], v[116:119], v[96:99], v[32:47]
  ds_read_b64_tr_b16 v[136:137], v158 offset:4096
  ds_read_b64_tr_b16 v[138:139], v158 offset:5120
  ds_read_b64_tr_b16 v[140:141], v159 offset:4096
  ds_read_b64_tr_b16 v[142:143], v159 offset:5120
  v_mfma_f32_32x32x16_bf16 v[48:63], v[120:123], v[96:99], v[48:63]
  buffer_load_dwordx4 v146, s[40:43], s90 offen offset:2048 lds
  v_mfma_f32_32x32x16_bf16 v[64:79], v[124:127], v[96:99], v[64:79]
  buffer_load_dwordx4 v147, s[40:43], s90 offen offset:3072 lds
  v_mfma_f32_16x16x32_bf16 v[164:167], v[160:163], v[112:115], v[164:167]
  s_waitcnt lgkmcnt(0)
  v_mfma_f32_32x32x16_bf16 v[16:31], v[128:131], v[100:103], v[16:31]
  ds_read_b64_tr_b16 v[112:113], v156 offset:8192
  ds_read_b64_tr_b16 v[114:115], v156 offset:9216
  s_nop 0
  ds_read_b64_tr_b16 v[116:117], v157 offset:8192
  ds_read_b64_tr_b16 v[118:119], v157 offset:9216
  v_mfma_f32_32x32x16_bf16 v[32:47], v[132:135], v[100:103], v[32:47]
  ds_read_b64_tr_b16 v[120:121], v158 offset:8192
  ds_read_b64_tr_b16 v[122:123], v158 offset:9216
  ds_read_b64_tr_b16 v[124:125], v159 offset:8192
  ds_read_b64_tr_b16 v[126:127], v159 offset:9216
  v_mfma_f32_32x32x16_bf16 v[48:63], v[136:139], v[100:103], v[48:63]
  s_add_u32 m0, s93, 4096
  s_nop 0
  buffer_load_dwordx4 v148, s[28:31], s83 offen offset:0 lds
  v_mfma_f32_32x32x16_bf16 v[64:79], v[140:143], v[100:103], v[64:79]
  buffer_load_dwordx4 v149, s[28:31], s83 offen offset:1024 lds
  v_mfma_f32_16x16x32_bf16 v[164:167], v[160:163], v[128:131], v[164:167]
  s_waitcnt lgkmcnt(0)
  v_mfma_f32_32x32x16_bf16 v[16:31], v[112:115], v[104:107], v[16:31]
  ds_read_b64_tr_b16 v[128:129], v156 offset:12288
  ds_read_b64_tr_b16 v[130:131], v156 offset:13312
  ds_read_b64_tr_b16 v[132:133], v157 offset:12288
  ds_read_b64_tr_b16 v[134:135], v157 offset:13312
  v_mfma_f32_32x32x16_bf16 v[32:47], v[116:119], v[104:107], v[32:47]
  ds_read_b64_tr_b16 v[136:137], v158 offset:12288
  ds_read_b64_tr_b16 v[138:139], v158 offset:13312
  ds_read_b64_tr_b16 v[140:141], v159 offset:12288
  ds_read_b64_tr_b16 v[142:143], v159 offset:13312
  v_mfma_f32_32x32x16_bf16 v[48:63], v[120:123], v[104:107], v[48:63]
  buffer_load_dwordx4 v150, s[28:31], s83 offen offset:2048 lds
  v_mfma_f32_32x32x16_bf16 v[64:79], v[124:127], v[104:107], v[64:79]
  buffer_load_dwordx4 v151, s[28:31], s83 offen offset:3072 lds
  v_mfma_f32_16x16x32_bf16 v[164:167], v[160:163], v[112:115], v[164:167]
  s_waitcnt lgkmcnt(0)
  s_waitcnt vmcnt(9)
  s_barrier
  v_mfma_f32_32x32x16_bf16 v[16:31], v[128:131], v[108:111], v[16:31]
  s_nop 0
  ds_read_b128 v[80:83], v152 offset:0
  ds_read_b128 v[84:87], v153 offset:0
  ds_read_b128 v[88:91], v154 offset:0
  ds_read_b128 v[92:95], v155 offset:0
  ds_read_b64_tr_b16 v[112:113], v156 offset:16384
  ds_read_b64_tr_b16 v[114:115], v156 offset:17408
  v_mfma_f32_32x32x16_bf16 v[32:47], v[132:135], v[108:111], v[32:47]
  ds_read_b64_tr_b16 v[116:117], v157 offset:16384
  ds_read_b64_tr_b16 v[118:119], v157 offset:17408
  ds_read_b64_tr_b16 v[120:121], v158 offset:16384
  ds_read_b64_tr_b16 v[122:123], v158 offset:17408
  ds_read_b64_tr_b16 v[124:125], v159 offset:16384
  ds_read_b64_tr_b16 v[126:127], v159 offset:17408
  v_mfma_f32_32x32x16_bf16 v[48:63], v[136:139], v[108:111], v[48:63]
  s_mov_b32 m0, s92
  s_nop 0
  buffer_load_dwordx4 v144, s[40:43], s91 offen offset:0 lds
  buffer_load_dwordx4 v145, s[40:43], s91 offen offset:1024 lds
  v_mfma_f32_32x32x16_bf16 v[64:79], v[140:143], v[108:111], v[64:79]
  s_waitcnt vmcnt(10)
  s_mov_b32 s74, 400000
  s_branch L_noc_3
L_no_1:
  buffer_load_dwordx2 v[6:7], v4, s[32:35], 0 offen sc1
  s_waitcnt vmcnt(0)
L_noc_3:
  v_readfirstlane_b32 s0, v6
  v_readfirstlane_b32 s1, v7
  s_nop 2
  s_cmp_lg_u32 s0, 0
  s_cbranch_scc1 L_nod_2
  s_sub_u32 s74, s74, 1
  s_cbranch_scc1 L_nod_2
  s_sleep 1
  s_branch L_no_1
L_nod_2:
  s_cmp_lg_u32 s64, 0
  s_cbranch_scc1 L_pub_4
  s_mov_b64 exec, 1
  buffer_store_dwordx2 v[6:7], v4, s[44:47], s15 offen sc1
  s_mov_b64 exec, -1
L_pub_4:
  v_mfma_f32_16x16x32_bf16 v[164:167], v[160:163], v[128:131], v[164:167]
  s_waitcnt lgkmcnt(0)
  v_mfma_f32_32x32x16_bf16 v[16:31], v[112:115], v[80:83], v[16:31]
  s_nop 0
  ds_read_b64_tr_b16 v[128:129], v156 offset:20480
  ds_read_b64_tr_b16 v[130:131], v156 offset:21504
  ds_read_b64_tr_b16 v[132:133], v157 offset:20480
  ds_read_b64_tr_b16 v[134:135], v157 offset:21504
  v_mfma_f32_32x32x16_bf16 v[32:47], v[116:119], v[80:83], v[32:47]
  ds_read_b64_tr_b16 v[136:137], v158 offset:20480
  ds_read_b64_tr_b16 v[138:139], v158 offset:21504
  ds_read_b64_tr_b16 v[140:141], v159 offset:20480
  ds_read_b64_tr_b16 v[142:143], v159 offset:21504
  v_mfma_f32_32x32x16_bf16 v[48:63], v[120:123], v[80:83], v[48:63]
  buffer_load_dwordx4 v146, s[40:43], s91 offen offset:2048 lds
  v_mfma_f32_32x32x16_bf16 v[64:79], v[124:127], v[80:83], v[64:79]
  buffer_load_dwordx4 v147, s[40:43], s91 offen offset:3072 lds
  v_mfma_f32_16x16x32_bf16 v[164:167], v[160:163], v[112:115], v[164:167]
  s_waitcnt lgkmcnt(0)
  v_mfma_f32_32x32x16_bf16 v[16:31], v[128:131], v[84:87], v[16:31]
  s_nop 0
  ds_read_b64_tr_b16 v[112:113], v156 offset:24576
  ds_read_b64_tr_b16 v[114:115], v156 offset:25600
  ds_read_b64_tr_b16 v[116:117], v157 offset:24576
  ds_read_b64_tr_b16 v[118:119], v157 offset:25600
  v_mfma_f32_32x32x16_bf16 v[32:47], v[132:135], v[84:87], v[32:47]
  ds_read_b64_tr_b16 v[120:121], v158 offset:24576
  ds_read_b64_tr_b16 v[122:123], v158 offset:25600
  ds_read_b64_tr_b16 v[124:125], v159 offset:24576
  ds_read_b64_tr_b16 v[126:127], v159 offset:25600
  v_mfma_f32_32x32x16_bf16 v[48:63], v[136:139], v[84:87], v[48:63]
  s_mov_b32 m0, s93
  s_nop 0
  buffer_load_dwordx4 v148, s[28:31], s84 offen offset:0 lds
  v_mfma_f32_32x32x16_bf16 v[64:79], v[140:143], v[84:87], v[64:79]
  buffer_load_dwordx4 v149, s[28:31], s84 offen offset:1024 lds
  v_mfma_f32_16x16x32_bf16 v[164:167], v[160:163], v[128:131], v[164:167]
  s_waitcnt lgkmcnt(0)
  s_nop 0
  v_mfma_f32_32x32x16_bf16 v[16:31], v[112:115], v[88:91], v[16:31]
  ds_read_b64_tr_b16 v[128:129], v156 offset:28672
  ds_read_b64_tr_b16 v[130:131], v156 offset:29696
  ds_read_b64_tr_b16 v[132:133], v157 offset:28672
  ds_read_b64_tr_b16 v[134:135], v157 offset:29696
  v_mfma_f32_32x32x16_bf16 v[32:47], v[116:119], v[88:91], v[32:47]
  ds_read_b64_tr_b16 v[136:137], v158 offset:28672
  ds_read_b64_tr_b16 v[138:139], v158 offset:29696
  ds_read_b64_tr_b16 v[140:141], v159 offset:28672
  ds_read_b64_tr_b16 v[142:143], v159 offset:29696
  v_mfma_f32_32x32x16_bf16 v[48:63], v[120:123], v[88:91], v[48:63]
  buffer_load_dwordx4 v150, s[28:31], s84 offen offset:2048 lds
  v_mfma_f32_32x32x16_bf16 v[64:79], v[124:127], v[88:91], v[64:79]
  buffer_load_dwordx4 v151, s[28:31], s84 offen offset:3072 lds
  v_mfma_f32_16x16x32_bf16 v[164:167], v[160:163], v[112:115], v[164:167]
  s_waitcnt lgkmcnt(0)
  s_waitcnt vmcnt(8)
  s_barrier
  v_mfma_f32_32x32x16_bf16 v[16:31], v[128:131], v[92:95], v[16:31]
  ds_read_b128 v[96:99], v152 offset:4096
  ds_read_b128 v[100:103], v153 offset:4096
  ds_read_b128 v[104:107], v154 offset:4096
  ds_read_b128 v[108:111], v155 offset:4096
  ds_read_b64_tr_b16 v[112:113], v156 offset:32768
  ds_read_b64_tr_b16 v[114:115], v156 offset:33792
  s_nop 0
  v_mfma_f32_32x32x16_bf16 v[32:47], v[132:135], v[92:95], v[32:47]
  ds_read_b64_tr_b16 v[116:117], v157 offset:32768
  ds_read_b64_tr_b16 v[118:119], v157 offset:33792
  ds_read_b64_tr_b16 v[120:121], v158 offset:32768
  ds_read_b64_tr_b16 v[122:123], v158 offset:33792
  ds_read_b64_tr_b16 v[124:125], v159 offset:32768
  ds_read_b64_tr_b16 v[126:127], v159 offset:33792
  v_mfma_f32_32x32x16_bf16 v[48:63], v[136:139], v[92:95], v[48:63]
  v_mfma_f32_32x32x16_bf16 v[64:79], v[140:143], v[92:95], v[64:79]
  v_mfma_f32_16x16x32_bf16 v[164:167], v[160:163], v[128:131], v[164:167]
  s_waitcnt lgkmcnt(0)
  v_mfma_f32_32x32x16_bf16 v[16:31], v[112:115], v[96:99], v[16:31]
  ds_read_b64_tr_b16 v[128:129], v156 offset:36864
  ds_read_b64_tr_b16 v[130:131], v156 offset:37888
  ds_read_b64_tr_b16 v[132:133], v157 offset:36864
  ds_read_b64_tr_b16 v[134:135], v157 offset:37888
  s_nop 0
  v_mfma_f32_32x32x16_bf16 v[32:47], v[116:119], v[96:99], v[32:47]
  ds_read_b64_tr_b16 v[136:137], v158 offset:36864
  ds_read_b64_tr_b16 v[138:139], v158 offset:37888
  ds_read_b64_tr_b16 v[140:141], v159 offset:36864
  ds_read_b64_tr_b16 v[142:143], v159 offset:37888
  v_mfma_f32_32x32x16_bf16 v[48:63], v[120:123], v[96:99], v[48:63]
  v_mfma_f32_32x32x16_bf16 v[64:79], v[124:127], v[96:99], v[64:79]
  v_mfma_f32_16x16x32_bf16 v[164:167], v[160:163], v[112:115], v[164:167]
  s_waitcnt lgkmcnt(0)
  v_mfma_f32_32x32x16_bf16 v[16:31], v[128:131], v[100:103], v[16:31]
  ds_read_b64_tr_b16 v[112:113], v156 offset:40960
  ds_read_b64_tr_b16 v[114:115], v156 offset:41984
  ds_read_b64_tr_b16 v[116:117], v157 offset:40960
  ds_read_b64_tr_b16 v[118:119], v157 offset:41984
  v_mfma_f32_32x32x16_bf16 v[32:47], v[132:135], v[100:103], v[32:47]
  ds_read_b64_tr_b16 v[120:121], v158 offset:40960
  s_nop 0
  ds_read_b64_tr_b16 v[122:123], v158 offset:41984
  ds_read_b64_tr_b16 v[124:125], v159 offset:40960
  ds_read_b64_tr_b16 v[126:127], v159 offset:41984
  v_mfma_f32_32x32x16_bf16 v[48:63], v[136:139], v[100:103], v[48:63]
  v_mfma_f32_32x32x16_bf16 v[64:79], v[140:143], v[100:103], v[64:79]
  v_mfma_f32_16x16x32_bf16 v[164:167], v[160:163], v[128:131], v[164:167]
  s_waitcnt lgkmcnt(0)
  v_mfma_f32_32x32x16_bf16 v[16:31], v[112:115], v[104:107], v[16:31]
  s_nop 0
  ds_read_b64_tr_b16 v[128:129], v156 offset:45056
  ds_read_b64_tr_b16 v[130:131], v156 offset:46080
  ds_read_b64_tr_b16 v[132:133], v157 offset:45056
  ds_read_b64_tr_b16 v[134:135], v157 offset:46080
  v_mfma_f32_32x32x16_bf16 v[32:47], v[116:119], v[104:107], v[32:47]
  ds_read_b64_tr_b16 v[136:137], v158 offset:45056
  ds_read_b64_tr_b16 v[138:139], v158 offset:46080
  ds_read_b64_tr_b16 v[140:141], v159 offset:45056
  ds_read_b64_tr_b16 v[142:143], v159 offset:46080
  v_mfma_f32_32x32x16_bf16 v[48:63], v[120:123], v[104:107], v[48:63]
  buffer_load_dwordx4 v[168:171], v188, s[44:47], s13 offen sc1
  v_mfma_f32_32x32x16_bf16 v[64:79], v[124:127], v[104:107], v[64:79]
  v_mfma_f32_16x16x32_bf16 v[164:167], v[160:163], v[112:115], v[164:167]
  s_waitcnt lgkmcnt(0)
  s_waitcnt vmcnt(1)
  s_barrier
  v_mfma_f32_32x32x16_bf16 v[16:31], v[128:131], v[108:111], v[16:31]
  s_nop 0
  ds_read_b128 v[80:83], v152 offset:0
  ds_read_b128 v[84:87], v153 offset:0
  ds_read_b128 v[88:91], v154 offset:0
  ds_read_b128 v[92:95], v155 offset:0
  ds_read_b64_tr_b16 v[112:113], v156 offset:0
  ds_read_b64_tr_b16 v[114:115], v156 offset:1024
  v_mfma_f32_32x32x16_bf16 v[32:47], v[132:135], v[108:111], v[32:47]
  ds_read_b64_tr_b16 v[116:117], v157 offset:0
  ds_read_b64_tr_b16 v[118:119], v157 offset:1024
  ds_read_b64_tr_b16 v[120:121], v158 offset:0
  ds_read_b64_tr_b16 v[122:123], v158 offset:1024
  ds_read_b64_tr_b16 v[124:125], v159 offset:0
  ds_read_b64_tr_b16 v[126:127], v159 offset:1024
  v_mfma_f32_32x32x16_bf16 v[48:63], v[136:139], v[108:111], v[48:63]
  v_mfma_f32_32x32x16_bf16 v[64:79], v[140:143], v[108:111], v[64:79]
  v_mfma_f32_16x16x32_bf16 v[164:167], v[160:163], v[128:131], v[164:167]
  s_waitcnt lgkmcnt(0)
  v_mfma_f32_32x32x16_bf16 v[16:31], v[112:115], v[80:83], v[16:31]
  ds_read_b64_tr_b16 v[128:129], v156 offset:4096
  ds_read_b64_tr_b16 v[130:131], v156 offset:5120
  ds_read_b64_tr_b16 v[132:133], v157 offset:4096
  ds_read_b64_tr_b16 v[134:135], v157 offset:5120
  v_mfma_f32_32x32x16_bf16 v[32:47], v[116:119], v[80:83], v[32:47]
  ds_read_b64_tr_b16 v[136:137], v158 offset:4096
  s_nop 0
  ds_read_b64_tr_b16 v[138:139], v158 offset:5120
  ds_read_b64_tr_b16 v[140:141], v159 offset:4096
  ds_read_b64_tr_b16 v[142:143], v159 offset:5120
  v_mfma_f32_32x32x16_bf16 v[48:63], v[120:123], v[80:83], v[48:63]
  v_mfma_f32_32x32x16_bf16 v[64:79], v[124:127], v[80:83], v[64:79]
  v_mfma_f32_16x16x32_bf16 v[164:167], v[160:163], v[112:115], v[164:167]
  s_waitcnt lgkmcnt(0)
  v_mfma_f32_32x32x16_bf16 v[16:31], v[128:131], v[84:87], v[16:31]
  s_nop 0
  ds_read_b64_tr_b16 v[112:113], v156 offset:8192
  ds_read_b64_tr_b16 v[114:115], v156 offset:9216
  ds_read_b64_tr_b16 v[116:117], v157 offset:8192
  ds_read_b64_tr_b16 v[118:119], v157 offset:9216
  v_mfma_f32_32x32x16_bf16 v[32:47], v[132:135], v[84:87], v[32:47]
  ds_read_b64_tr_b16 v[120:121], v158 offset:8192
  ds_read_b64_tr_b16 v[122:123], v158 offset:9216
  ds_read_b64_tr_b16 v[124:125], v159 offset:8192
  ds_read_b64_tr_b16 v[126:127], v159 offset:9216
  v_mfma_f32_32x32x16_bf16 v[48:63], v[136:139], v[84:87], v[48:63]
  v_mfma_f32_32x32x16_bf16 v[64:79], v[140:143], v[84:87], v[64:79]
  v_mfma_f32_16x16x32_bf16 v[164:167], v[160:163], v[128:131], v[164:167]
  s_waitcnt lgkmcnt(0)
  v_mfma_f32_32x32x16_bf16 v[16:31], v[112:115], v[88:91], v[16:31]
  ds_read_b64_tr_b16 v[128:129], v156 offset:12288
  ds_read_b64_tr_b16 v[130:131], v156 offset:13312
  s_nop 0
  ds_read_b64_tr_b16 v[132:133], v157 offset:12288
  ds_read_b64_tr_b16 v[134:135], v157 offset:13312
  v_mfma_f32_32x32x16_bf16 v[32:47], v[116:119], v[88:91], v[32:47]
  ds_read_b64_tr_b16 v[136:137], v158 offset:12288
  ds_read_b64_tr_b16 v[138:139], v158 offset:13312
  ds_read_b64_tr_b16 v[140:141], v159 offset:12288
  ds_read_b64_tr_b16 v[142:143], v159 offset:13312
  v_mfma_f32_32x32x16_bf16 v[48:63], v[120:123], v[88:91], v[48:63]
  v_mfma_f32_32x32x16_bf16 v[64:79], v[124:127], v[88:91], v[64:79]
  v_mfma_f32_16x16x32_bf16 v[164:167], v[160:163], v[112:115], v[164:167]
  s_waitcnt lgkmcnt(0)
  v_mfma_f32_32x32x16_bf16 v[16:31], v[128:131], v[92:95], v[16:31]
  v_mfma_f32_32x32x16_bf16 v[32:47], v[132:135], v[92:95], v[32:47]
  v_mfma_f32_32x32x16_bf16 v[48:63], v[136:139], v[92:95], v[48:63]
  v_mfma_f32_32x32x16_bf16 v[64:79], v[140:143], v[92:95], v[64:79]
  v_mfma_f32_16x16x32_bf16 v[164:167], v[160:163], v[128:131], v[164:167]
  s_waitcnt vmcnt(0)
  s_mov_b32 s74, 400000
  s_branch L_recc_7
L_rec_5:
  buffer_load_dwordx4 v[168:171], v188, s[44:47], s13 offen sc1
  s_waitcnt vmcnt(0)
L_recc_7:
  v_cmp_ne_u32 vcc, v169, v6
  v_cmp_ne_u32 s[70:71], v171, v6
  s_nop 3
  s_or_b64 vcc, vcc, s[70:71]
  v_cmp_eq_u32 s[70:71], 0, v6
  s_nop 3
  s_or_b64 vcc, vcc, s[70:71]
  s_cbranch_vccz L_recd_6
  s_sub_u32 s74, s74, 1
  s_cbranch_scc1 L_recd_6
  s_sleep 1
  s_branch L_rec_5
L_recd_6:
  ds_write_b32 v185, v164
  v_mul_f32 v190, v170, v170
  v_mov_b32 v191, 0x3f800054
  v_mov_b32 v192, 0xb727c5ac
  v_fma_f32 v190, v190, v192, v191
  v_rsq_f32 v190, v190
  s_cmp_eq_u32 s94, 3
  s_cselect_b64 vcc, -1, 0
  v_mov_b32 v191, s14
  v_cndmask_b32 v190, v191, v190, vcc
  v_mul_f32 v12, v190, v170
  v_mul_f32 v14, v12, v168
  v_sub_f32_e64 v14, 0, v14
  s_waitcnt lgkmcnt(0)
  s_barrier
  ds_read_b128 v[80:83], v172 offset:0
  ds_read_b128 v[84:87], v172 offset:32
  ds_read_b128 v[88:91], v172 offset:64
  ds_read_b128 v[92:95], v172 offset:96
  ds_read_b128 v[96:99], v173 offset:0
  ds_read_b128 v[100:103], v173 offset:32
  ds_read_b128 v[104:107], v173 offset:64
  ds_read_b128 v[108:111], v173 offset:96
  ds_read_b128 v[112:115], v174 offset:0
  ds_read_b128 v[116:119], v174 offset:32
  ds_read_b128 v[120:123], v174 offset:64
  ds_read_b128 v[124:127], v174 offset:96
  s_cmp_eq_u32 s94, 3
  s_cbranch_scc1 L_A1_nosc
  v_pk_mul_f32 v[16:17], v[16:17], v[12:13] op_sel_hi:[1,0]
  v_pk_mul_f32 v[18:19], v[18:19], v[12:13] op_sel_hi:[1,0]
  v_pk_mul_f32 v[20:21], v[20:21], v[12:13] op_sel_hi:[1,0]
  v_pk_mul_f32 v[22:23], v[22:23], v[12:13] op_sel_hi:[1,0]
  v_pk_mul_f32 v[24:25], v[24:25], v[12:13] op_sel_hi:[1,0]
  v_pk_mul_f32 v[26:27], v[26:27], v[12:13] op_sel_hi:[1,0]
  v_pk_mul_f32 v[28:29], v[28:29], v[12:13] op_sel_hi:[1,0]
  v_pk_mul_f32 v[30:31], v[30:31], v[12:13] op_sel_hi:[1,0]
  v_pk_mul_f32 v[32:33], v[32:33], v[12:13] op_sel_hi:[1,0]
  v_pk_mul_f32 v[34:35], v[34:35], v[12:13] op_sel_hi:[1,0]
  v_pk_mul_f32 v[36:37], v[36:37], v[12:13] op_sel_hi:[1,0]
  v_pk_mul_f32 v[38:39], v[38:39], v[12:13] op_sel_hi:[1,0]
  v_pk_mul_f32 v[40:41], v[40:41], v[12:13] op_sel_hi:[1,0]
  v_pk_mul_f32 v[42:43], v[42:43], v[12:13] op_sel_hi:[1,0]
  v_pk_mul_f32 v[44:45], v[44:45], v[12:13] op_sel_hi:[1,0]
  v_pk_mul_f32 v[46:47], v[46:47], v[12:13] op_sel_hi:[1,0]
  v_pk_mul_f32 v[48:49], v[48:49], v[12:13] op_sel_hi:[1,0]
  v_pk_mul_f32 v[50:51], v[50:51], v[12:13] op_sel_hi:[1,0]
  v_pk_mul_f32 v[52:53], v[52:53], v[12:13] op_sel_hi:[1,0]
  v_pk_mul_f32 v[54:55], v[54:55], v[12:13] op_sel_hi:[1,0]
  v_pk_mul_f32 v[56:57], v[56:57], v[12:13] op_sel_hi:[1,0]
  v_pk_mul_f32 v[58:59], v[58:59], v[12:13] op_sel_hi:[1,0]
  v_pk_mul_f32 v[60:61], v[60:61], v[12:13] op_sel_hi:[1,0]
  v_pk_mul_f32 v[62:63], v[62:63], v[12:13] op_sel_hi:[1,0]
  v_pk_mul_f32 v[64:65], v[64:65], v[12:13] op_sel_hi:[1,0]
  v_pk_mul_f32 v[66:67], v[66:67], v[12:13] op_sel_hi:[1,0]
  v_pk_mul_f32 v[68:69], v[68:69], v[12:13] op_sel_hi:[1,0]
  v_pk_mul_f32 v[70:71], v[70:71], v[12:13] op_sel_hi:[1,0]
  v_pk_mul_f32 v[72:73], v[72:73], v[12:13] op_sel_hi:[1,0]
  v_pk_mul_f32 v[74:75], v[74:75], v[12:13] op_sel_hi:[1,0]
  v_pk_mul_f32 v[76:77], v[76:77], v[12:13] op_sel_hi:[1,0]
  v_pk_mul_f32 v[78:79], v[78:79], v[12:13] op_sel_hi:[1,0]
L_A1_nosc:
  s_waitcnt lgkmcnt(8)
  ds_read_b128 v[128:131], v175 offset:0
  ds_read_b128 v[132:135], v175 offset:32
  ds_read_b128 v[136:139], v175 offset:64
  ds_read_b128 v[140:143], v175 offset:96
  s_cmp_eq_u32 s94, 2
  s_cbranch_scc1 L_A1_v
  s_cmp_eq_u32 s94, 3
  s_cbranch_scc1 L_A1_w1
  s_nop 0
  v_pk_fma_f32 v[16:17], v[80:81], v[14:15], v[16:17] op_sel_hi:[1,0,1]
  v_pk_fma_f32 v[18:19], v[82:83], v[14:15], v[18:19] op_sel_hi:[1,0,1]
  v_pk_fma_f32 v[20:21], v[84:85], v[14:15], v[20:21] op_sel_hi:[1,0,1]
  v_pk_fma_f32 v[22:23], v[86:87], v[14:15], v[22:23] op_sel_hi:[1,0,1]
  v_pk_fma_f32 v[24:25], v[88:89], v[14:15], v[24:25] op_sel_hi:[1,0,1]
  v_pk_fma_f32 v[26:27], v[90:91], v[14:15], v[26:27] op_sel_hi:[1,0,1]
  v_pk_fma_f32 v[28:29], v[92:93], v[14:15], v[28:29] op_sel_hi:[1,0,1]
  v_pk_fma_f32 v[30:31], v[94:95], v[14:15], v[30:31] op_sel_hi:[1,0,1]
  v_cvt_pk_bf16_f32 v216, v16, v17
  v_cvt_pk_bf16_f32 v217, v18, v19
  v_cvt_pk_bf16_f32 v218, v20, v21
  v_cvt_pk_bf16_f32 v219, v22, v23
  v_cvt_pk_bf16_f32 v220, v24, v25
  v_cvt_pk_bf16_f32 v221, v26, v27
  v_cvt_pk_bf16_f32 v222, v28, v29
  v_cvt_pk_bf16_f32 v223, v30, v31
  v_cndmask_b32 v222, v222, v182, s[26:27]
  v_cndmask_b32 v223, v223, v183, s[26:27]
  buffer_store_dwordx4 v[216:219], v184, s[44:47], s4 offen sc1
  buffer_store_dwordx4 v[220:223], v184, s[44:47], s8 offen sc1
  s_waitcnt lgkmcnt(8)
  v_pk_fma_f32 v[32:33], v[96:97], v[14:15], v[32:33] op_sel_hi:[1,0,1]
  v_pk_fma_f32 v[34:35], v[98:99], v[14:15], v[34:35] op_sel_hi:[1,0,1]
  v_pk_fma_f32 v[36:37], v[100:101], v[14:15], v[36:37] op_sel_hi:[1,0,1]
  s_nop 0
  v_pk_fma_f32 v[38:39], v[102:103], v[14:15], v[38:39] op_sel_hi:[1,0,1]
  v_pk_fma_f32 v[40:41], v[104:105], v[14:15], v[40:41] op_sel_hi:[1,0,1]
  v_pk_fma_f32 v[42:43], v[106:107], v[14:15], v[42:43] op_sel_hi:[1,0,1]
  v_pk_fma_f32 v[44:45], v[108:109], v[14:15], v[44:45] op_sel_hi:[1,0,1]
  v_pk_fma_f32 v[46:47], v[110:111], v[14:15], v[46:47] op_sel_hi:[1,0,1]
  v_cvt_pk_bf16_f32 v224, v32, v33
  v_cvt_pk_bf16_f32 v225, v34, v35
  v_cvt_pk_bf16_f32 v226, v36, v37
  v_cvt_pk_bf16_f32 v227, v38, v39
  v_cvt_pk_bf16_f32 v228, v40, v41
  v_cvt_pk_bf16_f32 v229, v42, v43
  v_cvt_pk_bf16_f32 v230, v44, v45
  v_cvt_pk_bf16_f32 v231, v46, v47
  v_cndmask_b32 v230, v230, v182, s[26:27]
  v_cndmask_b32 v231, v231, v183, s[26:27]
  buffer_store_dwordx4 v[224:227], v184, s[44:47], s5 offen sc1
  buffer_store_dwordx4 v[228:231], v184, s[44:47], s9 offen sc1
  s_waitcnt lgkmcnt(4)
  v_pk_fma_f32 v[48:49], v[112:113], v[14:15], v[48:49] op_sel_hi:[1,0,1]
  v_pk_fma_f32 v[50:51], v[114:115], v[14:15], v[50:51] op_sel_hi:[1,0,1]
  v_pk_fma_f32 v[52:53], v[116:117], v[14:15], v[52:53] op_sel_hi:[1,0,1]
  v_pk_fma_f32 v[54:55], v[118:119], v[14:15], v[54:55] op_sel_hi:[1,0,1]
  v_pk_fma_f32 v[56:57], v[120:121], v[14:15], v[56:57] op_sel_hi:[1,0,1]
  v_pk_fma_f32 v[58:59], v[122:123], v[14:15], v[58:59] op_sel_hi:[1,0,1]
  s_nop 0
  v_pk_fma_f32 v[60:61], v[124:125], v[14:15], v[60:61] op_sel_hi:[1,0,1]
  v_pk_fma_f32 v[62:63], v[126:127], v[14:15], v[62:63] op_sel_hi:[1,0,1]
  v_cvt_pk_bf16_f32 v232, v48, v49
  v_cvt_pk_bf16_f32 v233, v50, v51
  v_cvt_pk_bf16_f32 v234, v52, v53
  v_cvt_pk_bf16_f32 v235, v54, v55
  v_cvt_pk_bf16_f32 v236, v56, v57
  v_cvt_pk_bf16_f32 v237, v58, v59
  v_cvt_pk_bf16_f32 v238, v60, v61
  v_cvt_pk_bf16_f32 v239, v62, v63
  v_cndmask_b32 v238, v238, v182, s[26:27]
  v_cndmask_b32 v239, v239, v183, s[26:27]
  buffer_store_dwordx4 v[232:235], v184, s[44:47], s6 offen sc1
  buffer_store_dwordx4 v[236:239], v184, s[44:47], s10 offen sc1
  s_waitcnt lgkmcnt(0)
  v_pk_fma_f32 v[64:65], v[128:129], v[14:15], v[64:65] op_sel_hi:[1,0,1]
  s_nop 0
  v_pk_fma_f32 v[66:67], v[130:131], v[14:15], v[66:67] op_sel_hi:[1,0,1]
  v_pk_fma_f32 v[68:69], v[132:133], v[14:15], v[68:69] op_sel_hi:[1,0,1]
  v_pk_fma_f32 v[70:71], v[134:135], v[14:15], v[70:71] op_sel_hi:[1,0,1]
  v_pk_fma_f32 v[72:73], v[136:137], v[14:15], v[72:73] op_sel_hi:[1,0,1]
  v_pk_fma_f32 v[74:75], v[138:139], v[14:15], v[74:75] op_sel_hi:[1,0,1]
  v_pk_fma_f32 v[76:77], v[140:141], v[14:15], v[76:77] op_sel_hi:[1,0,1]
  v_pk_fma_f32 v[78:79], v[142:143], v[14:15], v[78:79] op_sel_hi:[1,0,1]
  v_cvt_pk_bf16_f32 v240, v64, v65
  v_cvt_pk_bf16_f32 v241, v66, v67
  v_cvt_pk_bf16_f32 v242, v68, v69
  v_cvt_pk_bf16_f32 v243, v70, v71
  v_cvt_pk_bf16_f32 v244, v72, v73
  v_cvt_pk_bf16_f32 v245, v74, v75
  v_cvt_pk_bf16_f32 v246, v76, v77
  v_cvt_pk_bf16_f32 v247, v78, v79
  v_cndmask_b32 v246, v246, v182, s[26:27]
  v_cndmask_b32 v247, v247, v183, s[26:27]
  buffer_store_dwordx4 v[240:243], v184, s[44:47], s7 offen sc1
  buffer_store_dwordx4 v[244:247], v184, s[44:47], s11 offen sc1
  s_branch L_A1_pub
L_A1_v:
  v_pk_fma_f32 v[16:17], v[80:81], v[14:15], v[16:17] op_sel_hi:[1,0,1]
  v_pk_fma_f32 v[18:19], v[82:83], v[14:15], v[18:19] op_sel_hi:[1,0,1]
  v_pk_fma_f32 v[20:21], v[84:85], v[14:15], v[20:21] op_sel_hi:[1,0,1]
  v_pk_fma_f32 v[22:23], v[86:87], v[14:15], v[22:23] op_sel_hi:[1,0,1]
  s_nop 0
  v_pk_fma_f32 v[24:25], v[88:89], v[14:15], v[24:25] op_sel_hi:[1,0,1]
  v_pk_fma_f32 v[26:27], v[90:91], v[14:15], v[26:27] op_sel_hi:[1,0,1]
  v_pk_fma_f32 v[28:29], v[92:93], v[14:15], v[28:29] op_sel_hi:[1,0,1]
  v_pk_fma_f32 v[30:31], v[94:95], v[14:15], v[30:31] op_sel_hi:[1,0,1]
  v_cvt_pk_bf16_f32 v216, v16, v17
  v_cvt_pk_bf16_f32 v217, v18, v19
  v_cvt_pk_bf16_f32 v218, v20, v21
  v_cvt_pk_bf16_f32 v219, v22, v23
  v_cvt_pk_bf16_f32 v220, v24, v25
  v_cvt_pk_bf16_f32 v221, v26, v27
  v_cvt_pk_bf16_f32 v222, v28, v29
  v_cvt_pk_bf16_f32 v223, v30, v31
  v_cndmask_b32 v222, v222, v182, s[26:27]
  v_cndmask_b32 v223, v223, v183, s[26:27]
  s_waitcnt lgkmcnt(0)
  ds_write_b64 v176, v[216:217] offset:0
  s_nop 0
  ds_write_b64 v177, v[218:219] offset:0
  ds_write_b64 v178, v[220:221] offset:0
  ds_write_b64 v179, v[222:223] offset:0
  ds_read_b64_tr_b16 v[216:217], v180 offset:0
  ds_read_b64_tr_b16 v[218:219], v181 offset:0
  ds_read_b64_tr_b16 v[220:221], v180 offset:1024
  ds_read_b64_tr_b16 v[222:223], v181 offset:1024
  v_pk_fma_f32 v[32:33], v[96:97], v[14:15], v[32:33] op_sel_hi:[1,0,1]
  v_pk_fma_f32 v[34:35], v[98:99], v[14:15], v[34:35] op_sel_hi:[1,0,1]
  v_pk_fma_f32 v[36:37], v[100:101], v[14:15], v[36:37] op_sel_hi:[1,0,1]
  v_pk_fma_f32 v[38:39], v[102:103], v[14:15], v[38:39] op_sel_hi:[1,0,1]
  v_pk_fma_f32 v[40:41], v[104:105], v[14:15], v[40:41] op_sel_hi:[1,0,1]
  v_pk_fma_f32 v[42:43], v[106:107], v[14:15], v[42:43] op_sel_hi:[1,0,1]
  v_pk_fma_f32 v[44:45], v[108:109], v[14:15], v[44:45] op_sel_hi:[1,0,1]
  v_pk_fma_f32 v[46:47], v[110:111], v[14:15], v[46:47] op_sel_hi:[1,0,1]
  v_cvt_pk_bf16_f32 v224, v32, v33
  v_cvt_pk_bf16_f32 v225, v34, v35
  v_cvt_pk_bf16_f32 v226, v36, v37
  v_cvt_pk_bf16_f32 v227, v38, v39
  v_cvt_pk_bf16_f32 v228, v40, v41
  v_cvt_pk_bf16_f32 v229, v42, v43
  v_cvt_pk_bf16_f32 v230, v44, v45
  v_cvt_pk_bf16_f32 v231, v46, v47
  v_cndmask_b32 v230, v230, v182, s[26:27]
  v_cndmask_b32 v231, v231, v183, s[26:27]
  s_waitcnt lgkmcnt(0)
  buffer_store_dwordx4 v[216:219], v184, s[44:47], s4 offen sc1
  buffer_store_dwordx4 v[220:223], v184, s[44:47], s8 offen sc1
  ds_write_b64 v176, v[224:225] offset:2048
  ds_write_b64 v177, v[226:227] offset:2048
  ds_write_b64 v178, v[228:229] offset:2048
  ds_write_b64 v179, v[230:231] offset:2048
  s_nop 0
  ds_read_b64_tr_b16 v[224:225], v180 offset:2048
  ds_read_b64_tr_b16 v[226:227], v181 offset:2048
  ds_read_b64_tr_b16 v[228:229], v180 offset:3072
  ds_read_b64_tr_b16 v[230:231], v181 offset:3072
  v_pk_fma_f32 v[48:49], v[112:113], v[14:15], v[48:49] op_sel_hi:[1,0,1]
  v_pk_fma_f32 v[50:51], v[114:115], v[14:15], v[50:51] op_sel_hi:[1,0,1]
  v_pk_fma_f32 v[52:53], v[116:117], v[14:15], v[52:53] op_sel_hi:[1,0,1]
  v_pk_fma_f32 v[54:55], v[118:119], v[14:15], v[54:55] op_sel_hi:[1,0,1]
  v_pk_fma_f32 v[56:57], v[120:121], v[14:15], v[56:57] op_sel_hi:[1,0,1]
  v_pk_fma_f32 v[58:59], v[122:123], v[14:15], v[58:59] op_sel_hi:[1,0,1]
  v_pk_fma_f32 v[60:61], v[124:125], v[14:15], v[60:61] op_sel_hi:[1,0,1]
  v_pk_fma_f32 v[62:63], v[126:127], v[14:15], v[62:63] op_sel_hi:[1,0,1]
  v_cvt_pk_bf16_f32 v232, v48, v49
  v_cvt_pk_bf16_f32 v233, v50, v51
  v_cvt_pk_bf16_f32 v234, v52, v53
  v_cvt_pk_bf16_f32 v235, v54, v55
  v_cvt_pk_bf16_f32 v236, v56, v57
  v_cvt_pk_bf16_f32 v237, v58, v59
  v_cvt_pk_bf16_f32 v238, v60, v61
  v_cvt_pk_bf16_f32 v239, v62, v63
  v_cndmask_b32 v238, v238, v182, s[26:27]
  v_cndmask_b32 v239, v239, v183, s[26:27]
  s_waitcnt lgkmcnt(0)
  buffer_store_dwordx4 v[224:227], v184, s[44:47], s5 offen sc1
  s_nop 0
  buffer_store_dwordx4 v[228:231], v184, s[44:47], s9 offen sc1
  ds_write_b64 v176, v[232:233] offset:4096
  ds_write_b64 v177, v[234:235] offset:4096
  ds_write_b64 v178, v[236:237] offset:4096
  ds_write_b64 v179, v[238:239] offset:4096
  ds_read_b64_tr_b16 v[232:233], v180 offset:4096
  ds_read_b64_tr_b16 v[234:235], v181 offset:4096
  ds_read_b64_tr_b16 v[236:237], v180 offset:5120
  ds_read_b64_tr_b16 v[238:239], v181 offset:5120
  v_pk_fma_f32 v[64:65], v[128:129], v[14:15], v[64:65] op_sel_hi:[1,0,1]
  v_pk_fma_f32 v[66:67], v[130:131], v[14:15], v[66:67] op_sel_hi:[1,0,1]
  v_pk_fma_f32 v[68:69], v[132:133], v[14:15], v[68:69] op_sel_hi:[1,0,1]
  v_pk_fma_f32 v[70:71], v[134:135], v[14:15], v[70:71] op_sel_hi:[1,0,1]
  v_pk_fma_f32 v[72:73], v[136:137], v[14:15], v[72:73] op_sel_hi:[1,0,1]
  v_pk_fma_f32 v[74:75], v[138:139], v[14:15], v[74:75] op_sel_hi:[1,0,1]
  v_pk_fma_f32 v[76:77], v[140:141], v[14:15], v[76:77] op_sel_hi:[1,0,1]
  v_pk_fma_f32 v[78:79], v[142:143], v[14:15], v[78:79] op_sel_hi:[1,0,1]
  v_cvt_pk_bf16_f32 v240, v64, v65
  v_cvt_pk_bf16_f32 v241, v66, v67
  v_cvt_pk_bf16_f32 v242, v68, v69
  v_cvt_pk_bf16_f32 v243, v70, v71
  v_cvt_pk_bf16_f32 v244, v72, v73
  v_cvt_pk_bf16_f32 v245, v74, v75
  v_cvt_pk_bf16_f32 v246, v76, v77
  v_cvt_pk_bf16_f32 v247, v78, v79
  v_cndmask_b32 v246, v246, v182, s[26:27]
  v_cndmask_b32 v247, v247, v183, s[26:27]
  s_waitcnt lgkmcnt(0)
  buffer_store_dwordx4 v[232:235], v184, s[44:47], s6 offen sc1
  buffer_store_dwordx4 v[236:239], v184, s[44:47], s10 offen sc1
  ds_write_b64 v176, v[240:241] offset:6144
  ds_write_b64 v177, v[242:243] offset:6144
  s_nop 0
  ds_write_b64 v178, v[244:245] offset:6144
  ds_write_b64 v179, v[246:247] offset:6144
  ds_read_b64_tr_b16 v[240:241], v180 offset:6144
  ds_read_b64_tr_b16 v[242:243], v181 offset:6144
  ds_read_b64_tr_b16 v[244:245], v180 offset:7168
  ds_read_b64_tr_b16 v[246:247], v181 offset:7168
  s_waitcnt lgkmcnt(0)
  buffer_store_dwordx4 v[240:243], v184, s[44:47], s7 offen sc1
  s_nop 0
  buffer_store_dwordx4 v[244:247], v184, s[44:47], s11 offen sc1
  s_branch L_A1_pub
L_A1_w1:
  v_mul_f32 v190, 0xc0135761, v12
  v_mul_f32 v192, v12, v12
  v_rcp_f32 v194, v12
  v_mul_f32 v192, v192, v12
  v_mul_f32 v192, 0xbdd2d3e8, v192
  v_sub_f32_e64 v14, 0, v168
  v_pk_fma_f32 v[16:17], v[80:81], v[14:15], v[16:17] op_sel_hi:[1,0,1]
  v_pk_fma_f32 v[18:19], v[82:83], v[14:15], v[18:19] op_sel_hi:[1,0,1]
  v_pk_fma_f32 v[20:21], v[84:85], v[14:15], v[20:21] op_sel_hi:[1,0,1]
  v_pk_fma_f32 v[22:23], v[86:87], v[14:15], v[22:23] op_sel_hi:[1,0,1]
  v_pk_fma_f32 v[24:25], v[88:89], v[14:15], v[24:25] op_sel_hi:[1,0,1]
  v_pk_fma_f32 v[26:27], v[90:91], v[14:15], v[26:27] op_sel_hi:[1,0,1]
  v_pk_fma_f32 v[28:29], v[92:93], v[14:15], v[28:29] op_sel_hi:[1,0,1]
  v_pk_fma_f32 v[30:31], v[94:95], v[14:15], v[30:31] op_sel_hi:[1,0,1]
  v_pk_mul_f32 v[200:201], v[16:17], v[16:17]
  v_pk_mul_f32 v[202:203], v[18:19], v[18:19]
  v_pk_mul_f32 v[204:205], v[20:21], v[20:21]
  v_pk_mul_f32 v[206:207], v[22:23], v[22:23]
  v_pk_mul_f32 v[208:209], v[24:25], v[24:25]
  v_pk_mul_f32 v[210:211], v[26:27], v[26:27]
  v_pk_mul_f32 v[212:213], v[28:29], v[28:29]
  v_pk_mul_f32 v[214:215], v[30:31], v[30:31]
  v_pk_fma_f32 v[200:201], v[200:201], v[192:193], v[190:191] op_sel_hi:[1,0,0]
  v_pk_fma_f32 v[202:203], v[202:203], v[192:193], v[190:191] op_sel_hi:[1,0,0]
  v_pk_fma_f32 v[204:205], v[204:205], v[192:193], v[190:191] op_sel_hi:[1,0,0]
  v_pk_fma_f32 v[206:207], v[206:207], v[192:193], v[190:191] op_sel_hi:[1,0,0]
  v_pk_fma_f32 v[208:209], v[208:209], v[192:193], v[190:191] op_sel_hi:[1,0,0]
  v_pk_fma_f32 v[210:211], v[210:211], v[192:193], v[190:191] op_sel_hi:[1,0,0]
  v_pk_fma_f32 v[212:213], v[212:213], v[192:193], v[190:191] op_sel_hi:[1,0,0]
  v_pk_fma_f32 v[214:215], v[214:215], v[192:193], v[190:191] op_sel_hi:[1,0,0]
  v_pk_mul_f32 v[200:201], v[200:201], v[16:17]
  v_pk_mul_f32 v[202:203], v[202:203], v[18:19]
  v_pk_mul_f32 v[204:205], v[204:205], v[20:21]
  v_pk_mul_f32 v[206:207], v[206:207], v[22:23]
  v_pk_mul_f32 v[208:209], v[208:209], v[24:25]
  v_pk_mul_f32 v[210:211], v[210:211], v[26:27]
  v_pk_mul_f32 v[212:213], v[212:213], v[28:29]
  v_pk_mul_f32 v[214:215], v[214:215], v[30:31]
  v_exp_f32 v200, v200
  v_exp_f32 v201, v201
  v_exp_f32 v202, v202
  v_exp_f32 v203, v203
  v_exp_f32 v204, v204
  v_exp_f32 v205, v205
  v_exp_f32 v206, v206
  v_exp_f32 v207, v207
  v_exp_f32 v208, v208
  v_exp_f32 v209, v209
  v_exp_f32 v210, v210
  v_exp_f32 v211, v211
  v_exp_f32 v212, v212
  v_exp_f32 v213, v213
  v_exp_f32 v214, v214
  v_exp_f32 v215, v215
  v_pk_fma_f32 v[200:201], v[200:201], v[194:195], v[194:195] op_sel_hi:[1,0,0]
  v_pk_fma_f32 v[202:203], v[202:203], v[194:195], v[194:195] op_sel_hi:[1,0,0]
  v_pk_fma_f32 v[204:205], v[204:205], v[194:195], v[194:195] op_sel_hi:[1,0,0]
  v_pk_fma_f32 v[206:207], v[206:207], v[194:195], v[194:195] op_sel_hi:[1,0,0]
  v_pk_fma_f32 v[208:209], v[208:209], v[194:195], v[194:195] op_sel_hi:[1,0,0]
  v_pk_fma_f32 v[210:211], v[210:211], v[194:195], v[194:195] op_sel_hi:[1,0,0]
  v_pk_fma_f32 v[212:213], v[212:213], v[194:195], v[194:195] op_sel_hi:[1,0,0]
  v_pk_fma_f32 v[214:215], v[214:215], v[194:195], v[194:195] op_sel_hi:[1,0,0]
  v_rcp_f32 v200, v200
  v_rcp_f32 v201, v201
  v_rcp_f32 v202, v202
  v_rcp_f32 v203, v203
  v_rcp_f32 v204, v204
  v_rcp_f32 v205, v205
  v_rcp_f32 v206, v206
  v_rcp_f32 v207, v207
  v_rcp_f32 v208, v208
  v_rcp_f32 v209, v209
  v_rcp_f32 v210, v210
  v_rcp_f32 v211, v211
  v_rcp_f32 v212, v212
  v_rcp_f32 v213, v213
  v_rcp_f32 v214, v214
  v_rcp_f32 v215, v215
  v_pk_mul_f32 v[16:17], v[16:17], v[200:201]
  v_pk_mul_f32 v[18:19], v[18:19], v[202:203]
  v_pk_mul_f32 v[20:21], v[20:21], v[204:205]
  v_pk_mul_f32 v[22:23], v[22:23], v[206:207]
  v_pk_mul_f32 v[24:25], v[24:25], v[208:209]
  v_pk_mul_f32 v[26:27], v[26:27], v[210:211]
  v_pk_mul_f32 v[28:29], v[28:29], v[212:213]
  v_pk_mul_f32 v[30:31], v[30:31], v[214:215]
  v_cvt_pk_bf16_f32 v216, v16, v17
  v_cvt_pk_bf16_f32 v217, v18, v19
  v_cvt_pk_bf16_f32 v218, v20, v21
  v_cvt_pk_bf16_f32 v219, v22, v23
  v_cvt_pk_bf16_f32 v220, v24, v25
  v_cvt_pk_bf16_f32 v221, v26, v27
  v_cvt_pk_bf16_f32 v222, v28, v29
  v_cvt_pk_bf16_f32 v223, v30, v31
  buffer_store_dwordx4 v[216:219], v184, s[44:47], s4 offen sc1
  buffer_store_dwordx4 v[220:223], v184, s[44:47], s8 offen sc1
  s_waitcnt lgkmcnt(8)
  v_pk_fma_f32 v[32:33], v[96:97], v[14:15], v[32:33] op_sel_hi:[1,0,1]
  v_pk_fma_f32 v[34:35], v[98:99], v[14:15], v[34:35] op_sel_hi:[1,0,1]
  v_pk_fma_f32 v[36:37], v[100:101], v[14:15], v[36:37] op_sel_hi:[1,0,1]
  v_pk_fma_f32 v[38:39], v[102:103], v[14:15], v[38:39] op_sel_hi:[1,0,1]
  v_pk_fma_f32 v[40:41], v[104:105], v[14:15], v[40:41] op_sel_hi:[1,0,1]
  v_pk_fma_f32 v[42:43], v[106:107], v[14:15], v[42:43] op_sel_hi:[1,0,1]
  v_pk_fma_f32 v[44:45], v[108:109], v[14:15], v[44:45] op_sel_hi:[1,0,1]
  s_nop 0
  v_pk_fma_f32 v[46:47], v[110:111], v[14:15], v[46:47] op_sel_hi:[1,0,1]
  v_pk_mul_f32 v[200:201], v[32:33], v[32:33]
  v_pk_mul_f32 v[202:203], v[34:35], v[34:35]
  v_pk_mul_f32 v[204:205], v[36:37], v[36:37]
  v_pk_mul_f32 v[206:207], v[38:39], v[38:39]
  v_pk_mul_f32 v[208:209], v[40:41], v[40:41]
  v_pk_mul_f32 v[210:211], v[42:43], v[42:43]
  v_pk_mul_f32 v[212:213], v[44:45], v[44:45]
  v_pk_mul_f32 v[214:215], v[46:47], v[46:47]
  v_pk_fma_f32 v[200:201], v[200:201], v[192:193], v[190:191] op_sel_hi:[1,0,0]
  v_pk_fma_f32 v[202:203], v[202:203], v[192:193], v[190:191] op_sel_hi:[1,0,0]
  v_pk_fma_f32 v[204:205], v[204:205], v[192:193], v[190:191] op_sel_hi:[1,0,0]
  v_pk_fma_f32 v[206:207], v[206:207], v[192:193], v[190:191] op_sel_hi:[1,0,0]
  v_pk_fma_f32 v[208:209], v[208:209], v[192:193], v[190:191] op_sel_hi:[1,0,0]
  v_pk_fma_f32 v[210:211], v[210:211], v[192:193], v[190:191] op_sel_hi:[1,0,0]
  v_pk_fma_f32 v[212:213], v[212:213], v[192:193], v[190:191] op_sel_hi:[1,0,0]
  v_pk_fma_f32 v[214:215], v[214:215], v[192:193], v[190:191] op_sel_hi:[1,0,0]
  v_pk_mul_f32 v[200:201], v[200:201], v[32:33]
  v_pk_mul_f32 v[202:203], v[202:203], v[34:35]
  v_pk_mul_f32 v[204:205], v[204:205], v[36:37]
  v_pk_mul_f32 v[206:207], v[206:207], v[38:39]
  v_pk_mul_f32 v[208:209], v[208:209], v[40:41]
  v_pk_mul_f32 v[210:211], v[210:211], v[42:43]
  v_pk_mul_f32 v[212:213], v[212:213], v[44:45]
  v_pk_mul_f32 v[214:215], v[214:215], v[46:47]
  v_exp_f32 v200, v200
  v_exp_f32 v201, v201
  v_exp_f32 v202, v202
  v_exp_f32 v203, v203
  v_exp_f32 v204, v204
  v_exp_f32 v205, v205
  v_exp_f32 v206, v206
  v_exp_f32 v207, v207
  v_exp_f32 v208, v208
  v_exp_f32 v209, v209
  v_exp_f32 v210, v210
  v_exp_f32 v211, v211
  v_exp_f32 v212, v212
  v_exp_f32 v213, v213
  v_exp_f32 v214, v214
  v_exp_f32 v215, v215
  v_pk_fma_f32 v[200:201], v[200:201], v[194:195], v[194:195] op_sel_hi:[1,0,0]
  v_pk_fma_f32 v[202:203], v[202:203], v[194:195], v[194:195] op_sel_hi:[1,0,0]
  v_pk_fma_f32 v[204:205], v[204:205], v[194:195], v[194:195] op_sel_hi:[1,0,0]
  v_pk_fma_f32 v[206:207], v[206:207], v[194:195], v[194:195] op_sel_hi:[1,0,0]
  v_pk_fma_f32 v[208:209], v[208:209], v[194:195], v[194:195] op_sel_hi:[1,0,0]
  v_pk_fma_f32 v[210:211], v[210:211], v[194:195], v[194:195] op_sel_hi:[1,0,0]
  v_pk_fma_f32 v[212:213], v[212:213], v[194:195], v[194:195] op_sel_hi:[1,0,0]
  v_pk_fma_f32 v[214:215], v[214:215], v[194:195], v[194:195] op_sel_hi:[1,0,0]
  v_rcp_f32 v200, v200
  v_rcp_f32 v201, v201
  v_rcp_f32 v202, v202
  v_rcp_f32 v203, v203
  v_rcp_f32 v204, v204
  v_rcp_f32 v205, v205
  v_rcp_f32 v206, v206
  v_rcp_f32 v207, v207
  v_rcp_f32 v208, v208
  v_rcp_f32 v209, v209
  v_rcp_f32 v210, v210
  v_rcp_f32 v211, v211
  v_rcp_f32 v212, v212
  v_rcp_f32 v213, v213
  v_rcp_f32 v214, v214
  v_rcp_f32 v215, v215
  v_pk_mul_f32 v[32:33], v[32:33], v[200:201]
  v_pk_mul_f32 v[34:35], v[34:35], v[202:203]
  v_pk_mul_f32 v[36:37], v[36:37], v[204:205]
  v_pk_mul_f32 v[38:39], v[38:39], v[206:207]
  v_pk_mul_f32 v[40:41], v[40:41], v[208:209]
  v_pk_mul_f32 v[42:43], v[42:43], v[210:211]
  v_pk_mul_f32 v[44:45], v[44:45], v[212:213]
  v_pk_mul_f32 v[46:47], v[46:47], v[214:215]
  v_cvt_pk_bf16_f32 v224, v32, v33
  v_cvt_pk_bf16_f32 v225, v34, v35
  v_cvt_pk_bf16_f32 v226, v36, v37
  v_cvt_pk_bf16_f32 v227, v38, v39
  v_cvt_pk_bf16_f32 v228, v40, v41
  v_cvt_pk_bf16_f32 v229, v42, v43
  v_cvt_pk_bf16_f32 v230, v44, v45
  v_cvt_pk_bf16_f32 v231, v46, v47
  buffer_store_dwordx4 v[224:227], v184, s[44:47], s5 offen sc1
  buffer_store_dwordx4 v[228:231], v184, s[44:47], s9 offen sc1
  s_waitcnt lgkmcnt(4)
  v_pk_fma_f32 v[48:49], v[112:113], v[14:15], v[48:49] op_sel_hi:[1,0,1]
  v_pk_fma_f32 v[50:51], v[114:115], v[14:15], v[50:51] op_sel_hi:[1,0,1]
  v_pk_fma_f32 v[52:53], v[116:117], v[14:15], v[52:53] op_sel_hi:[1,0,1]
  v_pk_fma_f32 v[54:55], v[118:119], v[14:15], v[54:55] op_sel_hi:[1,0,1]
  s_nop 0
  v_pk_fma_f32 v[56:57], v[120:121], v[14:15], v[56:57] op_sel_hi:[1,0,1]
  v_pk_fma_f32 v[58:59], v[122:123], v[14:15], v[58:59] op_sel_hi:[1,0,1]
  v_pk_fma_f32 v[60:61], v[124:125], v[14:15], v[60:61] op_sel_hi:[1,0,1]
  v_pk_fma_f32 v[62:63], v[126:127], v[14:15], v[62:63] op_sel_hi:[1,0,1]
  v_pk_mul_f32 v[200:201], v[48:49], v[48:49]
  v_pk_mul_f32 v[202:203], v[50:51], v[50:51]
  v_pk_mul_f32 v[204:205], v[52:53], v[52:53]
  v_pk_mul_f32 v[206:207], v[54:55], v[54:55]
  v_pk_mul_f32 v[208:209], v[56:57], v[56:57]
  v_pk_mul_f32 v[210:211], v[58:59], v[58:59]
  v_pk_mul_f32 v[212:213], v[60:61], v[60:61]
  v_pk_mul_f32 v[214:215], v[62:63], v[62:63]
  v_pk_fma_f32 v[200:201], v[200:201], v[192:193], v[190:191] op_sel_hi:[1,0,0]
  v_pk_fma_f32 v[202:203], v[202:203], v[192:193], v[190:191] op_sel_hi:[1,0,0]
  v_pk_fma_f32 v[204:205], v[204:205], v[192:193], v[190:191] op_sel_hi:[1,0,0]
  v_pk_fma_f32 v[206:207], v[206:207], v[192:193], v[190:191] op_sel_hi:[1,0,0]
  v_pk_fma_f32 v[208:209], v[208:209], v[192:193], v[190:191] op_sel_hi:[1,0,0]
  v_pk_fma_f32 v[210:211], v[210:211], v[192:193], v[190:191] op_sel_hi:[1,0,0]
  v_pk_fma_f32 v[212:213], v[212:213], v[192:193], v[190:191] op_sel_hi:[1,0,0]
  v_pk_fma_f32 v[214:215], v[214:215], v[192:193], v[190:191] op_sel_hi:[1,0,0]
  v_pk_mul_f32 v[200:201], v[200:201], v[48:49]
  v_pk_mul_f32 v[202:203], v[202:203], v[50:51]
  v_pk_mul_f32 v[204:205], v[204:205], v[52:53]
  v_pk_mul_f32 v[206:207], v[206:207], v[54:55]
  v_pk_mul_f32 v[208:209], v[208:209], v[56:57]
  v_pk_mul_f32 v[210:211], v[210:211], v[58:59]
  v_pk_mul_f32 v[212:213], v[212:213], v[60:61]
  v_pk_mul_f32 v[214:215], v[214:215], v[62:63]
  v_exp_f32 v200, v200
  v_exp_f32 v201, v201
  v_exp_f32 v202, v202
  v_exp_f32 v203, v203
  v_exp_f32 v204, v204
  v_exp_f32 v205, v205
  v_exp_f32 v206, v206
  v_exp_f32 v207, v207
  v_exp_f32 v208, v208
  v_exp_f32 v209, v209
  v_exp_f32 v210, v210
  v_exp_f32 v211, v211
  v_exp_f32 v212, v212
  v_exp_f32 v213, v213
  v_exp_f32 v214, v214
  v_exp_f32 v215, v215
  v_pk_fma_f32 v[200:201], v[200:201], v[194:195], v[194:195] op_sel_hi:[1,0,0]
  v_pk_fma_f32 v[202:203], v[202:203], v[194:195], v[194:195] op_sel_hi:[1,0,0]
  v_pk_fma_f32 v[204:205], v[204:205], v[194:195], v[194:195] op_sel_hi:[1,0,0]
  v_pk_fma_f32 v[206:207], v[206:207], v[194:195], v[194:195] op_sel_hi:[1,0,0]
  v_pk_fma_f32 v[208:209], v[208:209], v[194:195], v[194:195] op_sel_hi:[1,0,0]
  v_pk_fma_f32 v[210:211], v[210:211], v[194:195], v[194:195] op_sel_hi:[1,0,0]
  v_pk_fma_f32 v[212:213], v[212:213], v[194:195], v[194:195] op_sel_hi:[1,0,0]
  v_pk_fma_f32 v[214:215], v[214:215], v[194:195], v[194:195] op_sel_hi:[1,0,0]
  v_rcp_f32 v200, v200
  v_rcp_f32 v201, v201
  v_rcp_f32 v202, v202
  v_rcp_f32 v203, v203
  v_rcp_f32 v204, v204
  v_rcp_f32 v205, v205
  v_rcp_f32 v206, v206
  v_rcp_f32 v207, v207
  v_rcp_f32 v208, v208
  v_rcp_f32 v209, v209
  v_rcp_f32 v210, v210
  v_rcp_f32 v211, v211
  v_rcp_f32 v212, v212
  v_rcp_f32 v213, v213
  v_rcp_f32 v214, v214
  v_rcp_f32 v215, v215
  v_pk_mul_f32 v[48:49], v[48:49], v[200:201]
  v_pk_mul_f32 v[50:51], v[50:51], v[202:203]
  v_pk_mul_f32 v[52:53], v[52:53], v[204:205]
  v_pk_mul_f32 v[54:55], v[54:55], v[206:207]
  v_pk_mul_f32 v[56:57], v[56:57], v[208:209]
  v_pk_mul_f32 v[58:59], v[58:59], v[210:211]
  v_pk_mul_f32 v[60:61], v[60:61], v[212:213]
  v_pk_mul_f32 v[62:63], v[62:63], v[214:215]
  v_cvt_pk_bf16_f32 v232, v48, v49
  v_cvt_pk_bf16_f32 v233, v50, v51
  v_cvt_pk_bf16_f32 v234, v52, v53
  v_cvt_pk_bf16_f32 v235, v54, v55
  v_cvt_pk_bf16_f32 v236, v56, v57
  v_cvt_pk_bf16_f32 v237, v58, v59
  v_cvt_pk_bf16_f32 v238, v60, v61
  v_cvt_pk_bf16_f32 v239, v62, v63
  buffer_store_dwordx4 v[232:235], v184, s[44:47], s6 offen sc1
  buffer_store_dwordx4 v[236:239], v184, s[44:47], s10 offen sc1
  s_waitcnt lgkmcnt(0)
  v_pk_fma_f32 v[64:65], v[128:129], v[14:15], v[64:65] op_sel_hi:[1,0,1]
  s_nop 0
  v_pk_fma_f32 v[66:67], v[130:131], v[14:15], v[66:67] op_sel_hi:[1,0,1]
  v_pk_fma_f32 v[68:69], v[132:133], v[14:15], v[68:69] op_sel_hi:[1,0,1]
  v_pk_fma_f32 v[70:71], v[134:135], v[14:15], v[70:71] op_sel_hi:[1,0,1]
  v_pk_fma_f32 v[72:73], v[136:137], v[14:15], v[72:73] op_sel_hi:[1,0,1]
  v_pk_fma_f32 v[74:75], v[138:139], v[14:15], v[74:75] op_sel_hi:[1,0,1]
  v_pk_fma_f32 v[76:77], v[140:141], v[14:15], v[76:77] op_sel_hi:[1,0,1]
  v_pk_fma_f32 v[78:79], v[142:143], v[14:15], v[78:79] op_sel_hi:[1,0,1]
  v_pk_mul_f32 v[200:201], v[64:65], v[64:65]
  v_pk_mul_f32 v[202:203], v[66:67], v[66:67]
  v_pk_mul_f32 v[204:205], v[68:69], v[68:69]
  v_pk_mul_f32 v[206:207], v[70:71], v[70:71]
  v_pk_mul_f32 v[208:209], v[72:73], v[72:73]
  v_pk_mul_f32 v[210:211], v[74:75], v[74:75]
  v_pk_mul_f32 v[212:213], v[76:77], v[76:77]
  v_pk_mul_f32 v[214:215], v[78:79], v[78:79]
  v_pk_fma_f32 v[200:201], v[200:201], v[192:193], v[190:191] op_sel_hi:[1,0,0]
  v_pk_fma_f32 v[202:203], v[202:203], v[192:193], v[190:191] op_sel_hi:[1,0,0]
  v_pk_fma_f32 v[204:205], v[204:205], v[192:193], v[190:191] op_sel_hi:[1,0,0]
  v_pk_fma_f32 v[206:207], v[206:207], v[192:193], v[190:191] op_sel_hi:[1,0,0]
  v_pk_fma_f32 v[208:209], v[208:209], v[192:193], v[190:191] op_sel_hi:[1,0,0]
  v_pk_fma_f32 v[210:211], v[210:211], v[192:193], v[190:191] op_sel_hi:[1,0,0]
  v_pk_fma_f32 v[212:213], v[212:213], v[192:193], v[190:191] op_sel_hi:[1,0,0]
  v_pk_fma_f32 v[214:215], v[214:215], v[192:193], v[190:191] op_sel_hi:[1,0,0]
  v_pk_mul_f32 v[200:201], v[200:201], v[64:65]
  v_pk_mul_f32 v[202:203], v[202:203], v[66:67]
  v_pk_mul_f32 v[204:205], v[204:205], v[68:69]
  v_pk_mul_f32 v[206:207], v[206:207], v[70:71]
  v_pk_mul_f32 v[208:209], v[208:209], v[72:73]
  v_pk_mul_f32 v[210:211], v[210:211], v[74:75]
  v_pk_mul_f32 v[212:213], v[212:213], v[76:77]
  v_pk_mul_f32 v[214:215], v[214:215], v[78:79]
  v_exp_f32 v200, v200
  v_exp_f32 v201, v201
  v_exp_f32 v202, v202
  v_exp_f32 v203, v203
  v_exp_f32 v204, v204
  v_exp_f32 v205, v205
  v_exp_f32 v206, v206
  v_exp_f32 v207, v207
  v_exp_f32 v208, v208
  v_exp_f32 v209, v209
  v_exp_f32 v210, v210
  v_exp_f32 v211, v211
  v_exp_f32 v212, v212
  v_exp_f32 v213, v213
  v_exp_f32 v214, v214
  v_exp_f32 v215, v215
  v_pk_fma_f32 v[200:201], v[200:201], v[194:195], v[194:195] op_sel_hi:[1,0,0]
  v_pk_fma_f32 v[202:203], v[202:203], v[194:195], v[194:195] op_sel_hi:[1,0,0]
  v_pk_fma_f32 v[204:205], v[204:205], v[194:195], v[194:195] op_sel_hi:[1,0,0]
  v_pk_fma_f32 v[206:207], v[206:207], v[194:195], v[194:195] op_sel_hi:[1,0,0]
  v_pk_fma_f32 v[208:209], v[208:209], v[194:195], v[194:195] op_sel_hi:[1,0,0]
  v_pk_fma_f32 v[210:211], v[210:211], v[194:195], v[194:195] op_sel_hi:[1,0,0]
  v_pk_fma_f32 v[212:213], v[212:213], v[194:195], v[194:195] op_sel_hi:[1,0,0]
  v_pk_fma_f32 v[214:215], v[214:215], v[194:195], v[194:195] op_sel_hi:[1,0,0]
  v_rcp_f32 v200, v200
  v_rcp_f32 v201, v201
  v_rcp_f32 v202, v202
  v_rcp_f32 v203, v203
  v_rcp_f32 v204, v204
  v_rcp_f32 v205, v205
  v_rcp_f32 v206, v206
  v_rcp_f32 v207, v207
  v_rcp_f32 v208, v208
  v_rcp_f32 v209, v209
  v_rcp_f32 v210, v210
  v_rcp_f32 v211, v211
  v_rcp_f32 v212, v212
  v_rcp_f32 v213, v213
  v_rcp_f32 v214, v214
  v_rcp_f32 v215, v215
  v_pk_mul_f32 v[64:65], v[64:65], v[200:201]
  v_pk_mul_f32 v[66:67], v[66:67], v[202:203]
  v_pk_mul_f32 v[68:69], v[68:69], v[204:205]
  v_pk_mul_f32 v[70:71], v[70:71], v[206:207]
  v_pk_mul_f32 v[72:73], v[72:73], v[208:209]
  v_pk_mul_f32 v[74:75], v[74:75], v[210:211]
  v_pk_mul_f32 v[76:77], v[76:77], v[212:213]
  v_pk_mul_f32 v[78:79], v[78:79], v[214:215]
  v_cvt_pk_bf16_f32 v240, v64, v65
  v_cvt_pk_bf16_f32 v241, v66, v67
  v_cvt_pk_bf16_f32 v242, v68, v69
  v_cvt_pk_bf16_f32 v243, v70, v71
  v_cvt_pk_bf16_f32 v244, v72, v73
  v_cvt_pk_bf16_f32 v245, v74, v75
  v_cvt_pk_bf16_f32 v246, v76, v77
  v_cvt_pk_bf16_f32 v247, v78, v79
  buffer_store_dwordx4 v[240:243], v184, s[44:47], s7 offen sc1
  buffer_store_dwordx4 v[244:247], v184, s[44:47], s11 offen sc1
L_A1_pub:
  s_waitcnt vmcnt(0) lgkmcnt(0)
  s_barrier
  s_cmp_lg_u32 s64, 0
  s_cbranch_scc1 L_post_8
  buffer_store_dwordx2 v[6:7], v186, s[44:47], 0 offen sc1
  buffer_store_dwordx2 v[6:7], v187, s[44:47], 0 offen sc1
L_post_8:
  s_lshr_b32 s68, s66, 4
  s_lshl_b32 s75, s65, 1
  s_add_u32 s75, s75, s68
  s_and_b32 s76, s66, 15
  s_lshl_b32 s68, s75, 4
  s_add_u32 s68, s68, s76
  s_lshl_b32 s68, s68, 2
  s_add_u32 s68, s68, s64
  s_lshl_b32 s52, s68, 7
  s_lshl_b32 s80, s75, 18
  s_add_u32 s80, s80, 2621440
  s_lshl_b32 s68, s64, 16
  s_add_u32 s68, s68, s80
  s_mov_b32 s86, s68
  s_lshl_b32 s68, s76, 14
  s_add_u32 s80, s80, s68
  s_lshl_b32 s77, s75, 17
  s_lshl_b32 s68, s76, 13
  s_add_u32 s77, s77, s68
  s_add_u32 s77, s77, 524288
  s_add_u32 s8, s76, 0
  s_and_b32 s8, s8, 15
  s_lshl_b32 s8, s8, 12
  s_add_u32 s9, s76, 1
  s_and_b32 s9, s9, 15
  s_lshl_b32 s9, s9, 12
  s_add_u32 s10, s76, 2
  s_and_b32 s10, s10, 15
  s_lshl_b32 s10, s10, 12
  s_add_u32 s11, s76, 3
  s_and_b32 s11, s11, 15
  s_lshl_b32 s11, s11, 12
  s_add_u32 s12, s76, 4
  s_and_b32 s12, s12, 15
  s_lshl_b32 s12, s12, 12
  s_add_u32 s13, s76, 5
  s_and_b32 s13, s13, 15
  s_lshl_b32 s13, s13, 12
  s_add_u32 s14, s76, 6
  s_and_b32 s14, s14, 15
  s_lshl_b32 s14, s14, 12
  s_add_u32 s15, s76, 7
  s_and_b32 s15, s15, 15
  s_lshl_b32 s15, s15, 12
  s_add_u32 s16, s76, 8
  s_and_b32 s16, s16, 15
  s_lshl_b32 s16, s16, 12
  s_add_u32 s17, s76, 9
  s_and_b32 s17, s17, 15
  s_lshl_b32 s17, s17, 12
  s_add_u32 s18, s76, 10
  s_and_b32 s18, s18, 15
  s_lshl_b32 s18, s18, 12
  s_add_u32 s19, s76, 11
  s_and_b32 s19, s19, 15
  s_lshl_b32 s19, s19, 12
  s_add_u32 s20, s76, 12
  s_and_b32 s20, s20, 15
  s_lshl_b32 s20, s20, 12
  s_add_u32 s21, s76, 13
  s_and_b32 s21, s21, 15
  s_lshl_b32 s21, s21, 12
  s_add_u32 s22, s76, 14
  s_and_b32 s22, s22, 15
  s_lshl_b32 s22, s22, 12
  s_add_u32 s23, s76, 15
  s_and_b32 s23, s23, 15
  s_lshl_b32 s23, s23, 12
  s_mov_b32 s81, 0
  s_mov_b32 s87, 0
  s_xor_b32 s4, s64, 3
  s_lshl_b32 s4, s4, 11
  s_add_u32 s4, s4, s77
  s_xor_b32 s5, s64, 2
  s_lshl_b32 s5, s5, 11
  s_add_u32 s5, s5, s77
  s_xor_b32 s6, s64, 1
  s_lshl_b32 s6, s6, 11
  s_add_u32 s6, s6, s77
  s_xor_b32 s7, s64, 0
  s_lshl_b32 s7, s7, 11
  s_add_u32 s7, s7, s77
  v_mul_u32_u24 v0, 33024, v3
  v_lshl_add_u32 v0, v2, 4, v0
  s_lshl_b32 s68, s76, 2
  s_add_u32 s68, s68, s64
  s_lshl_b32 s68, s68, 9
  s_mul_i32 s69, s75, 132096
  s_add_u32 s68, s68, s69
  s_add_u32 s83, s68, 10518528
  s_add_u32 s84, s83, 66048
  s_lshl_b32 s68, s76, 1
  s_lshr_b32 s69, s64, 1
  s_add_u32 s68, s68, s69
  s_nop 0
  s_mul_i32 s68, s68, 1792
  s_lshr_b32 s69, s75, 2
  s_lshl_b32 s69, s69, 6
  s_add_u32 s68, s68, s69
  s_and_b32 s69, s75, 3
  s_lshl_b32 s69, s69, 1
  s_and_b32 s70, s64, 1
  s_add_u32 s69, s69, s70
  s_lshl_b32 s69, s69, 3
  s_add_u32 s68, s68, s69
  s_add_u32 s85, s68, 303104
  s_mov_b32 s74, 400000
L_sp_9:
  s_nop 0
  s_buffer_load_dwordx16 s[28:43], s[44:47], s52 offset:0 glc
  s_buffer_load_dwordx4 s[48:51], s[44:47], s52 offset:64 glc
  s_waitcnt lgkmcnt(0)
  s_xor_b64 s[28:29], s[28:29], s[0:1]
  s_xor_b64 s[30:31], s[30:31], s[0:1]
  s_xor_b64 s[32:33], s[32:33], s[0:1]
  s_xor_b64 s[34:35], s[34:35], s[0:1]
  s_xor_b64 s[36:37], s[36:37], s[0:1]
  s_xor_b64 s[38:39], s[38:39], s[0:1]
  s_xor_b64 s[40:41], s[40:41], s[0:1]
  s_xor_b64 s[42:43], s[42:43], s[0:1]
  s_xor_b64 s[48:49], s[48:49], s[0:1]
  s_xor_b64 s[50:51], s[50:51], s[0:1]
  s_or_b64 s[28:29], s[28:29], s[50:51]
  s_or_b64 s[28:29], s[28:29], s[48:49]
  s_or_b64 s[28:29], s[28:29], s[42:43]
  s_or_b64 s[28:29], s[28:29], s[40:41]
  s_or_b64 s[28:29], s[28:29], s[38:39]
  s_or_b64 s[28:29], s[28:29], s[36:37]
  s_or_b64 s[28:29], s[28:29], s[34:35]
  s_or_b64 s[28:29], s[28:29], s[32:33]
  s_or_b64 s[28:29], s[28:29], s[30:31]
  s_cbranch_scc0 L_spd_10
  s_sub_u32 s74, s74, 1
  s_cbranch_scc1 L_spd_10
  s_sleep 1
  s_branch L_sp_9
L_spd_10:
  buffer_load_dwordx4 v[224:227], v11, s[44:47], s80 offen offset:0 sc1
  s_nop 0
  buffer_load_dwordx4 v[228:231], v11, s[44:47], s80 offen offset:1024 sc1
  buffer_load_dwordx4 v[16:19], v11, s[44:47], s4 offen offset:0 sc1
  buffer_load_dwordx4 v[20:23], v11, s[44:47], s4 offen offset:1024 sc1
  buffer_load_dwordx4 v[24:27], v11, s[44:47], s5 offen offset:0 sc1
  buffer_load_dwordx4 v[28:31], v11, s[44:47], s5 offen offset:1024 sc1
  buffer_load_dwordx4 v[32:35], v11, s[44:47], s6 offen offset:0 sc1
  buffer_load_dwordx4 v[36:39], v11, s[44:47], s6 offen offset:1024 sc1
  buffer_load_dwordx4 v[40:43], v11, s[44:47], s7 offen offset:0 sc1
  buffer_load_dwordx4 v[44:47], v11, s[44:47], s7 offen offset:1024 sc1
  v_add_u32_e64 v10, s86, v11
  buffer_load_dwordx4 v[160:163], v10, s[44:47], s8 offen offset:0 sc1
  buffer_load_dwordx4 v[164:167], v10, s[44:47], s8 offen offset:1024 sc1
  buffer_load_dwordx4 v[192:195], v10, s[44:47], s8 offen offset:2048 sc1
  buffer_load_dwordx4 v[196:199], v10, s[44:47], s8 offen offset:3072 sc1
  buffer_load_dwordx4 v[168:171], v10, s[44:47], s9 offen offset:0 sc1
  buffer_load_dwordx4 v[172:175], v10, s[44:47], s9 offen offset:1024 sc1
  s_mul_i32 s68, s64, 12288
  v_add_u32 v8, s68, v11
  s_waitcnt vmcnt(12)
  v_mfma_f32_32x32x16_bf16 v[112:127], v[224:227], v[16:19], 0
  v_mfma_f32_32x32x16_bf16 v[112:127], v[228:231], v[20:23], v[112:127]
  s_waitcnt vmcnt(10)
  v_mfma_f32_32x32x16_bf16 v[128:143], v[224:227], v[24:27], 0
  v_mfma_f32_32x32x16_bf16 v[128:143], v[228:231], v[28:31], v[128:143]
  s_nop 8
  v_max3_f32 v12, v112, v113, v114
  v_max_f32 v12, v12, v115
  v_max3_f32 v12, v12, v116, v117
  v_max3_f32 v12, v12, v118, v119
  v_max3_f32 v12, v12, v120, v121
  v_max3_f32 v12, v12, v122, v123
  v_max3_f32 v12, v12, v124, v125
  v_max3_f32 v12, v12, v126, v127
  s_waitcnt vmcnt(8)
  v_mfma_f32_32x32x16_bf16 v[112:127], v[224:227], v[32:35], 0
  v_mfma_f32_32x32x16_bf16 v[112:127], v[228:231], v[36:39], v[112:127]
  v_max3_f32 v13, v128, v129, v130
  v_max_f32_e64 v13, v13, v131
  v_max3_f32 v13, v13, v132, v133
  v_max3_f32 v13, v13, v134, v135
  v_max3_f32 v13, v13, v136, v137
  v_max3_f32 v13, v13, v138, v139
  v_max3_f32 v13, v13, v140, v141
  v_max3_f32 v13, v13, v142, v143
  s_waitcnt vmcnt(6)
  v_mfma_f32_32x32x16_bf16 v[128:143], v[224:227], v[40:43], 0
  v_mfma_f32_32x32x16_bf16 v[128:143], v[228:231], v[44:47], v[128:143]
  s_nop 0
  v_max3_f32 v14, v112, v113, v114
  v_max_f32_e64 v14, v14, v115
  v_max3_f32 v14, v14, v116, v117
  v_max3_f32 v14, v14, v118, v119
  v_max3_f32 v14, v14, v120, v121
  v_max3_f32 v14, v14, v122, v123
  v_max3_f32 v14, v14, v124, v125
  v_max3_f32 v14, v14, v126, v127
  s_nop 2
  v_max3_f32 v15, v128, v129, v130
  v_max_f32 v15, v15, v131
  v_max3_f32 v15, v15, v132, v133
  v_max3_f32 v15, v15, v134, v135
  v_max3_f32 v15, v15, v136, v137
  v_max3_f32 v15, v15, v138, v139
  v_max3_f32 v15, v15, v140, v141
  v_max3_f32 v15, v15, v142, v143
L_A2_setmax:
  v_mov_b32 v224, v12
  v_mov_b32 v225, v13
  v_mov_b32 v226, v14
  v_mov_b32 v227, v15
  v_permlane32_swap_b32 v224, v12
  v_permlane32_swap_b32 v225, v13
  v_permlane32_swap_b32 v226, v14
  v_permlane32_swap_b32 v227, v15
  v_max_f32 v12, v224, v12
  v_max_f32 v13, v225, v13
  v_max_f32 v14, v226, v14
  v_max_f32 v15, v227, v15
  v_cvt_pk_bf16_f32 v224, -v12, -v12
  v_and_b32 v225, 0xffff0000, v224
  v_sub_f32 v226, -v12, v225
  v_cvt_pk_bf16_f32 v227, v226, v226
  v_and_b32 v227, 0xffff0000, v227
  v_sub_f32_e64 v226, v226, v227
  v_and_b32 v224, 0xffff, v224
  v_or_b32 v224, v224, v227
  v_cvt_pk_bf16_f32 v226, v226, 0
  v_cndmask_b32 v22, v22, v224, s[26:27]
  v_cndmask_b32 v23, v23, v226, s[26:27]
  s_waitcnt vmcnt(4)
  v_mfma_f32_32x32x16_bf16 v[112:127], v[160:163], v[16:19], 0
  v_mfma_f32_32x32x16_bf16 v[112:127], v[164:167], v[20:23], v[112:127]
  v_cvt_pk_bf16_f32 v228, -v13, -v13
  v_and_b32 v229, 0xffff0000, v228
  v_sub_f32 v230, -v13, v229
  v_cvt_pk_bf16_f32 v231, v230, v230
  v_and_b32 v231, 0xffff0000, v231
  v_sub_f32 v230, v230, v231
  v_and_b32 v228, 0xffff, v228
  v_or_b32 v228, v228, v231
  v_cvt_pk_bf16_f32 v230, v230, 0
  v_cndmask_b32 v30, v30, v228, s[26:27]
  v_cndmask_b32 v31, v31, v230, s[26:27]
  v_cvt_pk_bf16_f32 v232, -v14, -v14
  v_and_b32 v233, 0xffff0000, v232
  v_sub_f32 v234, -v14, v233
  v_cvt_pk_bf16_f32 v235, v234, v234
  v_and_b32 v235, 0xffff0000, v235
  v_sub_f32 v234, v234, v235
  v_and_b32 v232, 0xffff, v232
  v_or_b32 v232, v232, v235
  v_cvt_pk_bf16_f32 v234, v234, 0
  v_cndmask_b32 v38, v38, v232, s[26:27]
  v_cndmask_b32 v39, v39, v234, s[26:27]
  v_cvt_pk_bf16_f32 v236, -v15, -v15
  v_and_b32 v237, 0xffff0000, v236
  v_sub_f32 v238, -v15, v237
  v_cvt_pk_bf16_f32 v239, v238, v238
  v_and_b32 v239, 0xffff0000, v239
  v_sub_f32 v238, v238, v239
  v_and_b32 v236, 0xffff, v236
  v_or_b32 v236, v236, v239
  v_cvt_pk_bf16_f32 v238, v238, 0
  v_cndmask_b32 v46, v46, v236, s[26:27]
  v_cndmask_b32 v47, v47, v238, s[26:27]
  s_xor_b32 s68, s64, 3
  s_mul_i32 s68, s68, 12288
  v_add_u32_e64 v232, s68, v11
  s_xor_b32 s68, s64, 2
  s_mul_i32 s68, s68, 12288
  v_add_u32 v233, s68, v11
  s_xor_b32 s68, s64, 1
  s_mul_i32 s68, s68, 12288
  v_add_u32 v234, s68, v11
  v_mov_b32 v226, 49152
  v_mov_b32 v227, 0
  ds_write_b32 v226, v227
  s_setprio 0
  s_setprio 3
  v_mfma_f32_32x32x16_bf16 v[128:143], v[160:163], v[24:27], 0
  buffer_load_dwordx4 v[200:203], v10, s[44:47], s9 offen offset:2048 sc1
  s_setprio 0
  v_exp_f32 v112, v112
  v_exp_f32 v113, v113
  v_exp_f32 v114, v114
  v_exp_f32 v115, v115
  v_cvt_pk_bf16_f32 v144, v112, v113
  v_mfma_f32_32x32x16_bf16 v[128:143], v[164:167], v[28:31], v[128:143]
  v_exp_f32 v116, v116
  v_exp_f32 v117, v117
  v_cvt_pk_bf16_f32 v145, v114, v115
  v_exp_f32 v118, v118
  v_exp_f32 v119, v119
  v_cvt_pk_bf16_f32 v146, v116, v117
  s_setprio 3
  buffer_load_dwordx4 v[204:207], v10, s[44:47], s9 offen offset:3072 sc1
  s_setprio 0
  v_exp_f32 v120, v120
  v_exp_f32 v121, v121
  v_cvt_pk_bf16_f32 v147, v118, v119
  v_exp_f32 v122, v122
  v_exp_f32 v123, v123
  v_cvt_pk_bf16_f32 v148, v120, v121
  v_exp_f32 v124, v124
  v_exp_f32 v125, v125
  v_cvt_pk_bf16_f32 v149, v122, v123
  v_exp_f32 v126, v126
  v_exp_f32 v127, v127
  v_cvt_pk_bf16_f32 v150, v124, v125
  v_cvt_pk_bf16_f32 v151, v126, v127
  s_setprio 3
  v_mfma_f32_32x32x16_bf16 v[112:127], v[160:163], v[32:35], 0
  buffer_load_dwordx4 v[176:179], v10, s[44:47], s10 offen offset:0 sc1
  s_setprio 0
  v_exp_f32 v128, v128
  v_exp_f32 v129, v129
  v_exp_f32 v130, v130
  v_exp_f32 v131, v131
  v_cvt_pk_bf16_f32 v152, v128, v129
  v_mfma_f32_32x32x16_bf16 v[112:127], v[164:167], v[36:39], v[112:127]
  s_waitcnt vmcnt(5)
  v_exp_f32 v132, v132
  v_exp_f32 v133, v133
  v_cvt_pk_bf16_f32 v153, v130, v131
  v_exp_f32 v134, v134
  v_exp_f32 v135, v135
  v_cvt_pk_bf16_f32 v154, v132, v133
  s_setprio 3
  v_mfma_f32_32x32x16_bf16 v[48:63], v[192:195], v[144:147], 0
  buffer_load_dwordx4 v[180:183], v10, s[44:47], s10 offen offset:1024 sc1
  s_setprio 0
  v_exp_f32 v136, v136
  v_exp_f32 v137, v137
  v_cvt_pk_bf16_f32 v155, v134, v135
  v_exp_f32 v138, v138
  v_exp_f32 v139, v139
  v_cvt_pk_bf16_f32 v156, v136, v137
  v_mfma_f32_32x32x16_bf16 v[48:63], v[196:199], v[148:151], v[48:63]
  v_exp_f32 v140, v140
  v_exp_f32 v141, v141
  v_cvt_pk_bf16_f32 v157, v138, v139
  v_exp_f32 v142, v142
  v_exp_f32 v143, v143
  v_cvt_pk_bf16_f32 v158, v140, v141
  v_cvt_pk_bf16_f32 v159, v142, v143
  s_setprio 3
  v_mfma_f32_32x32x16_bf16 v[128:143], v[160:163], v[40:43], 0
  buffer_load_dwordx4 v[208:211], v10, s[44:47], s10 offen offset:2048 sc1
  s_setprio 0
  v_exp_f32 v112, v112
  v_exp_f32 v113, v113
  v_exp_f32 v114, v114
  v_exp_f32 v115, v115
  v_cvt_pk_bf16_f32 v144, v112, v113
  v_mfma_f32_32x32x16_bf16 v[128:143], v[164:167], v[44:47], v[128:143]
  v_exp_f32 v116, v116
  v_exp_f32 v117, v117
  v_cvt_pk_bf16_f32 v145, v114, v115
  v_exp_f32 v118, v118
  v_exp_f32 v119, v119
  v_cvt_pk_bf16_f32 v146, v116, v117
  s_setprio 3
  v_mfma_f32_32x32x16_bf16 v[64:79], v[192:195], v[152:155], 0
  buffer_load_dwordx4 v[212:215], v10, s[44:47], s10 offen offset:3072 sc1
  s_setprio 0
  v_exp_f32 v120, v120
  v_exp_f32 v121, v121
  v_cvt_pk_bf16_f32 v147, v118, v119
  v_exp_f32 v122, v122
  v_exp_f32 v123, v123
  v_cvt_pk_bf16_f32 v148, v120, v121
  v_mfma_f32_32x32x16_bf16 v[64:79], v[196:199], v[156:159], v[64:79]
  s_waitcnt vmcnt(6)
  v_exp_f32 v124, v124
  v_exp_f32 v125, v125
  v_cvt_pk_bf16_f32 v149, v122, v123
  v_exp_f32 v126, v126
  v_exp_f32 v127, v127
  v_cvt_pk_bf16_f32 v150, v124, v125
  v_cvt_pk_bf16_f32 v151, v126, v127
  s_setprio 3
  v_mfma_f32_32x32x16_bf16 v[112:127], v[168:171], v[16:19], 0
  buffer_load_dwordx4 v[184:187], v10, s[44:47], s11 offen offset:0 sc1
  s_setprio 0
  v_exp_f32 v128, v128
  v_exp_f32 v129, v129
  v_exp_f32 v130, v130
  v_exp_f32 v131, v131
  v_cvt_pk_bf16_f32 v152, v128, v129
  v_mfma_f32_32x32x16_bf16 v[112:127], v[172:175], v[20:23], v[112:127]
  v_exp_f32 v132, v132
  v_exp_f32 v133, v133
  v_cvt_pk_bf16_f32 v153, v130, v131
  v_exp_f32 v134, v134
  v_exp_f32_e64 v135, v135
  v_cvt_pk_bf16_f32 v154, v132, v133
  s_setprio 3
  v_mfma_f32_32x32x16_bf16 v[80:95], v[192:195], v[144:147], 0
  buffer_load_dwordx4 v[188:191], v10, s[44:47], s11 offen offset:1024 sc1
  s_setprio 0
  v_exp_f32 v136, v136
  v_exp_f32 v137, v137
  v_cvt_pk_bf16_f32 v155, v134, v135
  v_exp_f32 v138, v138
  v_exp_f32 v139, v139
  v_cvt_pk_bf16_f32 v156, v136, v137
  v_mfma_f32_32x32x16_bf16 v[80:95], v[196:199], v[148:151], v[80:95]
  v_exp_f32 v140, v140
  v_exp_f32 v141, v141
  v_cvt_pk_bf16_f32 v157, v138, v139
  v_exp_f32 v142, v142
  v_exp_f32_e64 v143, v143
  v_cvt_pk_bf16_f32 v158, v140, v141
  v_cvt_pk_bf16_f32 v159, v142, v143
  s_setprio 3
  v_mfma_f32_32x32x16_bf16 v[128:143], v[168:171], v[24:27], 0
  buffer_load_dwordx4 v[216:219], v10, s[44:47], s11 offen offset:2048 sc1
  s_setprio 0
  v_exp_f32 v112, v112
  v_exp_f32 v113, v113
  v_exp_f32 v114, v114
  v_exp_f32 v115, v115
  v_cvt_pk_bf16_f32 v144, v112, v113
  v_mfma_f32_32x32x16_bf16 v[128:143], v[172:175], v[28:31], v[128:143]
  v_exp_f32 v116, v116
  v_exp_f32 v117, v117
  v_cvt_pk_bf16_f32 v145, v114, v115
  v_exp_f32 v118, v118
  v_exp_f32 v119, v119
  v_cvt_pk_bf16_f32 v146, v116, v117
  s_setprio 3
  v_mfma_f32_32x32x16_bf16 v[96:111], v[192:195], v[152:155], 0
  buffer_load_dwordx4 v[220:223], v10, s[44:47], s11 offen offset:3072 sc1
  s_setprio 0
  v_exp_f32 v120, v120
  v_exp_f32 v121, v121
  v_cvt_pk_bf16_f32 v147, v118, v119
  v_exp_f32 v122, v122
  v_exp_f32_e64 v123, v123
  v_cvt_pk_bf16_f32 v148, v120, v121
  v_mfma_f32_32x32x16_bf16 v[96:111], v[196:199], v[156:159], v[96:111]
  v_exp_f32 v124, v124
  v_exp_f32 v125, v125
  v_cvt_pk_bf16_f32 v149, v122, v123
  v_exp_f32 v126, v126
  v_exp_f32_e64 v127, v127
  v_cvt_pk_bf16_f32 v150, v124, v125
  v_cvt_pk_bf16_f32 v151, v126, v127
  s_setprio 3
  v_mfma_f32_32x32x16_bf16 v[112:127], v[168:171], v[32:35], 0
  buffer_load_dwordx4 v[160:163], v10, s[44:47], s12 offen offset:0 sc1
  s_setprio 0
  v_exp_f32 v128, v128
  v_exp_f32 v129, v129
  v_exp_f32 v130, v130
  v_exp_f32 v131, v131
  v_cvt_pk_bf16_f32 v152, v128, v129
  v_mfma_f32_32x32x16_bf16 v[112:127], v[172:175], v[36:39], v[112:127]
  s_waitcnt vmcnt(9)
  v_exp_f32 v132, v132
  v_exp_f32 v133, v133
  v_cvt_pk_bf16_f32 v153, v130, v131
  v_exp_f32 v134, v134
  v_exp_f32 v135, v135
  v_cvt_pk_bf16_f32 v154, v132, v133
  s_setprio 3
  v_mfma_f32_32x32x16_bf16 v[48:63], v[200:203], v[144:147], v[48:63]
  buffer_load_dwordx4 v[164:167], v10, s[44:47], s12 offen offset:1024 sc1
  s_setprio 0
  v_exp_f32 v136, v136
  v_exp_f32 v137, v137
  v_cvt_pk_bf16_f32 v155, v134, v135
  v_exp_f32 v138, v138
  v_exp_f32 v139, v139
  v_cvt_pk_bf16_f32 v156, v136, v137
  v_mfma_f32_32x32x16_bf16 v[48:63], v[204:207], v[148:151], v[48:63]
  v_exp_f32 v140, v140
  v_exp_f32 v141, v141
  v_cvt_pk_bf16_f32 v157, v138, v139
  v_exp_f32 v142, v142
  v_exp_f32 v143, v143
  v_cvt_pk_bf16_f32 v158, v140, v141
  v_cvt_pk_bf16_f32 v159, v142, v143
  s_setprio 3
  v_mfma_f32_32x32x16_bf16 v[128:143], v[168:171], v[40:43], 0
  buffer_load_dwordx4 v[192:195], v10, s[44:47], s12 offen offset:2048 sc1
  s_setprio 0
  v_exp_f32 v112, v112
  v_exp_f32 v113, v113
  v_exp_f32 v114, v114
  v_exp_f32 v115, v115
  v_cvt_pk_bf16_f32 v144, v112, v113
  v_mfma_f32_32x32x16_bf16 v[128:143], v[172:175], v[44:47], v[128:143]
  v_exp_f32 v116, v116
  v_exp_f32 v117, v117
  v_cvt_pk_bf16_f32 v145, v114, v115
  v_exp_f32 v118, v118
  v_exp_f32 v119, v119
  v_cvt_pk_bf16_f32 v146, v116, v117
  s_setprio 3
  v_mfma_f32_32x32x16_bf16 v[64:79], v[200:203], v[152:155], v[64:79]
  buffer_load_dwordx4 v[196:199], v10, s[44:47], s12 offen offset:3072 sc1
  s_setprio 0
  v_exp_f32 v120, v120
  v_exp_f32 v121, v121
  v_cvt_pk_bf16_f32 v147, v118, v119
  v_exp_f32 v122, v122
  v_exp_f32 v123, v123
  v_cvt_pk_bf16_f32 v148, v120, v121
  v_mfma_f32_32x32x16_bf16 v[64:79], v[204:207], v[156:159], v[64:79]
  s_waitcnt vmcnt(10)
  v_exp_f32 v124, v124
  v_exp_f32 v125, v125
  v_cvt_pk_bf16_f32 v149, v122, v123
  v_exp_f32 v126, v126
  v_exp_f32_e64 v127, v127
  v_cvt_pk_bf16_f32 v150, v124, v125
  v_cvt_pk_bf16_f32 v151, v126, v127
  s_setprio 3
  v_mfma_f32_32x32x16_bf16 v[112:127], v[176:179], v[16:19], 0
  buffer_load_dwordx4 v[168:171], v10, s[44:47], s13 offen offset:0 sc1
  s_setprio 0
  v_exp_f32 v128, v128
  v_exp_f32 v129, v129
  v_exp_f32 v130, v130
  v_exp_f32 v131, v131
  v_cvt_pk_bf16_f32 v152, v128, v129
  v_mfma_f32_32x32x16_bf16 v[112:127], v[180:183], v[20:23], v[112:127]
  v_exp_f32 v132, v132
  v_exp_f32 v133, v133
  v_cvt_pk_bf16_f32 v153, v130, v131
  v_exp_f32 v134, v134
  v_exp_f32 v135, v135
  v_cvt_pk_bf16_f32 v154, v132, v133
  s_setprio 3
  v_mfma_f32_32x32x16_bf16 v[80:95], v[200:203], v[144:147], v[80:95]
  buffer_load_dwordx4 v[172:175], v10, s[44:47], s13 offen offset:1024 sc1
  s_setprio 0
  v_exp_f32 v136, v136
  v_exp_f32 v137, v137
  v_cvt_pk_bf16_f32 v155, v134, v135
  v_exp_f32 v138, v138
  v_exp_f32 v139, v139
  v_cvt_pk_bf16_f32 v156, v136, v137
  v_mfma_f32_32x32x16_bf16 v[80:95], v[204:207], v[148:151], v[80:95]
  v_exp_f32 v140, v140
  v_exp_f32 v141, v141
  v_cvt_pk_bf16_f32 v157, v138, v139
  v_exp_f32 v142, v142
  v_exp_f32 v143, v143
  v_cvt_pk_bf16_f32 v158, v140, v141
  v_cvt_pk_bf16_f32 v159, v142, v143
  v_mfma_f32_32x32x16_bf16 v[128:143], v[176:179], v[24:27], 0
  v_exp_f32 v112, v112
  v_exp_f32 v113, v113
  v_exp_f32 v114, v114
  v_exp_f32 v115, v115
  v_cvt_pk_bf16_f32 v144, v112, v113
  v_mfma_f32_32x32x16_bf16 v[128:143], v[180:183], v[28:31], v[128:143]
  v_exp_f32 v116, v116
  v_exp_f32 v117, v117
  v_cvt_pk_bf16_f32 v145, v114, v115
  v_exp_f32 v118, v118
  v_exp_f32 v119, v119
  v_cvt_pk_bf16_f32 v146, v116, v117
  v_mfma_f32_32x32x16_bf16 v[96:111], v[200:203], v[152:155], v[96:111]
  v_exp_f32 v120, v120
  v_exp_f32 v121, v121
  v_cvt_pk_bf16_f32 v147, v118, v119
  v_exp_f32 v122, v122
  v_exp_f32 v123, v123
  v_cvt_pk_bf16_f32 v148, v120, v121
  v_mfma_f32_32x32x16_bf16 v[96:111], v[204:207], v[156:159], v[96:111]
  v_exp_f32 v124, v124
  v_exp_f32 v125, v125
  v_cvt_pk_bf16_f32 v149, v122, v123
  v_exp_f32 v126, v126
  v_exp_f32 v127, v127
  v_cvt_pk_bf16_f32 v150, v124, v125
  v_cvt_pk_bf16_f32 v151, v126, v127
  s_setprio 3
  v_mfma_f32_32x32x16_bf16 v[112:127], v[176:179], v[32:35], 0
  buffer_load_dwordx4 v[200:203], v10, s[44:47], s13 offen offset:2048 sc1
  s_setprio 0
  v_exp_f32 v128, v128
  v_exp_f32 v129, v129
  v_exp_f32 v130, v130
  v_exp_f32 v131, v131
  v_cvt_pk_bf16_f32 v152, v128, v129
  v_mfma_f32_32x32x16_bf16 v[112:127], v[180:183], v[36:39], v[112:127]
  s_waitcnt vmcnt(11)
  v_exp_f32 v132, v132
  v_exp_f32 v133, v133
  v_cvt_pk_bf16_f32 v153, v130, v131
  v_exp_f32 v134, v134
  v_exp_f32_e64 v135, v135
  v_cvt_pk_bf16_f32 v154, v132, v133
  s_setprio 3
  v_mfma_f32_32x32x16_bf16 v[48:63], v[208:211], v[144:147], v[48:63]
  buffer_load_dwordx4 v[204:207], v10, s[44:47], s13 offen offset:3072 sc1
  s_setprio 0
  v_exp_f32 v136, v136
  v_exp_f32 v137, v137
  v_cvt_pk_bf16_f32 v155, v134, v135
  v_exp_f32 v138, v138
  v_exp_f32 v139, v139
  v_cvt_pk_bf16_f32 v156, v136, v137
  v_mfma_f32_32x32x16_bf16 v[48:63], v[212:215], v[148:151], v[48:63]
  v_exp_f32 v140, v140
  v_exp_f32 v141, v141
  v_cvt_pk_bf16_f32 v157, v138, v139
  v_exp_f32 v142, v142
  v_exp_f32 v143, v143
  v_cvt_pk_bf16_f32 v158, v140, v141
  v_cvt_pk_bf16_f32 v159, v142, v143
  v_mfma_f32_32x32x16_bf16 v[128:143], v[176:179], v[40:43], 0
  v_exp_f32 v112, v112
  v_exp_f32 v113, v113
  v_exp_f32 v114, v114
  v_exp_f32 v115, v115
  v_cvt_pk_bf16_f32 v144, v112, v113
  v_mfma_f32_32x32x16_bf16 v[128:143], v[180:183], v[44:47], v[128:143]
  v_exp_f32 v116, v116
  v_exp_f32 v117, v117
  v_cvt_pk_bf16_f32 v145, v114, v115
  v_exp_f32 v118, v118
  v_exp_f32 v119, v119
  v_cvt_pk_bf16_f32 v146, v116, v117
  v_mfma_f32_32x32x16_bf16 v[64:79], v[208:211], v[152:155], v[64:79]
  v_exp_f32 v120, v120
  v_exp_f32 v121, v121
  v_cvt_pk_bf16_f32 v147, v118, v119
  v_exp_f32 v122, v122
  v_exp_f32 v123, v123
  v_cvt_pk_bf16_f32 v148, v120, v121
  v_mfma_f32_32x32x16_bf16 v[64:79], v[212:215], v[156:159], v[64:79]
  s_waitcnt vmcnt(10)
  v_exp_f32 v124, v124
  v_exp_f32 v125, v125
  v_cvt_pk_bf16_f32 v149, v122, v123
  v_exp_f32 v126, v126
  v_exp_f32 v127, v127
  v_cvt_pk_bf16_f32 v150, v124, v125
  v_cvt_pk_bf16_f32 v151, v126, v127
  s_setprio 3
  v_mfma_f32_32x32x16_bf16 v[112:127], v[184:187], v[16:19], 0
  buffer_load_dwordx4 v[176:179], v10, s[44:47], s14 offen offset:0 sc1
  s_setprio 0
  v_exp_f32 v128, v128
  v_exp_f32 v129, v129
  v_exp_f32 v130, v130
  v_exp_f32_e64 v131, v131
  v_cvt_pk_bf16_f32 v152, v128, v129
  v_mfma_f32_32x32x16_bf16 v[112:127], v[188:191], v[20:23], v[112:127]
  v_exp_f32 v132, v132
  v_exp_f32 v133, v133
  v_cvt_pk_bf16_f32 v153, v130, v131
  v_exp_f32 v134, v134
  v_exp_f32_e64 v135, v135
  v_cvt_pk_bf16_f32 v154, v132, v133
  s_setprio 3
  v_mfma_f32_32x32x16_bf16 v[80:95], v[208:211], v[144:147], v[80:95]
  buffer_load_dwordx4 v[180:183], v10, s[44:47], s14 offen offset:1024 sc1
  s_setprio 0
  v_exp_f32 v136, v136
  v_exp_f32 v137, v137
  v_cvt_pk_bf16_f32 v155, v134, v135
  v_exp_f32 v138, v138
  v_exp_f32 v139, v139
  v_cvt_pk_bf16_f32 v156, v136, v137
  v_mfma_f32_32x32x16_bf16 v[80:95], v[212:215], v[148:151], v[80:95]
  v_exp_f32 v140, v140
  v_exp_f32_e64 v141, v141
  v_cvt_pk_bf16_f32 v157, v138, v139
  v_exp_f32 v142, v142
  v_exp_f32 v143, v143
  v_cvt_pk_bf16_f32 v158, v140, v141
  v_cvt_pk_bf16_f32 v159, v142, v143
  v_mfma_f32_32x32x16_bf16 v[128:143], v[184:187], v[24:27], 0
  v_exp_f32 v112, v112
  v_exp_f32 v113, v113
  v_exp_f32 v114, v114
  v_exp_f32 v115, v115
  v_cvt_pk_bf16_f32 v144, v112, v113
  v_mfma_f32_32x32x16_bf16 v[128:143], v[188:191], v[28:31], v[128:143]
  v_exp_f32 v116, v116
  v_exp_f32 v117, v117
  v_cvt_pk_bf16_f32 v145, v114, v115
  v_exp_f32 v118, v118
  v_exp_f32 v119, v119
  v_cvt_pk_bf16_f32 v146, v116, v117
  v_mfma_f32_32x32x16_bf16 v[96:111], v[208:211], v[152:155], v[96:111]
  v_exp_f32 v120, v120
  v_exp_f32 v121, v121
  v_cvt_pk_bf16_f32 v147, v118, v119
  v_exp_f32 v122, v122
  v_exp_f32 v123, v123
  v_cvt_pk_bf16_f32 v148, v120, v121
  v_mfma_f32_32x32x16_bf16 v[96:111], v[212:215], v[156:159], v[96:111]
  v_exp_f32 v124, v124
  v_exp_f32 v125, v125
  v_cvt_pk_bf16_f32 v149, v122, v123
  v_exp_f32 v126, v126
  v_exp_f32 v127, v127
  v_cvt_pk_bf16_f32 v150, v124, v125
  v_cvt_pk_bf16_f32 v151, v126, v127
  s_setprio 3
  v_mfma_f32_32x32x16_bf16 v[112:127], v[184:187], v[32:35], 0
  buffer_load_dwordx4 v[208:211], v10, s[44:47], s14 offen offset:2048 sc1
  s_setprio 0
  v_exp_f32 v128, v128
  v_exp_f32 v129, v129
  v_exp_f32 v130, v130
  v_exp_f32 v131, v131
  v_cvt_pk_bf16_f32 v152, v128, v129
  v_mfma_f32_32x32x16_bf16 v[112:127], v[188:191], v[36:39], v[112:127]
  s_waitcnt vmcnt(11)
  v_exp_f32 v132, v132
  v_exp_f32 v133, v133
  v_cvt_pk_bf16_f32 v153, v130, v131
  v_exp_f32 v134, v134
  v_exp_f32 v135, v135
  v_cvt_pk_bf16_f32 v154, v132, v133
  s_setprio 3
  v_mfma_f32_32x32x16_bf16 v[48:63], v[216:219], v[144:147], v[48:63]
  buffer_load_dwordx4 v[212:215], v10, s[44:47], s14 offen offset:3072 sc1
  s_setprio 0
  v_exp_f32 v136, v136
  v_exp_f32_e64 v137, v137
  v_cvt_pk_bf16_f32 v155, v134, v135
  v_exp_f32 v138, v138
  v_exp_f32 v139, v139
  v_cvt_pk_bf16_f32 v156, v136, v137
  v_mfma_f32_32x32x16_bf16 v[48:63], v[220:223], v[148:151], v[48:63]
  v_exp_f32 v140, v140
  v_exp_f32 v141, v141
  v_cvt_pk_bf16_f32 v157, v138, v139
  v_exp_f32 v142, v142
  v_exp_f32 v143, v143
  v_cvt_pk_bf16_f32 v158, v140, v141
  v_cvt_pk_bf16_f32 v159, v142, v143
  v_mfma_f32_32x32x16_bf16 v[128:143], v[184:187], v[40:43], 0
  v_exp_f32 v112, v112
  v_exp_f32 v113, v113
  v_exp_f32 v114, v114
  v_exp_f32 v115, v115
  v_cvt_pk_bf16_f32 v144, v112, v113
  v_mfma_f32_32x32x16_bf16 v[128:143], v[188:191], v[44:47], v[128:143]
  v_exp_f32 v116, v116
  v_exp_f32 v117, v117
  v_cvt_pk_bf16_f32 v145, v114, v115
  v_exp_f32 v118, v118
  v_exp_f32 v119, v119
  v_cvt_pk_bf16_f32 v146, v116, v117
  v_mfma_f32_32x32x16_bf16 v[64:79], v[216:219], v[152:155], v[64:79]
  v_exp_f32 v120, v120
  v_exp_f32 v121, v121
  v_cvt_pk_bf16_f32 v147, v118, v119
  v_exp_f32 v122, v122
  v_exp_f32 v123, v123
  v_cvt_pk_bf16_f32 v148, v120, v121
  v_mfma_f32_32x32x16_bf16 v[64:79], v[220:223], v[156:159], v[64:79]
  s_waitcnt vmcnt(10)
  v_exp_f32 v124, v124
  v_exp_f32 v125, v125
  v_cvt_pk_bf16_f32 v149, v122, v123
  v_exp_f32 v126, v126
  v_exp_f32 v127, v127
  v_cvt_pk_bf16_f32 v150, v124, v125
  v_cvt_pk_bf16_f32 v151, v126, v127
  s_setprio 3
  v_mfma_f32_32x32x16_bf16 v[112:127], v[160:163], v[16:19], 0
  buffer_load_dwordx4 v[184:187], v10, s[44:47], s15 offen offset:0 sc1
  s_setprio 0
  v_exp_f32 v128, v128
  v_exp_f32 v129, v129
  v_exp_f32 v130, v130
  v_exp_f32 v131, v131
  v_cvt_pk_bf16_f32 v152, v128, v129
  v_mfma_f32_32x32x16_bf16 v[112:127], v[164:167], v[20:23], v[112:127]
  v_exp_f32 v132, v132
  v_exp_f32 v133, v133
  v_cvt_pk_bf16_f32 v153, v130, v131
  v_exp_f32 v134, v134
  v_exp_f32_e64 v135, v135
  v_cvt_pk_bf16_f32 v154, v132, v133
  s_setprio 3
  v_mfma_f32_32x32x16_bf16 v[80:95], v[216:219], v[144:147], v[80:95]
  buffer_load_dwordx4 v[188:191], v10, s[44:47], s15 offen offset:1024 sc1
  s_setprio 0
  v_exp_f32 v136, v136
  v_exp_f32 v137, v137
  v_cvt_pk_bf16_f32 v155, v134, v135
  v_exp_f32 v138, v138
  v_exp_f32 v139, v139
  v_cvt_pk_bf16_f32 v156, v136, v137
  v_mfma_f32_32x32x16_bf16 v[80:95], v[220:223], v[148:151], v[80:95]
  v_exp_f32 v140, v140
  v_exp_f32 v141, v141
  v_cvt_pk_bf16_f32 v157, v138, v139
  v_exp_f32 v142, v142
  v_exp_f32 v143, v143
  v_cvt_pk_bf16_f32 v158, v140, v141
  v_cvt_pk_bf16_f32 v159, v142, v143
  v_mfma_f32_32x32x16_bf16 v[128:143], v[160:163], v[24:27], 0
  v_exp_f32 v112, v112
  v_exp_f32 v113, v113
  v_exp_f32 v114, v114
  v_exp_f32 v115, v115
  v_cvt_pk_bf16_f32 v144, v112, v113
  v_mfma_f32_32x32x16_bf16 v[128:143], v[164:167], v[28:31], v[128:143]
  v_exp_f32 v116, v116
  v_exp_f32 v117, v117
  v_cvt_pk_bf16_f32 v145, v114, v115
  v_exp_f32 v118, v118
  v_exp_f32 v119, v119
  v_cvt_pk_bf16_f32 v146, v116, v117
  v_mfma_f32_32x32x16_bf16 v[96:111], v[216:219], v[152:155], v[96:111]
  v_exp_f32 v120, v120
  v_exp_f32 v121, v121
  v_cvt_pk_bf16_f32 v147, v118, v119
  v_exp_f32 v122, v122
  v_exp_f32 v123, v123
  v_cvt_pk_bf16_f32 v148, v120, v121
  v_mfma_f32_32x32x16_bf16 v[96:111], v[220:223], v[156:159], v[96:111]
  v_exp_f32 v124, v124
  v_exp_f32 v125, v125
  v_cvt_pk_bf16_f32 v149, v122, v123
  v_exp_f32 v126, v126
  v_exp_f32 v127, v127
  v_cvt_pk_bf16_f32 v150, v124, v125
  v_cvt_pk_bf16_f32 v151, v126, v127
  s_setprio 3
  v_mfma_f32_32x32x16_bf16 v[112:127], v[160:163], v[32:35], 0
  buffer_load_dwordx4 v[216:219], v10, s[44:47], s15 offen offset:2048 sc1
  s_setprio 0
  v_exp_f32 v128, v128
  v_exp_f32 v129, v129
  v_exp_f32 v130, v130
  v_exp_f32 v131, v131
  v_cvt_pk_bf16_f32 v152, v128, v129
  v_mfma_f32_32x32x16_bf16 v[112:127], v[164:167], v[36:39], v[112:127]
  s_waitcnt vmcnt(11)
  v_exp_f32 v132, v132
  v_exp_f32 v133, v133
  v_cvt_pk_bf16_f32 v153, v130, v131
  v_exp_f32 v134, v134
  v_exp_f32 v135, v135
  v_cvt_pk_bf16_f32 v154, v132, v133
  s_setprio 3
  v_mfma_f32_32x32x16_bf16 v[48:63], v[192:195], v[144:147], v[48:63]
  buffer_load_dwordx4 v[220:223], v10, s[44:47], s15 offen offset:3072 sc1
  s_setprio 0
  v_exp_f32 v136, v136
  v_exp_f32 v137, v137
  v_cvt_pk_bf16_f32 v155, v134, v135
  v_exp_f32 v138, v138
  v_exp_f32 v139, v139
  v_cvt_pk_bf16_f32 v156, v136, v137
  v_mfma_f32_32x32x16_bf16 v[48:63], v[196:199], v[148:151], v[48:63]
  v_exp_f32 v140, v140
  v_exp_f32 v141, v141
  v_cvt_pk_bf16_f32 v157, v138, v139
  v_exp_f32 v142, v142
  v_exp_f32 v143, v143
  v_cvt_pk_bf16_f32 v158, v140, v141
  v_cvt_pk_bf16_f32 v159, v142, v143
  v_mfma_f32_32x32x16_bf16 v[128:143], v[160:163], v[40:43], 0
  v_exp_f32 v112, v112
  v_exp_f32 v113, v113
  v_exp_f32 v114, v114
  v_exp_f32 v115, v115
  v_cvt_pk_bf16_f32 v144, v112, v113
  v_mfma_f32_32x32x16_bf16 v[128:143], v[164:167], v[44:47], v[128:143]
  v_exp_f32 v116, v116
  v_exp_f32 v117, v117
  v_cvt_pk_bf16_f32 v145, v114, v115
  v_exp_f32 v118, v118
  v_exp_f32 v119, v119
  v_cvt_pk_bf16_f32 v146, v116, v117
  v_mfma_f32_32x32x16_bf16 v[64:79], v[192:195], v[152:155], v[64:79]
  v_exp_f32 v120, v120
  v_exp_f32 v121, v121
  v_cvt_pk_bf16_f32 v147, v118, v119
  v_exp_f32 v122, v122
  v_exp_f32_e64 v123, v123
  v_cvt_pk_bf16_f32 v148, v120, v121
  v_mfma_f32_32x32x16_bf16 v[64:79], v[196:199], v[156:159], v[64:79]
  s_waitcnt vmcnt(10)
  v_exp_f32 v124, v124
  v_exp_f32 v125, v125
  v_cvt_pk_bf16_f32 v149, v122, v123
  v_exp_f32 v126, v126
  v_exp_f32 v127, v127
  v_cvt_pk_bf16_f32 v150, v124, v125
  v_cvt_pk_bf16_f32 v151, v126, v127
  s_setprio 3
  v_mfma_f32_32x32x16_bf16 v[112:127], v[168:171], v[16:19], 0
  buffer_load_dwordx4 v[160:163], v10, s[44:47], s16 offen offset:0 sc1
  s_setprio 0
  v_exp_f32 v128, v128
  v_exp_f32 v129, v129
  v_exp_f32 v130, v130
  v_exp_f32 v131, v131
  v_cvt_pk_bf16_f32 v152, v128, v129
  v_mfma_f32_32x32x16_bf16 v[112:127], v[172:175], v[20:23], v[112:127]
  v_exp_f32 v132, v132
  v_exp_f32_e64 v133, v133
  v_cvt_pk_bf16_f32 v153, v130, v131
  v_exp_f32 v134, v134
  v_exp_f32 v135, v135
  v_cvt_pk_bf16_f32 v154, v132, v133
  s_setprio 3
  v_mfma_f32_32x32x16_bf16 v[80:95], v[192:195], v[144:147], v[80:95]
  buffer_load_dwordx4 v[164:167], v10, s[44:47], s16 offen offset:1024 sc1
  s_setprio 0
  v_exp_f32 v136, v136
  v_exp_f32 v137, v137
  v_cvt_pk_bf16_f32 v155, v134, v135
  v_exp_f32 v138, v138
  v_exp_f32 v139, v139
  v_cvt_pk_bf16_f32 v156, v136, v137
  v_mfma_f32_32x32x16_bf16 v[80:95], v[196:199], v[148:151], v[80:95]
  v_exp_f32 v140, v140
  v_exp_f32 v141, v141
  v_cvt_pk_bf16_f32 v157, v138, v139
  v_exp_f32 v142, v142
  v_exp_f32 v143, v143
  v_cvt_pk_bf16_f32 v158, v140, v141
  v_cvt_pk_bf16_f32 v159, v142, v143
  v_mfma_f32_32x32x16_bf16 v[128:143], v[168:171], v[24:27], 0
  v_exp_f32 v112, v112
  v_exp_f32 v113, v113
  v_exp_f32 v114, v114
  v_exp_f32 v115, v115
  v_cvt_pk_bf16_f32 v144, v112, v113
  v_mfma_f32_32x32x16_bf16 v[128:143], v[172:175], v[28:31], v[128:143]
  v_exp_f32 v116, v116
  v_exp_f32 v117, v117
  v_cvt_pk_bf16_f32 v145, v114, v115
  v_exp_f32 v118, v118
  v_exp_f32 v119, v119
  v_cvt_pk_bf16_f32 v146, v116, v117
  v_mfma_f32_32x32x16_bf16 v[96:111], v[192:195], v[152:155], v[96:111]
  v_exp_f32 v120, v120
  v_exp_f32 v121, v121
  v_cvt_pk_bf16_f32 v147, v118, v119
  v_exp_f32 v122, v122
  v_exp_f32 v123, v123
  v_cvt_pk_bf16_f32 v148, v120, v121
  v_mfma_f32_32x32x16_bf16 v[96:111], v[196:199], v[156:159], v[96:111]
  v_exp_f32 v124, v124
  v_exp_f32 v125, v125
  v_cvt_pk_bf16_f32 v149, v122, v123
  v_exp_f32 v126, v126
  v_exp_f32 v127, v127
  v_cvt_pk_bf16_f32 v150, v124, v125
  v_cvt_pk_bf16_f32 v151, v126, v127
  s_setprio 3
  v_mfma_f32_32x32x16_bf16 v[112:127], v[168:171], v[32:35], 0
  buffer_load_dwordx4 v[192:195], v10, s[44:47], s16 offen offset:2048 sc1
  s_setprio 0
  v_exp_f32 v128, v128
  v_exp_f32 v129, v129
  v_exp_f32 v130, v130
  v_exp_f32 v131, v131
  v_cvt_pk_bf16_f32 v152, v128, v129
  v_mfma_f32_32x32x16_bf16 v[112:127], v[172:175], v[36:39], v[112:127]
  s_waitcnt vmcnt(11)
  v_exp_f32 v132, v132
  v_exp_f32 v133, v133
  v_cvt_pk_bf16_f32 v153, v130, v131
  v_exp_f32 v134, v134
  v_exp_f32 v135, v135
  v_cvt_pk_bf16_f32 v154, v132, v133
  s_setprio 3
  v_mfma_f32_32x32x16_bf16 v[48:63], v[200:203], v[144:147], v[48:63]
  buffer_load_dwordx4 v[196:199], v10, s[44:47], s16 offen offset:3072 sc1
  s_setprio 0
  v_exp_f32 v136, v136
  v_exp_f32 v137, v137
  v_cvt_pk_bf16_f32 v155, v134, v135
  v_exp_f32 v138, v138
  v_exp_f32 v139, v139
  v_cvt_pk_bf16_f32 v156, v136, v137
  v_mfma_f32_32x32x16_bf16 v[48:63], v[204:207], v[148:151], v[48:63]
  v_exp_f32 v140, v140
  v_exp_f32 v141, v141
  v_cvt_pk_bf16_f32 v157, v138, v139
  v_exp_f32 v142, v142
  v_exp_f32 v143, v143
  v_cvt_pk_bf16_f32 v158, v140, v141
  v_cvt_pk_bf16_f32 v159, v142, v143
  v_mfma_f32_32x32x16_bf16 v[128:143], v[168:171], v[40:43], 0
  v_exp_f32 v112, v112
  v_exp_f32 v113, v113
  v_exp_f32 v114, v114
  v_exp_f32_e64 v115, v115
  v_cvt_pk_bf16_f32 v144, v112, v113
  v_mfma_f32_32x32x16_bf16 v[128:143], v[172:175], v[44:47], v[128:143]
  v_exp_f32 v116, v116
  v_exp_f32 v117, v117
  v_cvt_pk_bf16_f32 v145, v114, v115
  v_exp_f32 v118, v118
  v_exp_f32 v119, v119
  v_cvt_pk_bf16_f32 v146, v116, v117
  v_mfma_f32_32x32x16_bf16 v[64:79], v[200:203], v[152:155], v[64:79]
  v_exp_f32 v120, v120
  v_exp_f32 v121, v121
  v_cvt_pk_bf16_f32 v147, v118, v119
  v_exp_f32 v122, v122
  v_exp_f32 v123, v123
  v_cvt_pk_bf16_f32 v148, v120, v121
  v_mfma_f32_32x32x16_bf16 v[64:79], v[204:207], v[156:159], v[64:79]
  s_waitcnt vmcnt(10)
  v_exp_f32 v124, v124
  v_exp_f32 v125, v125
  v_cvt_pk_bf16_f32 v149, v122, v123
  v_exp_f32 v126, v126
  v_exp_f32_e64 v127, v127
  v_cvt_pk_bf16_f32 v150, v124, v125
  v_cvt_pk_bf16_f32 v151, v126, v127
  s_setprio 3
  v_mfma_f32_32x32x16_bf16 v[112:127], v[176:179], v[16:19], 0
  buffer_load_dwordx4 v[168:171], v10, s[44:47], s17 offen offset:0 sc1
  s_setprio 0
  v_exp_f32 v128, v128
  v_exp_f32 v129, v129
  v_exp_f32 v130, v130
  v_exp_f32 v131, v131
  v_cvt_pk_bf16_f32 v152, v128, v129
  v_mfma_f32_32x32x16_bf16 v[112:127], v[180:183], v[20:23], v[112:127]
  v_exp_f32 v132, v132
  v_exp_f32 v133, v133
  v_cvt_pk_bf16_f32 v153, v130, v131
  v_exp_f32 v134, v134
  v_exp_f32 v135, v135
  v_cvt_pk_bf16_f32 v154, v132, v133
  s_setprio 3
  v_mfma_f32_32x32x16_bf16 v[80:95], v[200:203], v[144:147], v[80:95]
  buffer_load_dwordx4 v[172:175], v10, s[44:47], s17 offen offset:1024 sc1
  s_setprio 0
  v_exp_f32 v136, v136
  v_exp_f32 v137, v137
  v_cvt_pk_bf16_f32 v155, v134, v135
  v_exp_f32 v138, v138
  v_exp_f32 v139, v139
  v_cvt_pk_bf16_f32 v156, v136, v137
  v_mfma_f32_32x32x16_bf16 v[80:95], v[204:207], v[148:151], v[80:95]
  v_exp_f32 v140, v140
  v_exp_f32 v141, v141
  v_cvt_pk_bf16_f32 v157, v138, v139
  v_exp_f32 v142, v142
  v_exp_f32 v143, v143
  v_cvt_pk_bf16_f32 v158, v140, v141
  v_cvt_pk_bf16_f32 v159, v142, v143
  v_mfma_f32_32x32x16_bf16 v[128:143], v[176:179], v[24:27], 0
  v_exp_f32 v112, v112
  v_exp_f32 v113, v113
  v_exp_f32 v114, v114
  v_exp_f32 v115, v115
  v_cvt_pk_bf16_f32 v144, v112, v113
  v_mfma_f32_32x32x16_bf16 v[128:143], v[180:183], v[28:31], v[128:143]
  v_exp_f32 v116, v116
  v_exp_f32 v117, v117
  v_cvt_pk_bf16_f32 v145, v114, v115
  v_exp_f32 v118, v118
  v_exp_f32 v119, v119
  v_cvt_pk_bf16_f32 v146, v116, v117
  v_mfma_f32_32x32x16_bf16 v[96:111], v[200:203], v[152:155], v[96:111]
  v_exp_f32 v120, v120
  v_exp_f32 v121, v121
  v_cvt_pk_bf16_f32 v147, v118, v119
  v_exp_f32 v122, v122
  v_exp_f32 v123, v123
  v_cvt_pk_bf16_f32 v148, v120, v121
  v_mfma_f32_32x32x16_bf16 v[96:111], v[204:207], v[156:159], v[96:111]
  v_exp_f32 v124, v124
  v_exp_f32 v125, v125
  v_cvt_pk_bf16_f32 v149, v122, v123
  v_exp_f32 v126, v126
  v_exp_f32_e64 v127, v127
  v_cvt_pk_bf16_f32 v150, v124, v125
  v_cvt_pk_bf16_f32 v151, v126, v127
  s_setprio 3
  v_mfma_f32_32x32x16_bf16 v[112:127], v[176:179], v[32:35], 0
  buffer_load_dwordx4 v[200:203], v10, s[44:47], s17 offen offset:2048 sc1
  s_setprio 0
  v_exp_f32 v128, v128
  v_exp_f32 v129, v129
  v_exp_f32 v130, v130
  v_exp_f32 v131, v131
  v_cvt_pk_bf16_f32 v152, v128, v129
  v_mfma_f32_32x32x16_bf16 v[112:127], v[180:183], v[36:39], v[112:127]
  s_waitcnt vmcnt(11)
  v_exp_f32 v132, v132
  v_exp_f32 v133, v133
  v_cvt_pk_bf16_f32 v153, v130, v131
  v_exp_f32 v134, v134
  v_exp_f32 v135, v135
  v_cvt_pk_bf16_f32 v154, v132, v133
  s_setprio 3
  v_mfma_f32_32x32x16_bf16 v[48:63], v[208:211], v[144:147], v[48:63]
  buffer_load_dwordx4 v[204:207], v10, s[44:47], s17 offen offset:3072 sc1
  s_setprio 0
  v_exp_f32 v136, v136
  v_exp_f32 v137, v137
  v_cvt_pk_bf16_f32 v155, v134, v135
  v_exp_f32 v138, v138
  v_exp_f32 v139, v139
  v_cvt_pk_bf16_f32 v156, v136, v137
  v_mfma_f32_32x32x16_bf16 v[48:63], v[212:215], v[148:151], v[48:63]
  v_exp_f32 v140, v140
  v_exp_f32 v141, v141
  v_cvt_pk_bf16_f32 v157, v138, v139
  v_exp_f32 v142, v142
  v_exp_f32 v143, v143
  v_cvt_pk_bf16_f32 v158, v140, v141
  v_cvt_pk_bf16_f32 v159, v142, v143
  v_mfma_f32_32x32x16_bf16 v[128:143], v[176:179], v[40:43], 0
  v_exp_f32 v112, v112
  v_exp_f32 v113, v113
  v_exp_f32 v114, v114
  v_exp_f32 v115, v115
  v_cvt_pk_bf16_f32 v144, v112, v113
  v_mfma_f32_32x32x16_bf16 v[128:143], v[180:183], v[44:47], v[128:143]
  v_exp_f32 v116, v116
  v_exp_f32 v117, v117
  v_cvt_pk_bf16_f32 v145, v114, v115
  v_exp_f32 v118, v118
  v_exp_f32 v119, v119
  v_cvt_pk_bf16_f32 v146, v116, v117
  v_mfma_f32_32x32x16_bf16 v[64:79], v[208:211], v[152:155], v[64:79]
  v_exp_f32 v120, v120
  v_exp_f32 v121, v121
  v_cvt_pk_bf16_f32 v147, v118, v119
  v_exp_f32 v122, v122
  v_exp_f32 v123, v123
  v_cvt_pk_bf16_f32 v148, v120, v121
  v_mfma_f32_32x32x16_bf16 v[64:79], v[212:215], v[156:159], v[64:79]
  s_waitcnt vmcnt(10)
  v_exp_f32 v124, v124
  v_exp_f32_e64 v125, v125
  v_cvt_pk_bf16_f32 v149, v122, v123
  v_exp_f32 v126, v126
  v_exp_f32 v127, v127
  v_cvt_pk_bf16_f32 v150, v124, v125
  v_cvt_pk_bf16_f32 v151, v126, v127
  s_setprio 3
  v_mfma_f32_32x32x16_bf16 v[112:127], v[184:187], v[16:19], 0
  buffer_load_dwordx4 v[176:179], v10, s[44:47], s18 offen offset:0 sc1
  s_setprio 0
  v_exp_f32 v128, v128
  v_exp_f32 v129, v129
  v_exp_f32 v130, v130
  v_exp_f32 v131, v131
  v_cvt_pk_bf16_f32 v152, v128, v129
  v_mfma_f32_32x32x16_bf16 v[112:127], v[188:191], v[20:23], v[112:127]
  v_exp_f32 v132, v132
  v_exp_f32 v133, v133
  v_cvt_pk_bf16_f32 v153, v130, v131
  v_exp_f32 v134, v134
  v_exp_f32_e64 v135, v135
  v_cvt_pk_bf16_f32 v154, v132, v133
  s_setprio 3
  v_mfma_f32_32x32x16_bf16 v[80:95], v[208:211], v[144:147], v[80:95]
  buffer_load_dwordx4 v[180:183], v10, s[44:47], s18 offen offset:1024 sc1
  s_setprio 0
  v_exp_f32 v136, v136
  v_exp_f32 v137, v137
  v_cvt_pk_bf16_f32 v155, v134, v135
  v_exp_f32 v138, v138
  v_exp_f32 v139, v139
  v_cvt_pk_bf16_f32 v156, v136, v137
  v_mfma_f32_32x32x16_bf16 v[80:95], v[212:215], v[148:151], v[80:95]
  v_exp_f32 v140, v140
  v_exp_f32 v141, v141
  v_cvt_pk_bf16_f32 v157, v138, v139
  v_exp_f32 v142, v142
  v_exp_f32 v143, v143
  v_cvt_pk_bf16_f32 v158, v140, v141
  v_cvt_pk_bf16_f32 v159, v142, v143
  v_mfma_f32_32x32x16_bf16 v[128:143], v[184:187], v[24:27], 0
  v_exp_f32 v112, v112
  v_exp_f32 v113, v113
  v_exp_f32 v114, v114
  v_exp_f32_e64 v115, v115
  v_cvt_pk_bf16_f32 v144, v112, v113
  v_mfma_f32_32x32x16_bf16 v[128:143], v[188:191], v[28:31], v[128:143]
  v_exp_f32 v116, v116
  v_exp_f32 v117, v117
  v_cvt_pk_bf16_f32 v145, v114, v115
  v_exp_f32 v118, v118
  v_exp_f32 v119, v119
  v_cvt_pk_bf16_f32 v146, v116, v117
  v_mfma_f32_32x32x16_bf16 v[96:111], v[208:211], v[152:155], v[96:111]
  v_exp_f32 v120, v120
  v_exp_f32 v121, v121
  v_cvt_pk_bf16_f32 v147, v118, v119
  v_exp_f32 v122, v122
  v_exp_f32 v123, v123
  v_cvt_pk_bf16_f32 v148, v120, v121
  v_mfma_f32_32x32x16_bf16 v[96:111], v[212:215], v[156:159], v[96:111]
  v_exp_f32 v124, v124
  v_exp_f32 v125, v125
  v_cvt_pk_bf16_f32 v149, v122, v123
  v_exp_f32 v126, v126
  v_exp_f32 v127, v127
  v_cvt_pk_bf16_f32 v150, v124, v125
  v_cvt_pk_bf16_f32 v151, v126, v127
  s_setprio 3
  v_mfma_f32_32x32x16_bf16 v[112:127], v[184:187], v[32:35], 0
  buffer_load_dwordx4 v[208:211], v10, s[44:47], s18 offen offset:2048 sc1
  s_setprio 0
  v_exp_f32 v128, v128
  v_exp_f32 v129, v129
  v_exp_f32 v130, v130
  v_exp_f32 v131, v131
  v_cvt_pk_bf16_f32 v152, v128, v129
  v_mfma_f32_32x32x16_bf16 v[112:127], v[188:191], v[36:39], v[112:127]
  s_waitcnt vmcnt(11)
  v_exp_f32 v132, v132
  v_exp_f32 v133, v133
  v_cvt_pk_bf16_f32 v153, v130, v131
  v_exp_f32 v134, v134
  v_exp_f32 v135, v135
  v_cvt_pk_bf16_f32 v154, v132, v133
  s_setprio 3
  v_mfma_f32_32x32x16_bf16 v[48:63], v[216:219], v[144:147], v[48:63]
  buffer_load_dwordx4 v[212:215], v10, s[44:47], s18 offen offset:3072 sc1
  s_setprio 0
  v_exp_f32 v136, v136
  v_exp_f32 v137, v137
  v_cvt_pk_bf16_f32 v155, v134, v135
  v_exp_f32 v138, v138
  v_exp_f32 v139, v139
  v_cvt_pk_bf16_f32 v156, v136, v137
  v_mfma_f32_32x32x16_bf16 v[48:63], v[220:223], v[148:151], v[48:63]
  v_exp_f32 v140, v140
  v_exp_f32 v141, v141
  v_cvt_pk_bf16_f32 v157, v138, v139
  v_exp_f32 v142, v142
  v_exp_f32_e64 v143, v143
  v_cvt_pk_bf16_f32 v158, v140, v141
  v_cvt_pk_bf16_f32 v159, v142, v143
  v_mfma_f32_32x32x16_bf16 v[128:143], v[184:187], v[40:43], 0
  v_exp_f32 v112, v112
  v_exp_f32 v113, v113
  v_exp_f32 v114, v114
  v_exp_f32 v115, v115
  v_cvt_pk_bf16_f32 v144, v112, v113
  v_mfma_f32_32x32x16_bf16 v[128:143], v[188:191], v[44:47], v[128:143]
  v_exp_f32 v116, v116
  v_exp_f32 v117, v117
  v_cvt_pk_bf16_f32 v145, v114, v115
  v_exp_f32 v118, v118
  v_exp_f32 v119, v119
  v_cvt_pk_bf16_f32 v146, v116, v117
  v_mfma_f32_32x32x16_bf16 v[64:79], v[216:219], v[152:155], v[64:79]
  v_exp_f32 v120, v120
  v_exp_f32 v121, v121
  v_cvt_pk_bf16_f32 v147, v118, v119
  v_exp_f32 v122, v122
  v_exp_f32 v123, v123
  v_cvt_pk_bf16_f32 v148, v120, v121
  v_mfma_f32_32x32x16_bf16 v[64:79], v[220:223], v[156:159], v[64:79]
  s_waitcnt vmcnt(10)
  v_exp_f32 v124, v124
  v_exp_f32 v125, v125
  v_cvt_pk_bf16_f32 v149, v122, v123
  v_exp_f32 v126, v126
  v_exp_f32 v127, v127
  v_cvt_pk_bf16_f32 v150, v124, v125
  v_cvt_pk_bf16_f32 v151, v126, v127
  s_setprio 3
  v_mfma_f32_32x32x16_bf16 v[112:127], v[160:163], v[16:19], 0
  buffer_load_dwordx4 v[184:187], v10, s[44:47], s19 offen offset:0 sc1
  s_setprio 0
  v_exp_f32 v128, v128
  v_exp_f32 v129, v129
  v_exp_f32 v130, v130
  v_exp_f32 v131, v131
  v_cvt_pk_bf16_f32 v152, v128, v129
  v_mfma_f32_32x32x16_bf16 v[112:127], v[164:167], v[20:23], v[112:127]
  v_exp_f32 v132, v132
  v_exp_f32 v133, v133
  v_cvt_pk_bf16_f32 v153, v130, v131
  v_exp_f32 v134, v134
  v_exp_f32 v135, v135
  v_cvt_pk_bf16_f32 v154, v132, v133
  s_setprio 3
  v_mfma_f32_32x32x16_bf16 v[80:95], v[216:219], v[144:147], v[80:95]
  buffer_load_dwordx4 v[188:191], v10, s[44:47], s19 offen offset:1024 sc1
  s_setprio 0
  v_exp_f32 v136, v136
  v_exp_f32 v137, v137
  v_cvt_pk_bf16_f32 v155, v134, v135
  v_exp_f32 v138, v138
  v_exp_f32_e64 v139, v139
  v_cvt_pk_bf16_f32 v156, v136, v137
  v_mfma_f32_32x32x16_bf16 v[80:95], v[220:223], v[148:151], v[80:95]
  v_exp_f32 v140, v140
  v_exp_f32 v141, v141
  v_cvt_pk_bf16_f32 v157, v138, v139
  v_exp_f32 v142, v142
  v_exp_f32 v143, v143
  v_cvt_pk_bf16_f32 v158, v140, v141
  v_cvt_pk_bf16_f32 v159, v142, v143
  v_mfma_f32_32x32x16_bf16 v[128:143], v[160:163], v[24:27], 0
  v_exp_f32 v112, v112
  v_exp_f32 v113, v113
  v_exp_f32 v114, v114
  v_exp_f32 v115, v115
  v_cvt_pk_bf16_f32 v144, v112, v113
  v_mfma_f32_32x32x16_bf16 v[128:143], v[164:167], v[28:31], v[128:143]
  v_exp_f32 v116, v116
  v_exp_f32 v117, v117
  v_cvt_pk_bf16_f32 v145, v114, v115
  v_exp_f32 v118, v118
  v_exp_f32 v119, v119
  v_cvt_pk_bf16_f32 v146, v116, v117
  v_mfma_f32_32x32x16_bf16 v[96:111], v[216:219], v[152:155], v[96:111]
  v_exp_f32 v120, v120
  v_exp_f32 v121, v121
  v_cvt_pk_bf16_f32 v147, v118, v119
  v_exp_f32 v122, v122
  v_exp_f32 v123, v123
  v_cvt_pk_bf16_f32 v148, v120, v121
  v_mfma_f32_32x32x16_bf16 v[96:111], v[220:223], v[156:159], v[96:111]
  v_exp_f32 v124, v124
  v_exp_f32 v125, v125
  v_cvt_pk_bf16_f32 v149, v122, v123
  v_exp_f32 v126, v126
  v_exp_f32 v127, v127
  v_cvt_pk_bf16_f32 v150, v124, v125
  v_cvt_pk_bf16_f32 v151, v126, v127
  s_setprio 3
  v_mfma_f32_32x32x16_bf16 v[112:127], v[160:163], v[32:35], 0
  buffer_load_dwordx4 v[216:219], v10, s[44:47], s19 offen offset:2048 sc1
  s_setprio 0
  v_exp_f32 v128, v128
  v_exp_f32 v129, v129
  v_exp_f32 v130, v130
  v_exp_f32 v131, v131
  v_cvt_pk_bf16_f32 v152, v128, v129
  v_mfma_f32_32x32x16_bf16 v[112:127], v[164:167], v[36:39], v[112:127]
  s_waitcnt vmcnt(11)
  v_exp_f32 v132, v132
  v_exp_f32 v133, v133
  v_cvt_pk_bf16_f32 v153, v130, v131
  v_exp_f32 v134, v134
  v_exp_f32 v135, v135
  v_cvt_pk_bf16_f32 v154, v132, v133
  s_setprio 3
  v_mfma_f32_32x32x16_bf16 v[48:63], v[192:195], v[144:147], v[48:63]
  buffer_load_dwordx4 v[220:223], v10, s[44:47], s19 offen offset:3072 sc1
  s_setprio 0
  v_exp_f32 v136, v136
  v_exp_f32 v137, v137
  v_cvt_pk_bf16_f32 v155, v134, v135
  v_exp_f32 v138, v138
  v_exp_f32 v139, v139
  v_cvt_pk_bf16_f32 v156, v136, v137
  v_mfma_f32_32x32x16_bf16 v[48:63], v[196:199], v[148:151], v[48:63]
  v_exp_f32 v140, v140
  v_exp_f32_e64 v141, v141
  v_cvt_pk_bf16_f32 v157, v138, v139
  v_exp_f32 v142, v142
  v_exp_f32 v143, v143
  v_cvt_pk_bf16_f32 v158, v140, v141
  v_cvt_pk_bf16_f32 v159, v142, v143
  v_mfma_f32_32x32x16_bf16 v[128:143], v[160:163], v[40:43], 0
  v_exp_f32 v112, v112
  v_exp_f32 v113, v113
  v_exp_f32 v114, v114
  v_exp_f32 v115, v115
  v_cvt_pk_bf16_f32 v144, v112, v113
  v_mfma_f32_32x32x16_bf16 v[128:143], v[164:167], v[44:47], v[128:143]
  v_exp_f32 v116, v116
  v_exp_f32 v117, v117
  v_cvt_pk_bf16_f32 v145, v114, v115
  v_exp_f32 v118, v118
  v_exp_f32 v119, v119
  v_cvt_pk_bf16_f32 v146, v116, v117
  v_mfma_f32_32x32x16_bf16 v[64:79], v[192:195], v[152:155], v[64:79]
  v_exp_f32 v120, v120
  v_exp_f32 v121, v121
  v_cvt_pk_bf16_f32 v147, v118, v119
  v_exp_f32 v122, v122
  v_exp_f32 v123, v123
  v_cvt_pk_bf16_f32 v148, v120, v121
  v_mfma_f32_32x32x16_bf16 v[64:79], v[196:199], v[156:159], v[64:79]
  s_waitcnt vmcnt(10)
  v_exp_f32 v124, v124
  v_exp_f32 v125, v125
  v_cvt_pk_bf16_f32 v149, v122, v123
  v_exp_f32 v126, v126
  v_exp_f32_e64 v127, v127
  v_cvt_pk_bf16_f32 v150, v124, v125
  v_cvt_pk_bf16_f32 v151, v126, v127
  s_setprio 3
  v_mfma_f32_32x32x16_bf16 v[112:127], v[168:171], v[16:19], 0
  buffer_load_dwordx4 v[160:163], v10, s[44:47], s20 offen offset:0 sc1
  s_setprio 0
  v_exp_f32 v128, v128
  v_exp_f32 v129, v129
  v_exp_f32 v130, v130
  v_exp_f32 v131, v131
  v_cvt_pk_bf16_f32 v152, v128, v129
  v_mfma_f32_32x32x16_bf16 v[112:127], v[172:175], v[20:23], v[112:127]
  v_exp_f32 v132, v132
  v_exp_f32 v133, v133
  v_cvt_pk_bf16_f32 v153, v130, v131
  v_exp_f32 v134, v134
  v_exp_f32 v135, v135
  v_cvt_pk_bf16_f32 v154, v132, v133
  s_setprio 3
  v_mfma_f32_32x32x16_bf16 v[80:95], v[192:195], v[144:147], v[80:95]
  buffer_load_dwordx4 v[164:167], v10, s[44:47], s20 offen offset:1024 sc1
  s_setprio 0
  v_exp_f32 v136, v136
  v_exp_f32 v137, v137
  v_cvt_pk_bf16_f32 v155, v134, v135
  v_exp_f32 v138, v138
  v_exp_f32 v139, v139
  v_cvt_pk_bf16_f32 v156, v136, v137
  v_mfma_f32_32x32x16_bf16 v[80:95], v[196:199], v[148:151], v[80:95]
  v_exp_f32 v140, v140
  v_exp_f32 v141, v141
  v_cvt_pk_bf16_f32 v157, v138, v139
  v_exp_f32 v142, v142
  v_exp_f32 v143, v143
  v_cvt_pk_bf16_f32 v158, v140, v141
  v_cvt_pk_bf16_f32 v159, v142, v143
  v_mfma_f32_32x32x16_bf16 v[128:143], v[168:171], v[24:27], 0
  v_exp_f32 v112, v112
  v_exp_f32 v113, v113
  v_exp_f32 v114, v114
  v_exp_f32 v115, v115
  v_cvt_pk_bf16_f32 v144, v112, v113
  v_mfma_f32_32x32x16_bf16 v[128:143], v[172:175], v[28:31], v[128:143]
  v_exp_f32 v116, v116
  v_exp_f32 v117, v117
  v_cvt_pk_bf16_f32 v145, v114, v115
  v_exp_f32 v118, v118
  v_exp_f32 v119, v119
  v_cvt_pk_bf16_f32 v146, v116, v117
  v_mfma_f32_32x32x16_bf16 v[96:111], v[192:195], v[152:155], v[96:111]
  v_exp_f32 v120, v120
  v_exp_f32 v121, v121
  v_cvt_pk_bf16_f32 v147, v118, v119
  v_exp_f32 v122, v122
  v_exp_f32 v123, v123
  v_cvt_pk_bf16_f32 v148, v120, v121
  v_mfma_f32_32x32x16_bf16 v[96:111], v[196:199], v[156:159], v[96:111]
  v_exp_f32 v124, v124
  v_exp_f32 v125, v125
  v_cvt_pk_bf16_f32 v149, v122, v123
  v_exp_f32 v126, v126
  v_exp_f32 v127, v127
  v_cvt_pk_bf16_f32 v150, v124, v125
  v_cvt_pk_bf16_f32 v151, v126, v127
  v_mfma_f32_32x32x16_bf16 v[112:127], v[168:171], v[32:35], 0
  v_exp_f32 v128, v128
  v_exp_f32 v129, v129
  v_exp_f32 v130, v130
  v_exp_f32 v131, v131
  v_cvt_pk_bf16_f32 v152, v128, v129
  v_mfma_f32_32x32x16_bf16 v[112:127], v[172:175], v[36:39], v[112:127]
  s_waitcnt vmcnt(10)
  v_exp_f32 v132, v132
  v_exp_f32 v133, v133
  v_cvt_pk_bf16_f32 v153, v130, v131
  v_exp_f32 v134, v134
  v_exp_f32 v135, v135
  v_cvt_pk_bf16_f32 v154, v132, v133
  v_mfma_f32_32x32x16_bf16 v[48:63], v[200:203], v[144:147], v[48:63]
  v_exp_f32 v136, v136
  v_exp_f32 v137, v137
  v_cvt_pk_bf16_f32 v155, v134, v135
  v_exp_f32 v138, v138
  v_exp_f32 v139, v139
  v_cvt_pk_bf16_f32 v156, v136, v137
  v_mfma_f32_32x32x16_bf16 v[48:63], v[204:207], v[148:151], v[48:63]
  v_exp_f32 v140, v140
  v_exp_f32 v141, v141
  v_cvt_pk_bf16_f32 v157, v138, v139
  v_exp_f32 v142, v142
  v_exp_f32_e64 v143, v143
  v_cvt_pk_bf16_f32 v158, v140, v141
  v_cvt_pk_bf16_f32 v159, v142, v143
  v_mfma_f32_32x32x16_bf16 v[128:143], v[168:171], v[40:43], 0
  v_exp_f32 v112, v112
  v_exp_f32 v113, v113
  v_exp_f32 v114, v114
  v_exp_f32 v115, v115
  v_cvt_pk_bf16_f32 v144, v112, v113
  v_mfma_f32_32x32x16_bf16 v[128:143], v[172:175], v[44:47], v[128:143]
  v_exp_f32 v116, v116
  v_exp_f32 v117, v117
  v_cvt_pk_bf16_f32 v145, v114, v115
  v_exp_f32 v118, v118
  v_exp_f32 v119, v119
  v_cvt_pk_bf16_f32 v146, v116, v117
  v_mfma_f32_32x32x16_bf16 v[64:79], v[200:203], v[152:155], v[64:79]
  v_exp_f32 v120, v120
  v_exp_f32 v121, v121
  v_cvt_pk_bf16_f32 v147, v118, v119
  v_exp_f32 v122, v122
  v_exp_f32 v123, v123
  v_cvt_pk_bf16_f32 v148, v120, v121
  v_mfma_f32_32x32x16_bf16 v[64:79], v[204:207], v[156:159], v[64:79]
  s_waitcnt vmcnt(8)
  v_exp_f32 v124, v124
  v_exp_f32 v125, v125
  v_cvt_pk_bf16_f32 v149, v122, v123
  v_exp_f32 v126, v126
  v_exp_f32 v127, v127
  v_cvt_pk_bf16_f32 v150, v124, v125
  v_cvt_pk_bf16_f32 v151, v126, v127
  s_setprio 3
  v_mfma_f32_32x32x16_bf16 v[112:127], v[176:179], v[16:19], 0
  buffer_load_dwordx4 v[168:171], v10, s[44:47], s21 offen offset:0 sc1
  s_setprio 0
  v_exp_f32 v128, v128
  v_exp_f32 v129, v129
  v_exp_f32 v130, v130
  v_exp_f32 v131, v131
  v_cvt_pk_bf16_f32 v152, v128, v129
  v_mfma_f32_32x32x16_bf16 v[112:127], v[180:183], v[20:23], v[112:127]
  v_exp_f32 v132, v132
  v_exp_f32 v133, v133
  v_cvt_pk_bf16_f32 v153, v130, v131
  v_exp_f32 v134, v134
  v_exp_f32 v135, v135
  v_cvt_pk_bf16_f32 v154, v132, v133
  s_setprio 3
  v_mfma_f32_32x32x16_bf16 v[80:95], v[200:203], v[144:147], v[80:95]
  buffer_load_dwordx4 v[172:175], v10, s[44:47], s21 offen offset:1024 sc1
  s_setprio 0
  v_exp_f32 v136, v136
  v_exp_f32 v137, v137
  v_cvt_pk_bf16_f32 v155, v134, v135
  v_exp_f32 v138, v138
  v_exp_f32_e64 v139, v139
  v_cvt_pk_bf16_f32 v156, v136, v137
  v_mfma_f32_32x32x16_bf16 v[80:95], v[204:207], v[148:151], v[80:95]
  v_exp_f32 v140, v140
  v_exp_f32 v141, v141
  v_cvt_pk_bf16_f32 v157, v138, v139
  v_exp_f32 v142, v142
  v_exp_f32_e64 v143, v143
  v_cvt_pk_bf16_f32 v158, v140, v141
  v_cvt_pk_bf16_f32 v159, v142, v143
  s_setprio 3
  v_mfma_f32_32x32x16_bf16 v[128:143], v[176:179], v[24:27], 0
  buffer_load_dwordx4 v[192:195], v10, s[44:47], s20 offen offset:2048 sc1
  s_setprio 0
  v_exp_f32 v112, v112
  v_exp_f32 v113, v113
  v_exp_f32 v114, v114
  v_exp_f32 v115, v115
  v_cvt_pk_bf16_f32 v144, v112, v113
  v_mfma_f32_32x32x16_bf16 v[128:143], v[180:183], v[28:31], v[128:143]
  v_exp_f32 v116, v116
  v_exp_f32_e64 v117, v117
  v_cvt_pk_bf16_f32 v145, v114, v115
  v_exp_f32 v118, v118
  v_exp_f32 v119, v119
  v_cvt_pk_bf16_f32 v146, v116, v117
  s_setprio 3
  v_mfma_f32_32x32x16_bf16 v[96:111], v[200:203], v[152:155], v[96:111]
  buffer_load_dwordx4 v[196:199], v10, s[44:47], s20 offen offset:3072 sc1
  s_setprio 0
  v_exp_f32 v120, v120
  v_exp_f32 v121, v121
  v_cvt_pk_bf16_f32 v147, v118, v119
  v_exp_f32 v122, v122
  v_exp_f32 v123, v123
  v_cvt_pk_bf16_f32 v148, v120, v121
  v_mfma_f32_32x32x16_bf16 v[96:111], v[204:207], v[156:159], v[96:111]
  v_exp_f32 v124, v124
  v_exp_f32 v125, v125
  v_cvt_pk_bf16_f32 v149, v122, v123
  v_exp_f32 v126, v126
  v_exp_f32 v127, v127
  v_cvt_pk_bf16_f32 v150, v124, v125
  v_cvt_pk_bf16_f32 v151, v126, v127
  v_mfma_f32_32x32x16_bf16 v[112:127], v[176:179], v[32:35], 0
  v_exp_f32 v128, v128
  v_exp_f32 v129, v129
  v_exp_f32 v130, v130
  v_exp_f32 v131, v131
  v_cvt_pk_bf16_f32 v152, v128, v129
  v_mfma_f32_32x32x16_bf16 v[112:127], v[180:183], v[36:39], v[112:127]
  s_waitcnt vmcnt(10)
  v_exp_f32 v132, v132
  v_exp_f32 v133, v133
  v_cvt_pk_bf16_f32 v153, v130, v131
  v_exp_f32 v134, v134
  v_exp_f32 v135, v135
  v_cvt_pk_bf16_f32 v154, v132, v133
  v_mfma_f32_32x32x16_bf16 v[48:63], v[208:211], v[144:147], v[48:63]
  v_exp_f32 v136, v136
  v_exp_f32 v137, v137
  v_cvt_pk_bf16_f32 v155, v134, v135
  v_exp_f32 v138, v138
  v_exp_f32 v139, v139
  v_cvt_pk_bf16_f32 v156, v136, v137
  v_mfma_f32_32x32x16_bf16 v[48:63], v[212:215], v[148:151], v[48:63]
  v_exp_f32 v140, v140
  v_exp_f32 v141, v141
  v_cvt_pk_bf16_f32 v157, v138, v139
  v_exp_f32 v142, v142
  v_exp_f32 v143, v143
  v_cvt_pk_bf16_f32 v158, v140, v141
  v_cvt_pk_bf16_f32 v159, v142, v143
  v_mfma_f32_32x32x16_bf16 v[128:143], v[176:179], v[40:43], 0
  v_exp_f32 v112, v112
  v_exp_f32 v113, v113
  v_exp_f32 v114, v114
  v_exp_f32_e64 v115, v115
  v_cvt_pk_bf16_f32 v144, v112, v113
  v_mfma_f32_32x32x16_bf16 v[128:143], v[180:183], v[44:47], v[128:143]
  v_exp_f32 v116, v116
  v_exp_f32 v117, v117
  v_cvt_pk_bf16_f32 v145, v114, v115
  v_exp_f32 v118, v118
  v_exp_f32 v119, v119
  v_cvt_pk_bf16_f32 v146, v116, v117
  v_mfma_f32_32x32x16_bf16 v[64:79], v[208:211], v[152:155], v[64:79]
  v_exp_f32 v120, v120
  v_exp_f32 v121, v121
  v_cvt_pk_bf16_f32 v147, v118, v119
  v_exp_f32 v122, v122
  v_exp_f32 v123, v123
  v_cvt_pk_bf16_f32 v148, v120, v121
  v_mfma_f32_32x32x16_bf16 v[64:79], v[212:215], v[156:159], v[64:79]
  s_waitcnt vmcnt(8)
  v_exp_f32 v124, v124
  v_exp_f32 v125, v125
  v_cvt_pk_bf16_f32 v149, v122, v123
  v_exp_f32 v126, v126
  v_exp_f32_e64 v127, v127
  v_cvt_pk_bf16_f32 v150, v124, v125
  v_cvt_pk_bf16_f32 v151, v126, v127
  s_setprio 3
  v_mfma_f32_32x32x16_bf16 v[112:127], v[184:187], v[16:19], 0
  buffer_load_dwordx4 v[176:179], v10, s[44:47], s22 offen offset:0 sc1
  s_setprio 0
  v_exp_f32 v128, v128
  v_exp_f32 v129, v129
  v_exp_f32 v130, v130
  v_exp_f32 v131, v131
  v_cvt_pk_bf16_f32 v152, v128, v129
  v_mfma_f32_32x32x16_bf16 v[112:127], v[188:191], v[20:23], v[112:127]
  v_exp_f32 v132, v132
  v_exp_f32 v133, v133
  v_cvt_pk_bf16_f32 v153, v130, v131
  v_exp_f32 v134, v134
  v_exp_f32 v135, v135
  v_cvt_pk_bf16_f32 v154, v132, v133
  s_setprio 3
  v_mfma_f32_32x32x16_bf16 v[80:95], v[208:211], v[144:147], v[80:95]
  buffer_load_dwordx4 v[180:183], v10, s[44:47], s22 offen offset:1024 sc1
  s_setprio 0
  v_exp_f32 v136, v136
  v_exp_f32 v137, v137
  v_cvt_pk_bf16_f32 v155, v134, v135
  v_exp_f32 v138, v138
  v_exp_f32 v139, v139
  v_cvt_pk_bf16_f32 v156, v136, v137
  v_mfma_f32_32x32x16_bf16 v[80:95], v[212:215], v[148:151], v[80:95]
  v_exp_f32 v140, v140
  v_exp_f32 v141, v141
  v_cvt_pk_bf16_f32 v157, v138, v139
  v_exp_f32 v142, v142
  v_exp_f32 v143, v143
  v_cvt_pk_bf16_f32 v158, v140, v141
  v_cvt_pk_bf16_f32 v159, v142, v143
  s_setprio 3
  v_mfma_f32_32x32x16_bf16 v[128:143], v[184:187], v[24:27], 0
  buffer_load_dwordx4 v[200:203], v10, s[44:47], s21 offen offset:2048 sc1
  s_setprio 0
  v_exp_f32 v112, v112
  v_exp_f32 v113, v113
  v_exp_f32 v114, v114
  v_exp_f32 v115, v115
  v_cvt_pk_bf16_f32 v144, v112, v113
  v_mfma_f32_32x32x16_bf16 v[128:143], v[188:191], v[28:31], v[128:143]
  v_exp_f32 v116, v116
  v_exp_f32 v117, v117
  v_cvt_pk_bf16_f32 v145, v114, v115
  v_exp_f32 v118, v118
  v_exp_f32 v119, v119
  v_cvt_pk_bf16_f32 v146, v116, v117
  s_setprio 3
  v_mfma_f32_32x32x16_bf16 v[96:111], v[208:211], v[152:155], v[96:111]
  buffer_load_dwordx4 v[204:207], v10, s[44:47], s21 offen offset:3072 sc1
  s_setprio 0
  v_exp_f32 v120, v120
  v_exp_f32 v121, v121
  v_cvt_pk_bf16_f32 v147, v118, v119
  v_exp_f32 v122, v122
  v_exp_f32 v123, v123
  v_cvt_pk_bf16_f32 v148, v120, v121
  v_mfma_f32_32x32x16_bf16 v[96:111], v[212:215], v[156:159], v[96:111]
  v_exp_f32 v124, v124
  v_exp_f32 v125, v125
  v_cvt_pk_bf16_f32 v149, v122, v123
  v_exp_f32 v126, v126
  v_exp_f32 v127, v127
  v_cvt_pk_bf16_f32 v150, v124, v125
  v_cvt_pk_bf16_f32 v151, v126, v127
  v_mfma_f32_32x32x16_bf16 v[112:127], v[184:187], v[32:35], 0
  v_exp_f32 v128, v128
  v_exp_f32 v129, v129
  v_exp_f32 v130, v130
  v_exp_f32 v131, v131
  v_cvt_pk_bf16_f32 v152, v128, v129
  v_mfma_f32_32x32x16_bf16 v[112:127], v[188:191], v[36:39], v[112:127]
  s_waitcnt vmcnt(10)
  v_exp_f32 v132, v132
  v_exp_f32 v133, v133
  v_cvt_pk_bf16_f32 v153, v130, v131
  v_exp_f32 v134, v134
  v_exp_f32 v135, v135
  v_cvt_pk_bf16_f32 v154, v132, v133
  v_mfma_f32_32x32x16_bf16 v[48:63], v[216:219], v[144:147], v[48:63]
  v_exp_f32 v136, v136
  v_exp_f32 v137, v137
  v_cvt_pk_bf16_f32 v155, v134, v135
  v_exp_f32 v138, v138
  v_exp_f32_e64 v139, v139
  v_cvt_pk_bf16_f32 v156, v136, v137
  v_mfma_f32_32x32x16_bf16 v[48:63], v[220:223], v[148:151], v[48:63]
  v_exp_f32 v140, v140
  v_exp_f32 v141, v141
  v_cvt_pk_bf16_f32 v157, v138, v139
  v_exp_f32 v142, v142
  v_exp_f32 v143, v143
  v_cvt_pk_bf16_f32 v158, v140, v141
  v_cvt_pk_bf16_f32 v159, v142, v143
  v_mfma_f32_32x32x16_bf16 v[128:143], v[184:187], v[40:43], 0
  v_exp_f32 v112, v112
  v_exp_f32 v113, v113
  v_exp_f32 v114, v114
  v_exp_f32 v115, v115
  v_cvt_pk_bf16_f32 v144, v112, v113
  v_mfma_f32_32x32x16_bf16 v[128:143], v[188:191], v[44:47], v[128:143]
  v_exp_f32 v116, v116
  v_exp_f32 v117, v117
  v_cvt_pk_bf16_f32 v145, v114, v115
  v_exp_f32 v118, v118
  v_exp_f32 v119, v119
  v_cvt_pk_bf16_f32 v146, v116, v117
  v_mfma_f32_32x32x16_bf16 v[64:79], v[216:219], v[152:155], v[64:79]
  v_exp_f32 v120, v120
  v_exp_f32 v121, v121
  v_cvt_pk_bf16_f32 v147, v118, v119
  v_exp_f32 v122, v122
  v_exp_f32 v123, v123
  v_cvt_pk_bf16_f32 v148, v120, v121
  v_mfma_f32_32x32x16_bf16 v[64:79], v[220:223], v[156:159], v[64:79]
  s_waitcnt vmcnt(8)
  v_exp_f32 v124, v124
  v_exp_f32_e64 v125, v125
  v_cvt_pk_bf16_f32 v149, v122, v123
  v_exp_f32 v126, v126
  v_exp_f32 v127, v127
  v_cvt_pk_bf16_f32 v150, v124, v125
  v_cvt_pk_bf16_f32 v151, v126, v127
  s_setprio 3
  v_mfma_f32_32x32x16_bf16 v[112:127], v[160:163], v[16:19], 0
  buffer_load_dwordx4 v[184:187], v10, s[44:47], s23 offen offset:0 sc1
  s_setprio 0
  v_exp_f32 v128, v128
  v_exp_f32 v129, v129
  v_exp_f32 v130, v130
  v_exp_f32 v131, v131
  v_cvt_pk_bf16_f32 v152, v128, v129
  v_mfma_f32_32x32x16_bf16 v[112:127], v[164:167], v[20:23], v[112:127]
  v_exp_f32 v132, v132
  v_exp_f32 v133, v133
  v_cvt_pk_bf16_f32 v153, v130, v131
  v_exp_f32 v134, v134
  v_exp_f32_e64 v135, v135
  v_cvt_pk_bf16_f32 v154, v132, v133
  s_setprio 3
  v_mfma_f32_32x32x16_bf16 v[80:95], v[216:219], v[144:147], v[80:95]
  buffer_load_dwordx4 v[188:191], v10, s[44:47], s23 offen offset:1024 sc1
  s_setprio 0
  v_exp_f32 v136, v136
  v_exp_f32 v137, v137
  v_cvt_pk_bf16_f32 v155, v134, v135
  v_exp_f32 v138, v138
  v_exp_f32 v139, v139
  v_cvt_pk_bf16_f32 v156, v136, v137
  v_mfma_f32_32x32x16_bf16 v[80:95], v[220:223], v[148:151], v[80:95]
  v_exp_f32 v140, v140
  v_exp_f32 v141, v141
  v_cvt_pk_bf16_f32 v157, v138, v139
  v_exp_f32 v142, v142
  v_exp_f32 v143, v143
  v_cvt_pk_bf16_f32 v158, v140, v141
  v_cvt_pk_bf16_f32 v159, v142, v143
  s_setprio 3
  v_mfma_f32_32x32x16_bf16 v[128:143], v[160:163], v[24:27], 0
  buffer_load_dwordx4 v[208:211], v10, s[44:47], s22 offen offset:2048 sc1
  s_setprio 0
  v_exp_f32 v112, v112
  v_exp_f32 v113, v113
  v_exp_f32 v114, v114
  v_exp_f32 v115, v115
  v_cvt_pk_bf16_f32 v144, v112, v113
  v_mfma_f32_32x32x16_bf16 v[128:143], v[164:167], v[28:31], v[128:143]
  v_exp_f32 v116, v116
  v_exp_f32 v117, v117
  v_cvt_pk_bf16_f32 v145, v114, v115
  v_exp_f32 v118, v118
  v_exp_f32 v119, v119
  v_cvt_pk_bf16_f32 v146, v116, v117
  s_setprio 3
  v_mfma_f32_32x32x16_bf16 v[96:111], v[216:219], v[152:155], v[96:111]
  buffer_load_dwordx4 v[212:215], v10, s[44:47], s22 offen offset:3072 sc1
  s_setprio 0
  v_exp_f32 v120, v120
  v_exp_f32 v121, v121
  v_cvt_pk_bf16_f32 v147, v118, v119
  v_exp_f32 v122, v122
  v_exp_f32 v123, v123
  v_cvt_pk_bf16_f32 v148, v120, v121
  v_mfma_f32_32x32x16_bf16 v[96:111], v[220:223], v[156:159], v[96:111]
  v_exp_f32 v124, v124
  v_exp_f32 v125, v125
  v_cvt_pk_bf16_f32 v149, v122, v123
  v_exp_f32 v126, v126
  v_exp_f32 v127, v127
  v_cvt_pk_bf16_f32 v150, v124, v125
  v_cvt_pk_bf16_f32 v151, v126, v127
  s_setprio 3
  v_mfma_f32_32x32x16_bf16 v[112:127], v[160:163], v[32:35], 0
  buffer_load_dwordx4 v[216:219], v10, s[44:47], s23 offen offset:2048 sc1
  s_setprio 0
  v_exp_f32 v128, v128
  v_exp_f32 v129, v129
  v_exp_f32 v130, v130
  v_exp_f32 v131, v131
  v_cvt_pk_bf16_f32 v152, v128, v129
  v_mfma_f32_32x32x16_bf16 v[112:127], v[164:167], v[36:39], v[112:127]
  s_waitcnt vmcnt(9)
  v_exp_f32 v132, v132
  v_exp_f32 v133, v133
  v_cvt_pk_bf16_f32 v153, v130, v131
  v_exp_f32 v134, v134
  v_exp_f32 v135, v135
  v_cvt_pk_bf16_f32 v154, v132, v133
  s_setprio 3
  v_mfma_f32_32x32x16_bf16 v[48:63], v[192:195], v[144:147], v[48:63]
  buffer_load_dwordx4 v[220:223], v10, s[44:47], s23 offen offset:3072 sc1
  s_setprio 0
  v_exp_f32 v136, v136
  v_exp_f32 v137, v137
  v_cvt_pk_bf16_f32 v155, v134, v135
  v_exp_f32 v138, v138
  v_exp_f32 v139, v139
  v_cvt_pk_bf16_f32 v156, v136, v137
  v_mfma_f32_32x32x16_bf16 v[48:63], v[196:199], v[148:151], v[48:63]
  v_exp_f32 v140, v140
  v_exp_f32 v141, v141
  v_cvt_pk_bf16_f32 v157, v138, v139
  v_exp_f32 v142, v142
  v_exp_f32 v143, v143
  v_cvt_pk_bf16_f32 v158, v140, v141
  v_cvt_pk_bf16_f32 v159, v142, v143
  v_mfma_f32_32x32x16_bf16 v[128:143], v[168:171], v[16:19], 0
  v_exp_f32 v112, v112
  v_exp_f32 v113, v113
  v_exp_f32 v114, v114
  v_exp_f32 v115, v115
  v_cvt_pk_bf16_f32 v144, v112, v113
  v_mfma_f32_32x32x16_bf16 v[128:143], v[172:175], v[20:23], v[128:143]
  v_exp_f32 v116, v116
  v_exp_f32 v117, v117
  v_cvt_pk_bf16_f32 v145, v114, v115
  v_exp_f32 v118, v118
  v_exp_f32 v119, v119
  v_cvt_pk_bf16_f32 v146, v116, v117
  v_mfma_f32_32x32x16_bf16 v[64:79], v[192:195], v[152:155], v[64:79]
  v_exp_f32 v120, v120
  v_exp_f32 v121, v121
  v_cvt_pk_bf16_f32 v147, v118, v119
  v_exp_f32 v122, v122
  v_exp_f32 v123, v123
  v_cvt_pk_bf16_f32 v148, v120, v121
  v_mfma_f32_32x32x16_bf16 v[64:79], v[196:199], v[156:159], v[64:79]
  v_exp_f32 v124, v124
  v_exp_f32 v125, v125
  v_cvt_pk_bf16_f32 v149, v122, v123
  v_exp_f32 v126, v126
  v_exp_f32 v127, v127
  v_cvt_pk_bf16_f32 v150, v124, v125
  v_cvt_pk_bf16_f32 v151, v126, v127
  v_mfma_f32_32x32x16_bf16 v[112:127], v[168:171], v[24:27], 0
  v_exp_f32 v128, v128
  v_exp_f32 v129, v129
  v_exp_f32 v130, v130
  v_exp_f32 v131, v131
  v_cvt_pk_bf16_f32 v152, v128, v129
  v_mfma_f32_32x32x16_bf16 v[112:127], v[172:175], v[28:31], v[112:127]
  v_exp_f32 v132, v132
  v_exp_f32 v133, v133
  v_cvt_pk_bf16_f32 v153, v130, v131
  v_exp_f32 v134, v134
  v_exp_f32 v135, v135
  v_cvt_pk_bf16_f32 v154, v132, v133
  v_mfma_f32_32x32x16_bf16 v[80:95], v[192:195], v[144:147], v[80:95]
  v_exp_f32 v136, v136
  v_exp_f32 v137, v137
  v_cvt_pk_bf16_f32 v155, v134, v135
  v_exp_f32 v138, v138
  v_exp_f32 v139, v139
  v_cvt_pk_bf16_f32 v156, v136, v137
  v_mfma_f32_32x32x16_bf16 v[80:95], v[196:199], v[148:151], v[80:95]
  v_exp_f32 v140, v140
  v_exp_f32 v141, v141
  v_cvt_pk_bf16_f32 v157, v138, v139
  v_exp_f32 v142, v142
  v_exp_f32 v143, v143
  v_cvt_pk_bf16_f32 v158, v140, v141
  v_cvt_pk_bf16_f32 v159, v142, v143
  v_mfma_f32_32x32x16_bf16 v[128:143], v[168:171], v[32:35], 0
  v_exp_f32 v112, v112
  v_exp_f32 v113, v113
  v_exp_f32 v114, v114
  v_exp_f32 v115, v115
  v_cvt_pk_bf16_f32 v144, v112, v113
  v_mfma_f32_32x32x16_bf16 v[128:143], v[172:175], v[36:39], v[128:143]
  s_waitcnt vmcnt(6)
  v_exp_f32 v116, v116
  v_exp_f32 v117, v117
  v_cvt_pk_bf16_f32 v145, v114, v115
  v_exp_f32 v118, v118
  v_exp_f32 v119, v119
  v_cvt_pk_bf16_f32 v146, v116, v117
  v_mfma_f32_32x32x16_bf16 v[48:63], v[200:203], v[152:155], v[48:63]
  v_exp_f32 v120, v120
  v_exp_f32 v121, v121
  v_cvt_pk_bf16_f32 v147, v118, v119
  v_exp_f32 v122, v122
  v_exp_f32 v123, v123
  v_cvt_pk_bf16_f32 v148, v120, v121
  v_mfma_f32_32x32x16_bf16 v[48:63], v[204:207], v[156:159], v[48:63]
  v_exp_f32 v124, v124
  v_exp_f32 v125, v125
  v_cvt_pk_bf16_f32 v149, v122, v123
  v_exp_f32 v126, v126
  v_exp_f32_e64 v127, v127
  v_cvt_pk_bf16_f32 v150, v124, v125
  v_cvt_pk_bf16_f32 v151, v126, v127
  v_mfma_f32_32x32x16_bf16 v[112:127], v[176:179], v[16:19], 0
  v_exp_f32 v128, v128
  v_exp_f32 v129, v129
  v_exp_f32 v130, v130
  v_exp_f32 v131, v131
  v_cvt_pk_bf16_f32 v152, v128, v129
  v_mfma_f32_32x32x16_bf16 v[112:127], v[180:183], v[20:23], v[112:127]
  v_exp_f32 v132, v132
  v_exp_f32 v133, v133
  v_cvt_pk_bf16_f32 v153, v130, v131
  v_exp_f32 v134, v134
  v_exp_f32 v135, v135
  v_cvt_pk_bf16_f32 v154, v132, v133
  v_mfma_f32_32x32x16_bf16 v[64:79], v[200:203], v[144:147], v[64:79]
  v_exp_f32 v136, v136
  v_exp_f32 v137, v137
  v_cvt_pk_bf16_f32 v155, v134, v135
  v_exp_f32 v138, v138
  v_exp_f32 v139, v139
  v_cvt_pk_bf16_f32 v156, v136, v137
  v_mfma_f32_32x32x16_bf16 v[64:79], v[204:207], v[148:151], v[64:79]
  v_exp_f32 v140, v140
  v_exp_f32 v141, v141
  v_cvt_pk_bf16_f32 v157, v138, v139
  v_exp_f32 v142, v142
  v_exp_f32 v143, v143
  v_cvt_pk_bf16_f32 v158, v140, v141
  v_cvt_pk_bf16_f32 v159, v142, v143
  v_mfma_f32_32x32x16_bf16 v[128:143], v[176:179], v[24:27], 0
  v_exp_f32 v112, v112
  v_exp_f32 v113, v113
  v_exp_f32 v114, v114
  v_exp_f32 v115, v115
  v_cvt_pk_bf16_f32 v144, v112, v113
  v_mfma_f32_32x32x16_bf16 v[128:143], v[180:183], v[28:31], v[128:143]
  v_exp_f32 v116, v116
  v_exp_f32 v117, v117
  v_cvt_pk_bf16_f32 v145, v114, v115
  v_exp_f32 v118, v118
  v_exp_f32 v119, v119
  v_cvt_pk_bf16_f32 v146, v116, v117
  v_mfma_f32_32x32x16_bf16 v[80:95], v[200:203], v[152:155], v[80:95]
  v_exp_f32 v120, v120
  v_exp_f32 v121, v121
  v_cvt_pk_bf16_f32 v147, v118, v119
  v_exp_f32 v122, v122
  v_exp_f32 v123, v123
  v_cvt_pk_bf16_f32 v148, v120, v121
  v_mfma_f32_32x32x16_bf16 v[80:95], v[204:207], v[156:159], v[80:95]
  v_exp_f32 v124, v124
  v_exp_f32 v125, v125
  v_cvt_pk_bf16_f32 v149, v122, v123
  v_exp_f32 v126, v126
  v_exp_f32 v127, v127
  v_cvt_pk_bf16_f32 v150, v124, v125
  v_cvt_pk_bf16_f32 v151, v126, v127
  v_mfma_f32_32x32x16_bf16 v[112:127], v[176:179], v[32:35], 0
  v_exp_f32 v128, v128
  v_exp_f32 v129, v129
  v_exp_f32 v130, v130
  v_exp_f32 v131, v131
  v_cvt_pk_bf16_f32 v152, v128, v129
  v_mfma_f32_32x32x16_bf16 v[112:127], v[180:183], v[36:39], v[112:127]
  s_waitcnt vmcnt(2)
  v_exp_f32 v132, v132
  v_exp_f32 v133, v133
  v_cvt_pk_bf16_f32 v153, v130, v131
  v_exp_f32 v134, v134
  v_exp_f32 v135, v135
  v_cvt_pk_bf16_f32 v154, v132, v133
  v_mfma_f32_32x32x16_bf16 v[48:63], v[208:211], v[144:147], v[48:63]
  v_exp_f32 v136, v136
  v_exp_f32 v137, v137
  v_cvt_pk_bf16_f32 v155, v134, v135
  v_exp_f32 v138, v138
  v_exp_f32_e64 v139, v139
  v_cvt_pk_bf16_f32 v156, v136, v137
  v_mfma_f32_32x32x16_bf16 v[48:63], v[212:215], v[148:151], v[48:63]
  v_exp_f32 v140, v140
  v_exp_f32 v141, v141
  v_cvt_pk_bf16_f32 v157, v138, v139
  v_exp_f32 v142, v142
  v_exp_f32 v143, v143
  v_cvt_pk_bf16_f32 v158, v140, v141
  v_cvt_pk_bf16_f32 v159, v142, v143
  v_mfma_f32_32x32x16_bf16 v[128:143], v[184:187], v[16:19], 0
  v_exp_f32 v112, v112
  v_exp_f32 v113, v113
  v_exp_f32 v114, v114
  v_exp_f32 v115, v115
  v_cvt_pk_bf16_f32 v144, v112, v113
  v_mfma_f32_32x32x16_bf16 v[128:143], v[188:191], v[20:23], v[128:143]
  v_exp_f32 v116, v116
  v_exp_f32 v117, v117
  v_cvt_pk_bf16_f32 v145, v114, v115
  v_exp_f32 v118, v118
  v_exp_f32 v119, v119
  v_cvt_pk_bf16_f32 v146, v116, v117
  v_mfma_f32_32x32x16_bf16 v[64:79], v[208:211], v[152:155], v[64:79]
  v_exp_f32 v120, v120
  v_exp_f32 v121, v121
  v_cvt_pk_bf16_f32 v147, v118, v119
  v_exp_f32 v122, v122
  v_exp_f32 v123, v123
  v_cvt_pk_bf16_f32 v148, v120, v121
  v_mfma_f32_32x32x16_bf16 v[64:79], v[212:215], v[156:159], v[64:79]
  v_exp_f32 v124, v124
  v_exp_f32 v125, v125
  v_cvt_pk_bf16_f32 v149, v122, v123
  v_exp_f32 v126, v126
  v_exp_f32 v127, v127
  v_cvt_pk_bf16_f32 v150, v124, v125
  v_cvt_pk_bf16_f32 v151, v126, v127
  v_mfma_f32_32x32x16_bf16 v[112:127], v[184:187], v[24:27], 0
  v_exp_f32 v128, v128
  v_exp_f32 v129, v129
  v_exp_f32 v130, v130
  v_exp_f32 v131, v131
  v_cvt_pk_bf16_f32 v152, v128, v129
  v_mfma_f32_32x32x16_bf16 v[112:127], v[188:191], v[28:31], v[112:127]
  v_exp_f32 v132, v132
  v_exp_f32 v133, v133
  v_cvt_pk_bf16_f32 v153, v130, v131
  v_exp_f32 v134, v134
  v_exp_f32 v135, v135
  v_cvt_pk_bf16_f32 v154, v132, v133
  v_mfma_f32_32x32x16_bf16 v[80:95], v[208:211], v[144:147], v[80:95]
  v_exp_f32 v136, v136
  v_exp_f32 v137, v137
  v_cvt_pk_bf16_f32 v155, v134, v135
  v_exp_f32 v138, v138
  v_exp_f32 v139, v139
  v_cvt_pk_bf16_f32 v156, v136, v137
  v_mfma_f32_32x32x16_bf16 v[80:95], v[212:215], v[148:151], v[80:95]
  v_exp_f32 v140, v140
  v_exp_f32 v141, v141
  v_cvt_pk_bf16_f32 v157, v138, v139
  v_exp_f32 v142, v142
  v_exp_f32 v143, v143
  v_cvt_pk_bf16_f32 v158, v140, v141
  v_cvt_pk_bf16_f32 v159, v142, v143
  v_mfma_f32_32x32x16_bf16 v[128:143], v[184:187], v[32:35], 0
  v_exp_f32 v112, v112
  v_exp_f32 v113, v113
  v_exp_f32 v114, v114
  v_exp_f32 v115, v115
  v_cvt_pk_bf16_f32 v144, v112, v113
  v_mfma_f32_32x32x16_bf16 v[128:143], v[188:191], v[36:39], v[128:143]
  s_waitcnt vmcnt(0)
  v_exp_f32 v116, v116
  v_exp_f32 v117, v117
  v_cvt_pk_bf16_f32 v145, v114, v115
  v_exp_f32 v118, v118
  v_exp_f32_e64 v119, v119
  v_cvt_pk_bf16_f32 v146, v116, v117
  v_mfma_f32_32x32x16_bf16 v[48:63], v[216:219], v[152:155], v[48:63]
  v_exp_f32 v120, v120
  v_exp_f32 v121, v121
  v_cvt_pk_bf16_f32 v147, v118, v119
  v_exp_f32 v122, v122
  v_exp_f32 v123, v123
  v_cvt_pk_bf16_f32 v148, v120, v121
  v_mfma_f32_32x32x16_bf16 v[48:63], v[220:223], v[156:159], v[48:63]
  v_exp_f32 v124, v124
  v_exp_f32 v125, v125
  v_cvt_pk_bf16_f32 v149, v122, v123
  v_exp_f32 v126, v126
  v_exp_f32 v127, v127
  v_cvt_pk_bf16_f32 v150, v124, v125
  v_cvt_pk_bf16_f32 v151, v126, v127
  v_mfma_f32_32x32x16_bf16 v[112:127], v[160:163], v[40:43], 0
  v_exp_f32 v128, v128
  v_exp_f32 v129, v129
  v_exp_f32 v130, v130
  v_exp_f32 v131, v131
  v_cvt_pk_bf16_f32 v152, v128, v129
  v_mfma_f32_32x32x16_bf16 v[112:127], v[164:167], v[44:47], v[112:127]
  ds_write_b128 v8, v[48:51] offset:0
  v_exp_f32 v132, v132
  v_exp_f32 v133, v133
  v_cvt_pk_bf16_f32 v153, v130, v131
  v_exp_f32 v134, v134
  v_exp_f32 v135, v135
  v_cvt_pk_bf16_f32 v154, v132, v133
  v_mfma_f32_32x32x16_bf16 v[64:79], v[216:219], v[144:147], v[64:79]
  ds_write_b128 v8, v[52:55] offset:1024
  v_exp_f32 v136, v136
  v_exp_f32 v137, v137
  v_cvt_pk_bf16_f32 v155, v134, v135
  v_exp_f32 v138, v138
  v_exp_f32 v139, v139
  v_cvt_pk_bf16_f32 v156, v136, v137
  v_mfma_f32_32x32x16_bf16 v[64:79], v[220:223], v[148:151], v[64:79]
  ds_write_b128 v8, v[56:59] offset:2048
  ds_write_b128 v8, v[60:63] offset:3072
  v_exp_f32 v140, v140
  v_exp_f32 v141, v141
  v_cvt_pk_bf16_f32 v157, v138, v139
  v_exp_f32 v142, v142
  v_exp_f32 v143, v143
  v_cvt_pk_bf16_f32 v158, v140, v141
  v_cvt_pk_bf16_f32 v159, v142, v143
  v_mfma_f32_32x32x16_bf16 v[128:143], v[168:171], v[40:43], 0
  v_exp_f32 v112, v112
  v_exp_f32 v113, v113
  v_exp_f32 v114, v114
  v_exp_f32 v115, v115
  v_cvt_pk_bf16_f32 v144, v112, v113
  v_mfma_f32_32x32x16_bf16 v[128:143], v[172:175], v[44:47], v[128:143]
  ds_write_b128 v8, v[64:67] offset:4096
  v_exp_f32 v116, v116
  v_exp_f32 v117, v117
  v_cvt_pk_bf16_f32 v145, v114, v115
  v_exp_f32 v118, v118
  v_exp_f32 v119, v119
  v_cvt_pk_bf16_f32 v146, v116, v117
  v_mfma_f32_32x32x16_bf16 v[80:95], v[216:219], v[152:155], v[80:95]
  ds_write_b128 v8, v[68:71] offset:5120
  v_exp_f32 v120, v120
  v_exp_f32 v121, v121
  v_cvt_pk_bf16_f32 v147, v118, v119
  v_exp_f32 v122, v122
  v_exp_f32 v123, v123
  v_cvt_pk_bf16_f32 v148, v120, v121
  v_mfma_f32_32x32x16_bf16 v[80:95], v[220:223], v[156:159], v[80:95]
  ds_write_b128 v8, v[72:75] offset:6144
  ds_write_b128 v8, v[76:79] offset:7168
  v_exp_f32 v124, v124
  v_exp_f32 v125, v125
  v_cvt_pk_bf16_f32 v149, v122, v123
  v_exp_f32 v126, v126
  v_exp_f32 v127, v127
  v_cvt_pk_bf16_f32 v150, v124, v125
  v_cvt_pk_bf16_f32 v151, v126, v127
  v_mfma_f32_32x32x16_bf16 v[112:127], v[176:179], v[40:43], 0
  v_exp_f32 v128, v128
  v_exp_f32 v129, v129
  v_exp_f32 v130, v130
  v_exp_f32 v131, v131
  v_cvt_pk_bf16_f32 v152, v128, v129
  v_mfma_f32_32x32x16_bf16 v[112:127], v[180:183], v[44:47], v[112:127]
  ds_write_b128 v8, v[80:83] offset:8192
  v_exp_f32 v132, v132
  v_exp_f32 v133, v133
  v_cvt_pk_bf16_f32 v153, v130, v131
  v_exp_f32 v134, v134
  v_exp_f32 v135, v135
  v_cvt_pk_bf16_f32 v154, v132, v133
  v_mfma_f32_32x32x16_bf16 v[96:111], v[192:195], v[144:147], v[96:111]
  ds_write_b128 v8, v[84:87] offset:9216
  v_exp_f32 v136, v136
  v_exp_f32 v137, v137
  v_cvt_pk_bf16_f32 v155, v134, v135
  v_exp_f32 v138, v138
  v_exp_f32 v139, v139
  v_cvt_pk_bf16_f32 v156, v136, v137
  v_mfma_f32_32x32x16_bf16 v[96:111], v[196:199], v[148:151], v[96:111]
  ds_write_b128 v8, v[88:91] offset:10240
  ds_write_b128 v8, v[92:95] offset:11264
  v_exp_f32 v140, v140
  v_exp_f32 v141, v141
  v_cvt_pk_bf16_f32 v157, v138, v139
  v_exp_f32 v142, v142
  v_exp_f32 v143, v143
  v_cvt_pk_bf16_f32 v158, v140, v141
  v_cvt_pk_bf16_f32 v159, v142, v143
  v_mfma_f32_32x32x16_bf16 v[128:143], v[184:187], v[40:43], 0
  v_exp_f32 v112, v112
  v_exp_f32 v113, v113
  v_exp_f32 v114, v114
  v_exp_f32 v115, v115
  v_cvt_pk_bf16_f32 v144, v112, v113
  v_mfma_f32_32x32x16_bf16 v[128:143], v[188:191], v[44:47], v[128:143]
  s_waitcnt lgkmcnt(0)
  s_barrier
  v_exp_f32 v116, v116
  v_exp_f32 v117, v117
  v_cvt_pk_bf16_f32 v145, v114, v115
  v_exp_f32 v118, v118
  v_exp_f32 v119, v119
  v_cvt_pk_bf16_f32 v146, v116, v117
  v_mfma_f32_32x32x16_bf16 v[96:111], v[200:203], v[152:155], v[96:111]
  ds_read_b128 v[48:51], v232 offset:0
  ds_read_b128 v[52:55], v232 offset:1024
  ds_read_b128 v[56:59], v232 offset:2048
  ds_read_b128 v[60:63], v232 offset:3072
  v_exp_f32 v120, v120
  v_exp_f32 v121, v121
  v_cvt_pk_bf16_f32 v147, v118, v119
  v_exp_f32 v122, v122
  v_exp_f32 v123, v123
  v_cvt_pk_bf16_f32 v148, v120, v121
  v_mfma_f32_32x32x16_bf16 v[96:111], v[204:207], v[156:159], v[96:111]
  ds_read_b128 v[64:67], v233 offset:4096
  ds_read_b128 v[68:71], v233 offset:5120
  ds_read_b128 v[72:75], v233 offset:6144
  ds_read_b128 v[76:79], v233 offset:7168
  v_exp_f32 v124, v124
  v_exp_f32 v125, v125
  v_cvt_pk_bf16_f32 v149, v122, v123
  v_exp_f32 v126, v126
  v_exp_f32 v127, v127
  v_cvt_pk_bf16_f32 v150, v124, v125
  v_cvt_pk_bf16_f32 v151, v126, v127
  ds_read_b128 v[80:83], v234 offset:8192
  ds_read_b128 v[84:87], v234 offset:9216
  ds_read_b128 v[88:91], v234 offset:10240
  ds_read_b128 v[92:95], v234 offset:11264
  v_exp_f32 v128, v128
  v_exp_f32 v129, v129
  v_exp_f32 v130, v130
  v_exp_f32 v131, v131
  v_cvt_pk_bf16_f32 v152, v128, v129
  v_exp_f32 v132, v132
  v_exp_f32 v133, v133
  v_cvt_pk_bf16_f32 v153, v130, v131
  v_exp_f32 v134, v134
  v_exp_f32 v135, v135
  v_cvt_pk_bf16_f32 v154, v132, v133
  v_mfma_f32_32x32x16_bf16 v[96:111], v[208:211], v[144:147], v[96:111]
  v_exp_f32 v136, v136
  v_exp_f32 v137, v137
  v_cvt_pk_bf16_f32 v155, v134, v135
  v_exp_f32 v138, v138
  v_exp_f32 v139, v139
  v_cvt_pk_bf16_f32 v156, v136, v137
  v_mfma_f32_32x32x16_bf16 v[96:111], v[212:215], v[148:151], v[96:111]
  v_exp_f32 v140, v140
  v_exp_f32 v141, v141
  v_cvt_pk_bf16_f32 v157, v138, v139
  v_exp_f32 v142, v142
  v_exp_f32_e64 v143, v143
  v_cvt_pk_bf16_f32 v158, v140, v141
  v_cvt_pk_bf16_f32 v159, v142, v143
  s_setprio 2
  v_mfma_f32_32x32x16_bf16 v[96:111], v[216:219], v[152:155], v[96:111]
  v_mfma_f32_32x32x16_bf16 v[96:111], v[220:223], v[156:159], v[96:111]
  s_waitcnt lgkmcnt(4)
  v_pk_add_f32 v[48:49], v[48:49], v[64:65]
  v_pk_add_f32 v[50:51], v[50:51], v[66:67]
  v_pk_add_f32 v[52:53], v[52:53], v[68:69]
  v_pk_add_f32 v[54:55], v[54:55], v[70:71]
  v_pk_add_f32 v[56:57], v[56:57], v[72:73]
  s_nop 0
  v_pk_add_f32 v[58:59], v[58:59], v[74:75]
  v_pk_add_f32 v[60:61], v[60:61], v[76:77]
  v_pk_add_f32 v[62:63], v[62:63], v[78:79]
  s_waitcnt lgkmcnt(0)
  v_pk_add_f32 v[48:49], v[48:49], v[80:81]
  v_pk_add_f32 v[50:51], v[50:51], v[82:83]
  v_pk_add_f32 v[52:53], v[52:53], v[84:85]
  v_pk_add_f32 v[54:55], v[54:55], v[86:87]
  s_nop 0
  v_pk_add_f32 v[56:57], v[56:57], v[88:89]
  v_pk_add_f32 v[58:59], v[58:59], v[90:91]
  v_pk_add_f32 v[60:61], v[60:61], v[92:93]
  v_pk_add_f32 v[62:63], v[62:63], v[94:95]
  v_pk_add_f32 v[96:97], v[96:97], v[48:49]
  v_pk_add_f32 v[98:99], v[98:99], v[50:51]
  v_pk_add_f32 v[100:101], v[100:101], v[52:53]
  v_pk_add_f32 v[102:103], v[102:103], v[54:55]
  v_pk_add_f32 v[104:105], v[104:105], v[56:57]
  v_pk_add_f32 v[106:107], v[106:107], v[58:59]
  v_pk_add_f32 v[108:109], v[108:109], v[60:61]
  v_pk_add_f32 v[110:111], v[110:111], v[62:63]
  v_mov_b32 v228, v108
  v_mov_b32 v229, v108
  s_nop 1
  v_permlane32_swap_b32 v228, v229
  v_rcp_f32 v12, v229
  s_nop 0
  v_pk_mul_f32 v[96:97], v[96:97], v[12:13] op_sel_hi:[1,0]
  v_pk_mul_f32 v[98:99], v[98:99], v[12:13] op_sel_hi:[1,0]
  v_pk_mul_f32 v[100:101], v[100:101], v[12:13] op_sel_hi:[1,0]
  v_pk_mul_f32 v[102:103], v[102:103], v[12:13] op_sel_hi:[1,0]
  v_pk_mul_f32 v[104:105], v[104:105], v[12:13] op_sel_hi:[1,0]
  v_pk_mul_f32 v[106:107], v[106:107], v[12:13] op_sel_hi:[1,0]
  v_pk_mul_f32 v[108:109], v[108:109], v[12:13] op_sel_hi:[1,0]
  v_pk_mul_f32 v[110:111], v[110:111], v[12:13] op_sel_hi:[1,0]
  v_cvt_pk_bf16_f32 v144, v96, v97
  v_cvt_pk_bf16_f32 v145, v98, v99
  v_cvt_pk_bf16_f32 v146, v100, v101
  v_cvt_pk_bf16_f32 v147, v102, v103
  v_cvt_pk_bf16_f32 v148, v104, v105
  v_cvt_pk_bf16_f32 v149, v106, v107
  v_cvt_pk_bf16_f32 v150, v108, v109
  v_cvt_pk_bf16_f32 v151, v110, v111
  v_cndmask_b32 v150, v150, v4, s[26:27]
  v_cndmask_b32 v151, v151, v4, s[26:27]
  s_cmp_lg_u32 s87, 0
  s_cbranch_scc1 L_A2_done
  buffer_store_dwordx4 v[144:147], v0, s[44:47], s83 offen sc1
  buffer_store_dwordx4 v[148:151], v0, s[44:47], s84 offen sc1
  v_pk_mul_f32 v[230:231], v[96:97], 0 op_sel_hi:[1,0]
  v_pk_fma_f32 v[230:231], v[98:99], 0, v[230:231] op_sel_hi:[1,0,1]
  v_pk_fma_f32 v[230:231], v[100:101], 0, v[230:231] op_sel_hi:[1,0,1]
  v_pk_fma_f32 v[230:231], v[102:103], 0, v[230:231] op_sel_hi:[1,0,1]
  v_pk_fma_f32 v[230:231], v[104:105], 0, v[230:231] op_sel_hi:[1,0,1]
  v_pk_fma_f32 v[230:231], v[106:107], 0, v[230:231] op_sel_hi:[1,0,1]
  v_pk_fma_f32 v[230:231], v[108:109], 0, v[230:231] op_sel_hi:[1,0,1]
  v_pk_fma_f32 v[230:231], v[110:111], 0, v[230:231] op_sel_hi:[1,0,1]
  s_mov_b32 s68, 0x7b800000
  v_cmp_nge_f32 vcc, s68, v229
  v_cmp_u_f32 s[70:71], v230, v231
  s_nop 3
  s_or_b64 vcc, vcc, s[70:71]
  s_cmp_lg_u32 s81, 0
  s_cbranch_scc1 L_A2_good
  s_cbranch_vccz L_A2_good
  v_mov_b32 v227, 1
  ds_write_b32 v226, v227
  s_branch L_A2_done
L_A2_good:
  s_mov_b32 s87, 1
  v_lshlrev_b32 v230, 8, v1
  s_mov_b64 exec, 0x7f
  s_waitcnt vmcnt(0)
  buffer_store_dwordx2 v[6:7], v230, s[44:47], s85 offen sc1
  s_mov_b64 exec, -1
L_A2_done:
  s_waitcnt lgkmcnt(0)
  s_barrier
  ds_read_b32 v227, v226
  s_waitcnt lgkmcnt(0)
  v_readfirstlane_b32 s68, v227
  s_nop 3
  s_andn2_b32 s68, s68, s81
  s_cmp_lg_u32 s68, 0
  s_cbranch_scc1 L_A2_fallback
  s_endpgm
L_A2_fallback:
  s_mov_b32 s81, 1
  s_barrier
  v_cndmask_b32 v22, v22, v4, s[26:27]
  v_cndmask_b32 v23, v23, v4, s[26:27]
  s_nop 0
  v_mov_b32 v12, 0xff800000
  v_cndmask_b32 v30, v30, v4, s[26:27]
  v_cndmask_b32 v31, v31, v4, s[26:27]
  v_mov_b32 v13, 0xff800000
  v_cndmask_b32 v38, v38, v4, s[26:27]
  v_cndmask_b32 v39, v39, v4, s[26:27]
  v_mov_b32 v14, 0xff800000
  v_cndmask_b32 v46, v46, v4, s[26:27]
  v_cndmask_b32 v47, v47, v4, s[26:27]
  v_mov_b32 v15, 0xff800000
  s_mov_b32 s78, 0
  s_mov_b32 s72, 16
L_A2_fb_loop:
  buffer_load_dwordx4 v[224:227], v10, s[44:47], s78 offen offset:0 sc1
  buffer_load_dwordx4 v[228:231], v10, s[44:47], s78 offen offset:1024 sc1
  s_waitcnt vmcnt(0) lgkmcnt(0)
  v_mfma_f32_32x32x16_bf16 v[112:127], v[224:227], v[16:19], 0
  v_mfma_f32_32x32x16_bf16 v[112:127], v[228:231], v[20:23], v[112:127]
  s_nop 11
  v_max3_f32 v12, v12, v112, v113
  v_max3_f32 v12, v12, v114, v115
  v_max3_f32 v12, v12, v116, v117
  v_max3_f32 v12, v12, v118, v119
  v_max3_f32 v12, v12, v120, v121
  v_max3_f32 v12, v12, v122, v123
  v_max3_f32 v12, v12, v124, v125
  v_max3_f32 v12, v12, v126, v127
  s_nop 7
  v_mfma_f32_32x32x16_bf16 v[112:127], v[224:227], v[24:27], 0
  v_mfma_f32_32x32x16_bf16 v[112:127], v[228:231], v[28:31], v[112:127]
  s_nop 11
  v_max3_f32 v13, v13, v112, v113
  v_max3_f32 v13, v13, v114, v115
  v_max3_f32 v13, v13, v116, v117
  v_max3_f32 v13, v13, v118, v119
  v_max3_f32 v13, v13, v120, v121
  v_max3_f32 v13, v13, v122, v123
  v_max3_f32 v13, v13, v124, v125
  v_max3_f32 v13, v13, v126, v127
  s_nop 7
  v_mfma_f32_32x32x16_bf16 v[112:127], v[224:227], v[32:35], 0
  v_mfma_f32_32x32x16_bf16 v[112:127], v[228:231], v[36:39], v[112:127]
  s_nop 11
  v_max3_f32 v14, v14, v112, v113
  v_max3_f32 v14, v14, v114, v115
  v_max3_f32 v14, v14, v116, v117
  v_max3_f32 v14, v14, v118, v119
  v_max3_f32 v14, v14, v120, v121
  v_max3_f32 v14, v14, v122, v123
  v_max3_f32 v14, v14, v124, v125
  v_max3_f32 v14, v14, v126, v127
  s_nop 7
  v_mfma_f32_32x32x16_bf16 v[112:127], v[224:227], v[40:43], 0
  s_nop 0
  v_mfma_f32_32x32x16_bf16 v[112:127], v[228:231], v[44:47], v[112:127]
  s_nop 11
  v_max3_f32 v15, v15, v112, v113
  v_max3_f32 v15, v15, v114, v115
  v_max3_f32 v15, v15, v116, v117
  v_max3_f32 v15, v15, v118, v119
  v_max3_f32 v15, v15, v120, v121
  v_max3_f32 v15, v15, v122, v123
  s_nop 0
  v_max3_f32 v15, v15, v124, v125
  v_max3_f32 v15, v15, v126, v127
  s_nop 7
  s_add_u32 s78, s78, 4096
  s_sub_u32 s72, s72, 1
  s_cmp_lg_u32 s72, 0
  s_cbranch_scc1 L_A2_fb_loop
  v_lshlrev_b32 v232, 2, v1
  s_xor_b32 s68, s64, 3
  s_lshl_b32 s68, s68, 8
  s_lshl_b32 s69, s64, 10
  s_add_u32 s68, s68, s69
  v_add_u32 v233, s68, v232
  ds_write_b32 v233, v12
  s_xor_b32 s68, s64, 2
  s_lshl_b32 s68, s68, 8
  s_lshl_b32 s69, s64, 10
  s_add_u32 s68, s68, s69
  v_add_u32 v233, s68, v232
  ds_write_b32 v233, v13
  s_xor_b32 s68, s64, 1
  s_lshl_b32 s68, s68, 8
  s_lshl_b32 s69, s64, 10
  s_add_u32 s68, s68, s69
  v_add_u32 v233, s68, v232
  ds_write_b32 v233, v14
  s_xor_b32 s68, s64, 0
  s_lshl_b32 s68, s68, 8
  s_lshl_b32 s69, s64, 10
  s_add_u32 s68, s68, s69
  v_add_u32 v233, s68, v232
  ds_write_b32 v233, v15
  s_waitcnt lgkmcnt(0)
  s_barrier
  s_xor_b32 s68, s64, 3
  s_lshl_b32 s68, s68, 8
  v_add_u32 v233, s68, v232
  ds_read_b32 v234, v233 offset:0
  ds_read_b32 v235, v233 offset:1024
  ds_read_b32 v236, v233 offset:2048
  ds_read_b32 v237, v233 offset:3072
  s_waitcnt lgkmcnt(0)
  v_max3_f32 v12, v234, v235, v236
  v_max_f32 v12, v12, v237
  s_xor_b32 s68, s64, 2
  s_lshl_b32 s68, s68, 8
  v_add_u32_e64 v233, s68, v232
  ds_read_b32 v234, v233 offset:0
  ds_read_b32 v235, v233 offset:1024
  ds_read_b32 v236, v233 offset:2048
  ds_read_b32 v237, v233 offset:3072
  s_waitcnt lgkmcnt(0)
  v_max3_f32 v13, v234, v235, v236
  v_max_f32 v13, v13, v237
  s_xor_b32 s68, s64, 1
  s_lshl_b32 s68, s68, 8
  v_add_u32_e64 v233, s68, v232
  ds_read_b32 v234, v233 offset:0
  ds_read_b32 v235, v233 offset:1024
  ds_read_b32 v236, v233 offset:2048
  ds_read_b32 v237, v233 offset:3072
  s_waitcnt lgkmcnt(0)
  v_max3_f32 v14, v234, v235, v236
  v_max_f32 v14, v14, v237
  s_xor_b32 s68, s64, 0
  s_lshl_b32 s68, s68, 8
  v_add_u32_e64 v233, s68, v232
  ds_read_b32 v234, v233 offset:0
  ds_read_b32 v235, v233 offset:1024
  ds_read_b32 v236, v233 offset:2048
  ds_read_b32 v237, v233 offset:3072
  s_waitcnt lgkmcnt(0)
  v_max3_f32 v15, v234, v235, v236
  v_max_f32_e64 v15, v15, v237
  s_barrier
  buffer_load_dwordx4 v[160:163], v10, s[44:47], s8 offen offset:0 sc1
  buffer_load_dwordx4 v[164:167], v10, s[44:47], s8 offen offset:1024 sc1
  buffer_load_dwordx4 v[192:195], v10, s[44:47], s8 offen offset:2048 sc1
  buffer_load_dwordx4 v[196:199], v10, s[44:47], s8 offen offset:3072 sc1
  buffer_load_dwordx4 v[168:171], v10, s[44:47], s9 offen offset:0 sc1
  buffer_load_dwordx4 v[172:175], v10, s[44:47], s9 offen offset:1024 sc1
  s_waitcnt vmcnt(0) lgkmcnt(0)
  s_nop 7
  s_branch L_A2_setmax
L_roleB:
  s_lshl_b32 s68, s65, 5
  s_add_u32 s68, s68, s66
  s_lshl_b32 s68, s68, 2
  s_add_u32 s68, s68, s64
  s_mul_i32 s69, s68, 1792
  s_lshl_b32 s72, s68, 5
  s_add_u32 s72, s72, 20037632
  v_mul_u32_u24 v224, 896, v3
  v_lshl_add_u32 v224, v2, 4, v224
  v_mov_b32 v225, 0x7fff0000
  v_cmp_gt_u32 vcc, 28, v2
  s_nop 1
  v_cndmask_b32 v224, v225, v224, vcc
  s_waitcnt lgkmcnt(0)
  s_mov_b32 s28, s4
  s_mov_b32 s29, s5
  s_mov_b32 s30, 0x1c0000
  s_mov_b32 s31, 0x20000
  buffer_load_dwordx4 v[16:19], v224, s[28:31], s69 offen offset:0
  buffer_load_dwordx4 v[20:23], v224, s[28:31], s69 offen offset:448
  s_mov_b32 s32, s22
  s_mov_b32 s33, s23
  s_mov_b32 s34, 0x100
  s_mov_b32 s35, 0x20000
  s_mov_b32 s44, s24
  s_mov_b32 s45, s25
  s_mov_b32 s46, 0x135c000
  s_mov_b32 s47, 0x20000
  s_mov_b32 s36, s14
  s_mov_b32 s37, s15
  s_mov_b32 s38, 0x62000
  s_mov_b32 s39, 0x20000
  s_mov_b32 s48, s16
  s_mov_b32 s49, s17
  s_mov_b32 s50, 0x188000
  s_mov_b32 s51, 0x20000
  s_mov_b32 s52, s18
  s_mov_b32 s53, s19
  s_mov_b32 s54, 0x188000
  s_mov_b32 s55, 0x20000
  s_mov_b32 s56, s8
  s_mov_b32 s57, s9
  s_mov_b32 s58, 0x62000
  s_mov_b32 s59, 0x20000
  s_mov_b32 s60, s20
  s_mov_b32 s61, s21
  s_mov_b32 s62, 0x1c0000
  s_mov_b32 s63, 0x20000
  v_mov_b32 v24, 0
  v_mov_b32 v26, 0
  v_lshlrev_b32 v226, 4, v3
  s_and_b32 s68, s2, 255
  v_lshlrev_b32 v193, 7, v1
  s_cmp_lg_u32 s64, 0
  s_cbranch_scc1 L_tc_12
  v_and_b32 v193, 0x7ff, v193
  s_mul_i32 s68, s68, 1664
  buffer_load_dword v192, v193, s[36:39], s68 offen
  s_branch L_tj_11
L_tc_12:
  s_cmp_lg_u32 s64, 1
  s_cbranch_scc1 L_tc_13
  s_getpc_b64 s[40:41]
L_pc:
  s_sub_u32 s40, s40, L_pc-parallel_sum__mha_block__mixer_s_mlp__prompt_kernel
  s_subb_u32 s41, s41, 0
  s_mov_b32 s42, L_code_end-parallel_sum__mha_block__mixer_s_mlp__prompt_kernel
  s_mov_b32 s43, 0x20000
  s_mov_b32 s68, s66
  v_and_b32 v193, 0x7ff, v193
  s_mul_i32 s68, s68, 1536
  buffer_load_dword v192, v193, s[40:43], s68 offen
  s_branch L_tj_11
L_tc_13:
  s_cmp_lg_u32 s64, 2
  s_cbranch_scc1 L_tc_14
  v_and_b32 v193, 0x7ff, v193
  s_mul_i32 s68, s68, 1664
  buffer_load_dword v192, v193, s[36:39], s68 offen
  s_branch L_tj_11
L_tc_14:
  v_and_b32 v193, 0x7ff, v193
  s_mul_i32 s68, s68, 1664
  buffer_load_dword v192, v193, s[36:39], s68 offen
L_tj_11:
  s_mul_i32 s68, s66, 37
  s_lshr_b32 s68, s68, 8
  s_mul_i32 s69, s68, 7
  s_sub_u32 s76, s66, s69
  s_lshl_b32 s75, s65, 2
  s_add_u32 s75, s75, s68
  s_lshr_b32 s77, s64, 1
  s_and_b32 s78, s64, 1
  v_lshrrev_b32 v64, 3, v1
  v_bfe_u32 v65, v1, 4, 1
  v_lshlrev_b32 v65, 2, v65
  v_and_b32 v66, 7, v1
  v_xor_b32 v65, v65, v66
  v_mul_u32_u24 v64, 896, v64
  v_lshl_add_u32 v248, v65, 4, v64
  v_add_u32 v249, 6144, v248
  v_lshrrev_b32 v64, 3, v1
  v_add_u32 v64, 0, v64
  v_bfe_u32 v65, v64, 1, 3
  v_and_b32 v66, 7, v1
  v_xor_b32 v65, v65, v66
  v_mul_u32_u24 v64, 896, v64
  v_lshl_add_u32 v64, v65, 4, v64
  v_subrev_u32 v60, 0, v64
  v_lshrrev_b32 v64, 3, v1
  v_add_u32 v64, 8, v64
  v_bfe_u32 v65, v64, 1, 3
  v_and_b32 v66, 7, v1
  v_xor_b32 v65, v65, v66
  v_mul_u32_u24 v64, 896, v64
  v_lshl_add_u32 v64, v65, 4, v64
  v_subrev_u32 v61, 1024, v64
  s_waitcnt vmcnt(1)
  buffer_load_dwordx2 v[6:7], v4, s[32:35], 0 offen sc1
  v_dot2c_f32_bf16 v24, s67, v16
  v_dot2c_f32_bf16 v26, v16, v16
  v_dot2c_f32_bf16 v24, s67, v17
  v_dot2c_f32_bf16 v26, v17, v17
  v_dot2c_f32_bf16 v24, s67, v18
  v_dot2c_f32_bf16 v26, v18, v18
  v_dot2c_f32_bf16 v24, s67, v19
  v_dot2c_f32_bf16 v26, v19, v19
  v_dot2c_f32_bf16 v24, s67, v20
  v_dot2c_f32_bf16 v26, v20, v20
  v_dot2c_f32_bf16 v24, s67, v21
  v_dot2c_f32_bf16 v26, v21, v21
  v_dot2c_f32_bf16 v24, s67, v22
  v_dot2c_f32_bf16 v26, v22, v22
  v_dot2c_f32_bf16 v24, s67, v23
  v_dot2c_f32_bf16 v26, v23, v23
  s_nop 1
  s_nop 0
  v_add_f32_dpp v24, v24, v24 row_ror:8 row_mask:0xf bank_mask:0xf
  v_add_f32_dpp v26, v26, v26 row_ror:8 row_mask:0xf bank_mask:0xf
  s_nop 0
  v_add_f32_dpp v24, v24, v24 row_ror:4 row_mask:0xf bank_mask:0xf
  v_add_f32_dpp v26, v26, v26 row_ror:4 row_mask:0xf bank_mask:0xf
  s_nop 0
  v_add_f32_dpp v24, v24, v24 row_ror:2 row_mask:0xf bank_mask:0xf
  v_add_f32_dpp v26, v26, v26 row_ror:2 row_mask:0xf bank_mask:0xf
  s_nop 0
  s_nop 0
  v_add_f32_dpp v24, v24, v24 row_ror:1 row_mask:0xf bank_mask:0xf
  v_add_f32_dpp v26, v26, v26 row_ror:1 row_mask:0xf bank_mask:0xf
  v_mov_b32 v25, v24
  v_mov_b32 v27, v26
  s_nop 0
  v_permlane16_swap_b32 v24, v25
  v_permlane16_swap_b32 v26, v27
  v_add_f32 v24, v24, v25
  v_add_f32_e64 v26, v26, v27
  v_mul_f32 v24, 0x3b124925, v24
  v_mul_f32 v26, 0x3b124925, v26
  v_fma_f32 v26, -v24, v24, v26
  v_max_f32 v26, 0, v26
  v_add_f32 v26, 0x3727c5ac, v26
  v_rsq_f32 v26, v26
  s_waitcnt vmcnt(0)
  s_mov_b32 s74, 400000
  s_branch L_noc_18
L_no_16:
  buffer_load_dwordx2 v[6:7], v4, s[32:35], 0 offen sc1
  s_waitcnt vmcnt(0)
L_noc_18:
  v_readfirstlane_b32 s0, v6
  v_readfirstlane_b32 s1, v7
  s_nop 2
  s_cmp_lg_u32 s0, 0
  s_cbranch_scc1 L_nod_17
  s_sub_u32 s74, s74, 1
  s_cbranch_scc1 L_nod_17
  s_sleep 1
  s_branch L_no_16
L_nod_17:
  v_mov_b32 v25, v6
  v_mov_b32 v27, v6
  s_mov_b32 exec_lo, 1
  s_mov_b32 exec_hi, 1
  buffer_store_dwordx4 v[24:27], v226, s[44:47], s72 offen sc1
  s_mov_b64 exec, -1
  s_cmp_ge_u32 s66, 28
  s_cbranch_scc1 L_helper
  s_setprio 1
  v_mul_u32_u24 v214, 33024, v3
  v_lshl_add_u32 v214, v2, 4, v214
  s_lshl_b32 s68, s77, 9
  v_add_u32 v250, s68, v214
  s_xor_b32 s68, s68, 512
  v_add_u32 v251, s68, v214
  s_and_b32 s68, s65, 1
  s_mul_i32 s68, s68, 7
  s_add_u32 s83, s68, s76
  s_lshr_b32 s68, s65, 1
  s_lshl_b32 s68, s68, 2
  s_and_b32 s69, s75, 3
  s_add_u32 s82, s68, s69
  s_lshl_b32 s68, s69, 1
  s_add_u32 s68, s68, s76
  s_sub_u32 s69, s68, 7
  s_cselect_b32 s68, s68, s69
  s_add_u32 s92, s68, 0
  s_sub_u32 s73, s92, 7
  s_cselect_b32 s92, s92, s73
  s_add_u32 s93, s68, 1
  s_sub_u32 s73, s93, 7
  s_cselect_b32 s93, s93, s73
  s_add_u32 s94, s68, 2
  s_sub_u32 s73, s94, 7
  s_cselect_b32 s94, s94, s73
  s_add_u32 s95, s68, 3
  s_sub_u32 s73, s95, 7
  s_cselect_b32 s95, s95, s73
  s_add_u32 s96, s68, 4
  s_sub_u32 s73, s96, 7
  s_cselect_b32 s96, s96, s73
  s_add_u32 s97, s68, 5
  s_sub_u32 s73, s97, 7
  s_cselect_b32 s97, s97, s73
  s_add_u32 s98, s68, 6
  s_sub_u32 s73, s98, 7
  s_cselect_b32 s98, s98, s73
  s_and_b32 s68, s75, 3
  s_lshl_b32 s68, s68, 1
  s_add_u32 s68, s68, s76
  s_sub_u32 s69, s68, 7
  s_cselect_b32 s68, s68, s69
  s_add_u32 s4, s68, 0
  s_sub_u32 s73, s4, 7
  s_cselect_b32 s4, s4, s73
  s_add_u32 s5, s68, 1
  s_sub_u32 s73, s5, 7
  s_cselect_b32 s5, s5, s73
  s_add_u32 s6, s68, 2
  s_sub_u32 s73, s6, 7
  s_cselect_b32 s6, s6, s73
  s_add_u32 s7, s68, 3
  s_sub_u32 s73, s7, 7
  s_cselect_b32 s7, s7, s73
  s_add_u32 s8, s68, 4
  s_sub_u32 s73, s8, 7
  s_cselect_b32 s8, s8, s73
  s_add_u32 s9, s68, 5
  s_sub_u32 s73, s9, 7
  s_cselect_b32 s9, s9, s73
  s_add_u32 s10, s68, 6
  s_sub_u32 s73, s10, 7
  s_cselect_b32 s10, s10, s73
  s_mul_i32 s69, s64, 57344
  s_lshl_b32 s70, s83, 8
  s_add_u32 s69, s69, s70
  s_mul_i32 s68, s64, 401408
  s_lshl_b32 s70, s76, 7
  s_add_u32 s68, s68, s70
  s_mul_i32 s19, s64, 100352
  s_add_u32 s19, s19, s70
  s_lshl_b32 s70, s75, 10
  s_nop 0
  s_mul_i32 s71, s64, 1849344
  s_add_u32 s71, s71, s70
  s_add_u32 s71, s71, 12632064
  s_mul_i32 s20, s64, 528384
  s_add_u32 s20, s20, s70
  s_add_u32 s20, s20, 10518528
  s_lshl_b32 s72, s82, 2
  s_add_u32 s72, s72, s64
  s_lshl_b32 s79, s72, 8
  s_add_u32 s79, s79, 20070400
  s_lshl_b32 s72, s72, 9
  s_mul_i32 s84, s92, 229376
  s_add_u32 s84, s84, s69
  s_mul_i32 s11, s4, 57344
  s_add_u32 s11, s11, s68
  s_mul_i32 s4, s4, 264192
  s_add_u32 s4, s4, s71
  s_mul_i32 s92, s92, 264192
  s_add_u32 s92, s92, s72
  s_add_u32 s92, s92, 8667136
  s_mul_i32 s85, s93, 229376
  s_add_u32 s85, s85, s69
  s_mul_i32 s12, s5, 57344
  s_add_u32 s12, s12, s68
  s_mul_i32 s5, s5, 264192
  s_add_u32 s5, s5, s71
  s_mul_i32 s93, s93, 264192
  s_add_u32 s93, s93, s72
  s_add_u32 s93, s93, 8667136
  s_mul_i32 s86, s94, 229376
  s_add_u32 s86, s86, s69
  s_nop 0
  s_mul_i32 s13, s6, 57344
  s_add_u32 s13, s13, s68
  s_mul_i32 s6, s6, 264192
  s_add_u32 s6, s6, s71
  s_mul_i32 s94, s94, 264192
  s_add_u32 s94, s94, s72
  s_add_u32 s94, s94, 8667136
  s_mul_i32 s87, s95, 229376
  s_add_u32 s87, s87, s69
  s_mul_i32 s14, s7, 57344
  s_add_u32 s14, s14, s68
  s_mul_i32 s7, s7, 264192
  s_add_u32 s7, s7, s71
  s_mul_i32 s95, s95, 264192
  s_add_u32 s95, s95, s72
  s_add_u32 s95, s95, 8667136
  s_mul_i32 s88, s96, 229376
  s_add_u32 s88, s88, s69
  s_mul_i32 s15, s8, 57344
  s_add_u32 s15, s15, s68
  s_nop 0
  s_mul_i32 s8, s8, 264192
  s_add_u32 s8, s8, s71
  s_mul_i32 s96, s96, 264192
  s_add_u32 s96, s96, s72
  s_add_u32 s96, s96, 8667136
  s_mul_i32 s89, s97, 229376
  s_add_u32 s89, s89, s69
  s_mul_i32 s16, s9, 57344
  s_add_u32 s16, s16, s68
  s_mul_i32 s9, s9, 264192
  s_add_u32 s9, s9, s71
  s_mul_i32 s97, s97, 264192
  s_add_u32 s97, s97, s72
  s_add_u32 s97, s97, 8667136
  s_mul_i32 s90, s98, 229376
  s_add_u32 s90, s90, s69
  s_mul_i32 s17, s10, 57344
  s_add_u32 s17, s17, s68
  s_mul_i32 s10, s10, 264192
  s_add_u32 s10, s10, s71
  s_nop 0
  s_mul_i32 s98, s98, 264192
  s_add_u32 s98, s98, s72
  s_add_u32 s98, s98, 8667136
  s_mul_i32 s69, s83, 528384
  s_add_u32 s72, s72, s69
  s_add_u32 s72, s72, 12632064
  s_add_u32 s68, s64, 0
  s_and_b32 s68, s68, 3
  s_mul_i32 s68, s68, 132096
  s_add_u32 s80, s68, s72
  s_add_u32 s68, s64, 1
  s_and_b32 s68, s68, 3
  s_mul_i32 s68, s68, 132096
  s_add_u32 s81, s68, s72
  s_add_u32 s68, s64, 2
  s_and_b32 s68, s68, 3
  s_mul_i32 s68, s68, 132096
  s_add_u32 s99, s68, s72
  s_add_u32 s68, s64, 3
  s_and_b32 s68, s68, 3
  s_mul_i32 s68, s68, 132096
  s_add_u32 s3, s68, s72
  s_lshl_b32 s91, s64, 12
  s_nop 0
  s_mul_i32 s18, s64, 20480
  s_lshl_b32 s70, s76, 1
  s_add_u32 s70, s70, s78
  s_mul_i32 s68, s70, 132096
  s_lshl_b32 s69, s75, 10
  s_add_u32 s68, s68, s69
  s_add_u32 s21, s68, 8667136
  s_lshl_b32 s25, s70, 14
  s_add_u32 s25, s25, 20070400
  s_lshl_b32 s70, s70, 6
  s_lshl_b32 s68, s75, 1
  s_add_u32 s68, s68, s77
  s_mul_i32 s24, s68, 28672
  s_add_u32 s24, s24, s70
  s_mul_i32 s68, s75, 7
  s_add_u32 s68, s68, s76
  s_lshl_b32 s68, s68, 2
  s_add_u32 s68, s68, s64
  s_lshl_b32 s22, s68, 6
  s_mul_i32 s68, s82, 14
  s_add_u32 s68, s68, s83
  s_lshl_b32 s68, s68, 2
  s_add_u32 s68, s68, s64
  s_lshl_b32 s23, s68, 6
  s_lshr_b32 s68, s75, 1
  s_mul_i32 s68, s68, 3584
  s_and_b32 s69, s75, 1
  s_lshl_b32 s69, s69, 7
  s_add_u32 s68, s68, s69
  s_lshl_b32 s69, s76, 3
  s_add_u32 s68, s68, s69
  s_add_u32 s68, s68, 188416
  v_lshrrev_b32 v224, 1, v1
  v_lshlrev_b32 v224, 8, v224
  v_and_b32 v225, 1, v1
  v_lshl_add_u32 v224, v225, 6, v224
  v_add_u32 v254, s68, v224
  v_mov_b32 v224, 0x7fff0000
  v_cmp_gt_u32 vcc, 28, v1
  s_nop 1
  v_cndmask_b32 v254, v224, v254, vcc
  v_mul_u32_u24 v224, 37, v1
  v_lshrrev_b32 v224, 9, v224
  v_mul_u32_u24 v226, 14, v224
  v_sub_u32 v225, v1, v226
  s_lshl_b32 s68, s83, 1
  v_add_u32 v224, s68, v224
  v_mul_u32_u24 v224, 37, v224
  v_lshrrev_b32 v224, 8, v224
  v_mul_u32_u24 v226, 7, v224
  v_lshrrev_b32 v226, 1, v226
  v_sub_u32 v226, s83, v226
  v_lshlrev_b32 v226, 3, v226
  v_lshl_add_u32 v226, v224, 6, v226
  s_mul_i32 s68, s82, 3584
  s_add_u32 s68, s68, 245760
  v_lshl_add_u32 v226, v225, 8, v226
  v_add_u32 v255, s68, v226
  v_mov_b32 v224, 0x7fff0000
  v_cmp_gt_u32 vcc, 28, v1
  s_nop 1
  v_cndmask_b32 v255, v224, v255, vcc
  s_movk_i32 s71, 3584
  v_lshrrev_b32 v224, 4, v1
  v_lshlrev_b32 v225, 2, v224
  v_sub_u32 v225, v1, v225
  v_and_b32 v225, 15, v225
  v_mul_u32_u24 v224, s71, v224
  v_lshl_add_u32 v194, v225, 4, v224
  s_lshl_b32 s73, s71, 2
  s_sub_u32 s73, s73, 1024
  v_add_u32 v195, s73, v194
  v_add_u32 v196, s73, v195
  v_add_u32 v197, s73, v196
  v_bfe_u32 v224, v1, 2, 2
  v_and_b32 v225, 3, v1
  v_lshlrev_b32 v225, 3, v225
  v_bfe_u32 v226, v1, 4, 1
  v_lshl_add_u32 v225, v226, 5, v225
  v_lshl_add_u32 v225, v224, 6, v225
  v_lshl_add_u32 v224, v3, 3, v224
  v_lshlrev_b32 v224, 8, v224
  s_add_u32 s68, s64, 0
  s_and_b32 s68, s68, 3
  s_mul_i32 s68, s68, 64
  v_add_u32 v198, s68, v225
  v_and_b32 v198, 255, v198
  v_add_u32 v198, v198, v224
  s_add_u32 s68, s64, 1
  s_and_b32 s68, s68, 3
  s_mul_i32 s68, s68, 64
  v_add_u32 v199, s68, v225
  v_and_b32 v199, 255, v199
  v_add_u32 v199, v199, v224
  s_add_u32 s68, s64, 2
  s_and_b32 s68, s68, 3
  s_mul_i32 s68, s68, 64
  v_add_u32 v200, s68, v225
  v_and_b32 v200, 255, v200
  v_add_u32 v200, v200, v224
  s_add_u32 s68, s64, 3
  s_and_b32 s68, s68, 3
  s_mul_i32 s68, s68, 64
  v_add_u32 v201, s68, v225
  v_and_b32 v201, 255, v201
  v_add_u32 v201, v201, v224
  s_lshl_b32 s69, s64, 9
  s_add_u32 s69, s69, 73728
  v_lshl_add_u32 v223, v1, 3, s69
  s_add_u32 s68, s64, 0
  s_and_b32 s68, s68, 3
  s_lshl_b32 s68, s68, 7
  s_add_u32 s68, s68, s69
  v_lshl_add_u32 v202, v3, 4, s68
  s_add_u32 s68, s64, 1
  s_and_b32 s68, s68, 3
  s_lshl_b32 s68, s68, 7
  s_add_u32 s68, s68, s69
  v_lshl_add_u32 v203, v3, 4, s68
  s_add_u32 s68, s64, 2
  s_and_b32 s68, s68, 3
  s_lshl_b32 s68, s68, 7
  s_add_u32 s68, s68, s69
  v_lshl_add_u32 v204, v3, 4, s68
  s_add_u32 s68, s64, 3
  s_and_b32 s68, s68, 3
  s_lshl_b32 s68, s68, 7
  s_add_u32 s68, s68, s69
  v_lshl_add_u32 v205, v3, 4, s68
  v_bfe_u32 v224, v1, 2, 2
  v_and_b32 v225, 3, v1
  v_lshlrev_b32 v225, 3, v225
  v_bfe_u32 v226, v1, 4, 1
  v_lshl_add_u32 v225, v226, 5, v225
  v_lshrrev_b32 v226, 1, v224
  v_xor_b32 v226, s78, v226
  v_lshl_add_u32 v225, v226, 6, v225
  v_mad_u32_u24 v224, v3, 4, v224
  v_lshl_add_u32 v252, v224, 7, v225
  v_add_u32 v252, s18, v252
  v_xor_b32 v253, 64, v252
  v_mul_u32_u24 v215, 114688, v3
  v_lshl_add_u32 v215, v2, 3, v215
  s_lshl_b32 s68, s75, 6
  s_lshl_b32 s69, s77, 5
  s_add_u32 s68, s68, s69
  v_add_u32 v224, s68, v2
  v_lshlrev_b32 v222, 3, v224
  v_lshlrev_b32 v228, 4, v224
  v_mul_u32_u24 v225, 33024, v3
  v_mov_b32 v227, 0x7fff0000
  s_movk_i32 s70, 2048
  s_add_u32 s68, s78, 1
  v_subrev_u32 v226, s68, v224
  v_cmp_gt_u32 vcc, s70, v226
  v_lshl_add_u32 v216, v226, 4, v225
  s_nop 0
  v_cndmask_b32 v216, v227, v216, vcc
  v_add_u32 v226, s68, v224
  v_cmp_gt_u32 vcc, s70, v226
  v_lshl_add_u32 v217, v226, 4, v225
  s_nop 0
  v_cndmask_b32 v217, v227, v217, vcc
  s_and_b32 s72, s2, 255
  s_lshl_b32 s72, s72, 6
  s_mov_b32 s74, 400000
L_sp_19:
  s_buffer_load_dwordx2 s[70:71], s[44:47], s72 offset:360448 glc
  s_waitcnt lgkmcnt(0)
  s_xor_b64 s[70:71], s[70:71], s[0:1]
  s_cbranch_scc0 L_spd_20
  s_sub_u32 s74, s74, 1
  s_cbranch_scc1 L_spd_20
  s_sleep 1
  s_branch L_sp_19
L_spd_20:
  s_lshl_b32 s68, s75, 2
  s_add_u32 s68, s68, s64
  s_mul_i32 s68, s68, 14336
  s_lshl_b32 s69, s76, 7
  s_add_u32 s68, s68, s69
  s_lshl_b32 s70, s64, 11
  s_add_u32 m0, s70, 57344
  s_nop 0
  buffer_load_dwordx4 v60, s[28:31], s68 offen offset:0 lds
  buffer_load_dwordx4 v61, s[28:31], s68 offen offset:1024 lds
  s_mul_i32 s68, s64, 100352
  s_add_u32 s68, s68, s69
  s_mul_i32 s69, s64, 14336
  s_and_b32 s70, s75, 3
  s_lshl_b32 s70, s70, 1
  s_mul_i32 s72, s70, 14336
  s_add_u32 s72, s72, s68
  s_lshl_b32 s73, s70, 11
  s_add_u32 m0, s73, s69
  s_nop 0
  buffer_load_dwordx4 v248, s[36:39], s72 offen offset:0 lds
  buffer_load_dwordx4 v249, s[36:39], s72 offen offset:1024 lds
  s_add_u32 s70, s70, 1
  s_cmp_eq_u32 s70, 7
  s_cselect_b32 s70, 0, s70
  s_mul_i32 s72, s70, 14336
  s_add_u32 s72, s72, s68
  s_lshl_b32 s73, s70, 11
  s_add_u32 m0, s73, s69
  s_nop 0
  buffer_load_dwordx4 v248, s[36:39], s72 offen offset:0 lds
  buffer_load_dwordx4 v249, s[36:39], s72 offen offset:1024 lds
  s_add_u32 s70, s70, 1
  s_cmp_eq_u32 s70, 7
  s_cselect_b32 s70, 0, s70
  s_mul_i32 s72, s70, 14336
  s_add_u32 s72, s72, s68
  s_lshl_b32 s73, s70, 11
  s_add_u32 m0, s73, s69
  s_nop 0
  buffer_load_dwordx4 v248, s[36:39], s72 offen offset:0 lds
  buffer_load_dwordx4 v249, s[36:39], s72 offen offset:1024 lds
  s_add_u32 s70, s70, 1
  s_cmp_eq_u32 s70, 7
  s_cselect_b32 s70, 0, s70
  s_mul_i32 s72, s70, 14336
  s_add_u32 s72, s72, s68
  s_lshl_b32 s73, s70, 11
  s_add_u32 m0, s73, s69
  s_nop 0
  buffer_load_dwordx4 v248, s[36:39], s72 offen offset:0 lds
  buffer_load_dwordx4 v249, s[36:39], s72 offen offset:1024 lds
  s_add_u32 s70, s70, 1
  s_cmp_eq_u32 s70, 7
  s_cselect_b32 s70, 0, s70
  s_mul_i32 s72, s70, 14336
  s_add_u32 s72, s72, s68
  s_lshl_b32 s73, s70, 11
  s_add_u32 m0, s73, s69
  s_nop 0
  buffer_load_dwordx4 v248, s[36:39], s72 offen offset:0 lds
  buffer_load_dwordx4 v249, s[36:39], s72 offen offset:1024 lds
  s_add_u32 s70, s70, 1
  s_cmp_eq_u32 s70, 7
  s_cselect_b32 s70, 0, s70
  s_mul_i32 s72, s70, 14336
  s_add_u32 s72, s72, s68
  s_lshl_b32 s73, s70, 11
  s_add_u32 m0, s73, s69
  s_nop 0
  buffer_load_dwordx4 v248, s[36:39], s72 offen offset:0 lds
  buffer_load_dwordx4 v249, s[36:39], s72 offen offset:1024 lds
  s_add_u32 s70, s70, 1
  s_cmp_eq_u32 s70, 7
  s_cselect_b32 s70, 0, s70
  s_nop 0
  s_mul_i32 s72, s70, 14336
  s_add_u32 s72, s72, s68
  s_lshl_b32 s73, s70, 11
  s_add_u32 m0, s73, s69
  s_nop 0
  buffer_load_dwordx4 v248, s[36:39], s72 offen offset:0 lds
  buffer_load_dwordx4 v249, s[36:39], s72 offen offset:1024 lds
  s_mov_b32 s72, 20037632
  s_mov_b32 s74, 400000
L_rec_21:
  buffer_load_dwordx4 v[160:163], v228, s[44:47], s72 offen sc1
  s_waitcnt vmcnt(0)
L_recc_23:
  v_cmp_ne_u32 vcc, v161, v6
  v_cmp_ne_u32 s[70:71], v163, v6
  s_nop 3
  s_or_b64 vcc, vcc, s[70:71]
  v_cmp_eq_u32 s[70:71], 0, v6
  s_nop 3
  s_or_b64 vcc, vcc, s[70:71]
  s_cbranch_vccz L_recd_22
  s_sub_u32 s74, s74, 1
  s_cbranch_scc1 L_recd_22
  s_sleep 1
  s_branch L_rec_21
L_recd_22:
  s_barrier
  s_mul_i32 s71, s78, 28672
  v_bfe_u32 v224, v1, 2, 2
  v_and_b32 v225, 3, v1
  v_lshlrev_b32 v225, 3, v225
  v_bfe_u32 v226, v1, 4, 1
  v_lshl_add_u32 v225, v226, 5, v225
  v_lshrrev_b32 v226, 1, v224
  v_xor_b32 v226, s78, v226
  v_lshl_add_u32 v225, v226, 6, v225
  v_mad_u32_u24 v224, v3, 4, v224
  v_lshl_add_u32 v172, v224, 7, v225
  v_add_u32 v172, s71, v172
  v_xor_b32 v173, 64, v172
  v_bfe_u32 v224, v2, 1, 3
  s_lshl_b32 s68, s78, 2
  v_xor_b32 v224, s68, v224
  v_lshlrev_b32 v224, 4, v224
  v_lshl_add_u32 v224, v2, 7, v224
  v_lshl_add_u32 v224, v3, 3, v224
  s_lshl_b32 s68, s77, 12
  v_add_u32 v224, s68, v224
  v_xor_b32 v225, 0, v224
  ds_read_b64 v[164:165], v225 offset:57344
  v_xor_b32 v225, 16, v224
  ds_read_b64 v[166:167], v225 offset:57344
  v_xor_b32 v225, 32, v224
  ds_read_b64 v[168:169], v225 offset:57344
  v_xor_b32_e64 v225, 48, v224
  ds_read_b64 v[170:171], v225 offset:57344
  ds_read_b64_tr_b16 v[48:49], v172 offset:0
  ds_read_b64_tr_b16 v[50:51], v172 offset:1024
  ds_read_b64_tr_b16 v[52:53], v173 offset:0
  ds_read_b64_tr_b16 v[54:55], v173 offset:1024
  ds_read_b64_tr_b16 v[56:57], v172 offset:2048
  ds_read_b64_tr_b16 v[58:59], v172 offset:3072
  ds_read_b64_tr_b16 v[60:61], v173 offset:2048
  ds_read_b64_tr_b16 v[62:63], v173 offset:3072
  ds_read_b64_tr_b16 v[64:65], v172 offset:4096
  ds_read_b64_tr_b16 v[66:67], v172 offset:5120
  s_waitcnt lgkmcnt(10)
  ds_read_b64_tr_b16 v[68:69], v173 offset:4096
  ds_read_b64_tr_b16 v[70:71], v173 offset:5120
  ds_read_b64_tr_b16 v[72:73], v172 offset:6144
  ds_read_b64_tr_b16 v[74:75], v172 offset:7168
  s_waitcnt lgkmcnt(10)
  ds_read_b64_tr_b16 v[76:77], v173 offset:6144
  ds_read_b64_tr_b16 v[78:79], v173 offset:7168
  ds_read_b64_tr_b16 v[80:81], v172 offset:8192
  ds_read_b64_tr_b16 v[82:83], v172 offset:9216
  s_waitcnt lgkmcnt(10)
  ds_read_b64_tr_b16 v[84:85], v173 offset:8192
  ds_read_b64_tr_b16 v[86:87], v173 offset:9216
  ds_read_b64_tr_b16 v[88:89], v172 offset:10240
  ds_read_b64_tr_b16 v[90:91], v172 offset:11264
  s_waitcnt lgkmcnt(10)
  ds_read_b64_tr_b16 v[92:93], v173 offset:10240
  ds_read_b64_tr_b16 v[94:95], v173 offset:11264
  ds_read_b64_tr_b16 v[96:97], v172 offset:12288
  ds_read_b64_tr_b16 v[98:99], v172 offset:13312
  s_waitcnt lgkmcnt(10)
  ds_read_b64_tr_b16 v[100:101], v173 offset:12288
  ds_read_b64_tr_b16 v[102:103], v173 offset:13312
  ds_read_b64_tr_b16 v[104:105], v172 offset:14336
  ds_read_b64_tr_b16 v[106:107], v172 offset:15360
  s_waitcnt lgkmcnt(10)
  ds_read_b64_tr_b16 v[108:109], v173 offset:14336
  ds_read_b64_tr_b16 v[110:111], v173 offset:15360
  ds_read_b64_tr_b16 v[112:113], v172 offset:16384
  ds_read_b64_tr_b16 v[114:115], v172 offset:17408
  s_waitcnt lgkmcnt(10)
  ds_read_b64_tr_b16 v[116:117], v173 offset:16384
  ds_read_b64_tr_b16 v[118:119], v173 offset:17408
  ds_read_b64_tr_b16 v[120:121], v172 offset:18432
  ds_read_b64_tr_b16 v[122:123], v172 offset:19456
  s_waitcnt lgkmcnt(10)
  ds_read_b64_tr_b16 v[124:125], v173 offset:18432
  ds_read_b64_tr_b16 v[126:127], v173 offset:19456
  ds_read_b64_tr_b16 v[128:129], v172 offset:20480
  ds_read_b64_tr_b16 v[130:131], v172 offset:21504
  s_waitcnt lgkmcnt(10)
  ds_read_b64_tr_b16 v[132:133], v173 offset:20480
  ds_read_b64_tr_b16 v[134:135], v173 offset:21504
  ds_read_b64_tr_b16 v[136:137], v172 offset:22528
  s_nop 0
  ds_read_b64_tr_b16 v[138:139], v172 offset:23552
  s_waitcnt lgkmcnt(10)
  ds_read_b64_tr_b16 v[140:141], v173 offset:22528
  ds_read_b64_tr_b16 v[142:143], v173 offset:23552
  ds_read_b64_tr_b16 v[144:145], v172 offset:24576
  ds_read_b64_tr_b16 v[146:147], v172 offset:25600
  s_waitcnt lgkmcnt(10)
  ds_read_b64_tr_b16 v[148:149], v173 offset:24576
  ds_read_b64_tr_b16 v[150:151], v173 offset:25600
  ds_read_b64_tr_b16 v[152:153], v172 offset:26624
  ds_read_b64_tr_b16 v[154:155], v172 offset:27648
  s_waitcnt lgkmcnt(10)
  ds_read_b64_tr_b16 v[156:157], v173 offset:26624
  ds_read_b64_tr_b16 v[158:159], v173 offset:27648
  s_waitcnt lgkmcnt(0)
  s_barrier
  v_lshlrev_b32 v232, 16, v164
  v_and_b32 v233, 0xffff0000, v164
  v_lshlrev_b32_e64 v234, 16, v165
  v_and_b32 v235, 0xffff0000, v165
  v_lshlrev_b32 v236, 16, v166
  v_and_b32 v237, 0xffff0000, v166
  v_lshlrev_b32 v238, 16, v167
  v_and_b32 v239, 0xffff0000, v167
  v_lshlrev_b32 v240, 16, v168
  v_and_b32 v241, 0xffff0000, v168
  v_lshlrev_b32 v242, 16, v169
  v_and_b32 v243, 0xffff0000, v169
  v_lshlrev_b32_e64 v244, 16, v170
  v_and_b32 v245, 0xffff0000, v170
  v_lshlrev_b32 v246, 16, v171
  v_and_b32 v247, 0xffff0000, v171
  v_mov_b32 v12, v162
  v_mul_f32 v14, v160, v162
  v_sub_f32 v14, 0, v14
  v_pk_fma_f32 v[16:17], v[232:233], v[12:13], v[14:15] op_sel_hi:[1,0,0]
  v_pk_fma_f32 v[18:19], v[234:235], v[12:13], v[14:15] op_sel_hi:[1,0,0]
  v_pk_fma_f32 v[20:21], v[236:237], v[12:13], v[14:15] op_sel_hi:[1,0,0]
  v_pk_fma_f32 v[22:23], v[238:239], v[12:13], v[14:15] op_sel_hi:[1,0,0]
  v_pk_fma_f32 v[24:25], v[240:241], v[12:13], v[14:15] op_sel_hi:[1,0,0]
  v_pk_fma_f32 v[26:27], v[242:243], v[12:13], v[14:15] op_sel_hi:[1,0,0]
  v_pk_fma_f32 v[28:29], v[244:245], v[12:13], v[14:15] op_sel_hi:[1,0,0]
  v_pk_fma_f32 v[30:31], v[246:247], v[12:13], v[14:15] op_sel_hi:[1,0,0]
  s_mul_i32 s68, s78, 924672
  s_add_u32 s68, s68, 6815744
  s_add_u32 s69, s21, 66048
  s_lshl_b32 s70, s64, 12
  s_nop 0
  s_add_u32 s70, s70, 65536
  v_add_u32 v218, s70, v11
  v_xor_b32 v219, 4096, v218
  s_mov_b32 s74, 400000
L_sp_24:
  s_buffer_load_dwordx8 s[28:35], s[44:47], s22 offset:131072 glc
  s_waitcnt lgkmcnt(0)
  s_xor_b64 s[28:29], s[28:29], s[0:1]
  s_xor_b64 s[30:31], s[30:31], s[0:1]
  s_xor_b64 s[32:33], s[32:33], s[0:1]
  s_xor_b64 s[34:35], s[34:35], s[0:1]
  s_or_b64 s[28:29], s[28:29], s[34:35]
  s_or_b64 s[28:29], s[28:29], s[32:33]
  s_or_b64 s[28:29], s[28:29], s[30:31]
  s_cbranch_scc0 L_spd_25
  s_sub_u32 s74, s74, 1
  s_cbranch_scc1 L_spd_25
  s_sleep 1
  s_branch L_sp_24
L_spd_25:
  buffer_load_dwordx4 v[160:163], v216, s[44:47], s68 offen sc1
  s_add_u32 s68, s68, 66048
  buffer_load_dwordx4 v[164:167], v216, s[44:47], s68 offen sc1
  s_add_u32 s68, s68, 66048
  buffer_load_dwordx4 v[168:171], v216, s[44:47], s68 offen sc1
  s_add_u32 s68, s68, 66048
  buffer_load_dwordx4 v[172:175], v216, s[44:47], s68 offen sc1
  s_add_u32 s68, s68, 66048
  buffer_load_dwordx4 v[176:179], v216, s[44:47], s68 offen sc1
  s_add_u32 s68, s68, 66048
  buffer_load_dwordx4 v[180:183], v216, s[44:47], s68 offen sc1
  s_add_u32 s68, s68, 66048
  buffer_load_dwordx4 v[184:187], v216, s[44:47], s68 offen sc1
  s_add_u32 s68, s68, 66048
  buffer_load_dwordx4 v[188:191], v217, s[44:47], s68 offen sc1
  s_add_u32 s68, s68, 66048
  s_waitcnt vmcnt(7)
  v_mfma_f32_32x32x16_bf16 v[32:47], v[52:55], v[160:163], 0
  v_mfma_f32_32x32x16_bf16 v[16:31], v[48:51], v[160:163], v[16:31]
  buffer_load_dwordx4 v[160:163], v217, s[44:47], s68 offen sc1
  s_add_u32 s68, s68, 66048
  s_waitcnt vmcnt(7)
  v_mfma_f32_32x32x16_bf16 v[32:47], v[60:63], v[164:167], v[32:47]
  v_mfma_f32_32x32x16_bf16 v[16:31], v[56:59], v[164:167], v[16:31]
  buffer_load_dwordx4 v[164:167], v217, s[44:47], s68 offen sc1
  s_add_u32 s68, s68, 66048
  s_waitcnt vmcnt(7)
  v_mfma_f32_32x32x16_bf16 v[32:47], v[68:71], v[168:171], v[32:47]
  v_mfma_f32_32x32x16_bf16 v[16:31], v[64:67], v[168:171], v[16:31]
  buffer_load_dwordx4 v[168:171], v217, s[44:47], s68 offen sc1
  s_nop 0
  s_add_u32 s68, s68, 66048
  s_waitcnt vmcnt(7)
  v_mfma_f32_32x32x16_bf16 v[32:47], v[76:79], v[172:175], v[32:47]
  v_mfma_f32_32x32x16_bf16 v[16:31], v[72:75], v[172:175], v[16:31]
  buffer_load_dwordx4 v[172:175], v217, s[44:47], s68 offen sc1
  s_add_u32 s68, s68, 66048
  s_waitcnt vmcnt(7)
  v_mfma_f32_32x32x16_bf16 v[32:47], v[84:87], v[176:179], v[32:47]
  v_mfma_f32_32x32x16_bf16 v[16:31], v[80:83], v[176:179], v[16:31]
  buffer_load_dwordx4 v[176:179], v217, s[44:47], s68 offen sc1
  s_add_u32 s68, s68, 66048
  s_waitcnt vmcnt(7)
  v_mfma_f32_32x32x16_bf16 v[32:47], v[92:95], v[180:183], v[32:47]
  v_mfma_f32_32x32x16_bf16 v[16:31], v[88:91], v[180:183], v[16:31]
  buffer_load_dwordx4 v[180:183], v217, s[44:47], s68 offen sc1
  s_waitcnt vmcnt(7)
  v_mfma_f32_32x32x16_bf16 v[32:47], v[100:103], v[184:187], v[32:47]
  v_mfma_f32_32x32x16_bf16 v[16:31], v[96:99], v[184:187], v[16:31]
  s_waitcnt vmcnt(6)
  v_mfma_f32_32x32x16_bf16 v[32:47], v[108:111], v[188:191], v[32:47]
  v_mfma_f32_32x32x16_bf16 v[16:31], v[104:107], v[188:191], v[16:31]
  s_waitcnt vmcnt(5)
  v_mfma_f32_32x32x16_bf16 v[32:47], v[116:119], v[160:163], v[32:47]
  v_mfma_f32_32x32x16_bf16 v[16:31], v[112:115], v[160:163], v[16:31]
  s_waitcnt vmcnt(4)
  v_mfma_f32_32x32x16_bf16 v[32:47], v[124:127], v[164:167], v[32:47]
  v_mfma_f32_32x32x16_bf16 v[16:31], v[120:123], v[164:167], v[16:31]
  s_waitcnt vmcnt(3)
  v_mfma_f32_32x32x16_bf16 v[32:47], v[132:135], v[168:171], v[32:47]
  v_mfma_f32_32x32x16_bf16 v[16:31], v[128:131], v[168:171], v[16:31]
  s_waitcnt vmcnt(2)
  v_mfma_f32_32x32x16_bf16 v[32:47], v[140:143], v[172:175], v[32:47]
  v_mfma_f32_32x32x16_bf16 v[16:31], v[136:139], v[172:175], v[16:31]
  s_waitcnt vmcnt(1)
  v_mfma_f32_32x32x16_bf16 v[32:47], v[148:151], v[176:179], v[32:47]
  v_mfma_f32_32x32x16_bf16 v[16:31], v[144:147], v[176:179], v[16:31]
  s_waitcnt vmcnt(0)
  s_nop 0
  v_mfma_f32_32x32x16_bf16 v[32:47], v[156:159], v[180:183], v[32:47]
  v_mfma_f32_32x32x16_bf16 v[16:31], v[152:155], v[180:183], v[16:31]
  s_nop 10
  ds_write_b128 v218, v[32:35] offset:0
  ds_write_b128 v218, v[36:39] offset:1024
  ds_write_b128 v218, v[40:43] offset:2048
  ds_write_b128 v218, v[44:47] offset:3072
  s_waitcnt lgkmcnt(0)
  s_barrier
  s_nop 0
  ds_read_b128 v[32:35], v219 offset:0
  ds_read_b128 v[36:39], v219 offset:1024
  ds_read_b128 v[40:43], v219 offset:2048
  ds_read_b128 v[44:47], v219 offset:3072
  s_waitcnt lgkmcnt(3)
  v_pk_add_f32 v[16:17], v[16:17], v[32:33]
  v_pk_add_f32 v[18:19], v[18:19], v[34:35]
  s_waitcnt lgkmcnt(2)
  v_pk_add_f32 v[20:21], v[20:21], v[36:37]
  v_pk_add_f32 v[22:23], v[22:23], v[38:39]
  s_waitcnt lgkmcnt(1)
  v_pk_add_f32 v[24:25], v[24:25], v[40:41]
  v_pk_add_f32 v[26:27], v[26:27], v[42:43]
  s_waitcnt lgkmcnt(0)
  v_pk_add_f32 v[28:29], v[28:29], v[44:45]
  v_pk_add_f32 v[30:31], v[30:31], v[46:47]
  v_cvt_pk_bf16_f32 v48, v16, v17
  v_cvt_pk_bf16_f32 v49, v18, v19
  v_cvt_pk_bf16_f32 v50, v20, v21
  v_cvt_pk_bf16_f32 v51, v22, v23
  v_cvt_pk_bf16_f32 v52, v24, v25
  v_cvt_pk_bf16_f32 v53, v26, v27
  v_cvt_pk_bf16_f32 v54, v28, v29
  v_cvt_pk_bf16_f32 v55, v30, v31
  v_permlane32_swap_b32 v48, v50
  v_permlane32_swap_b32 v49, v51
  buffer_store_dwordx4 v[48:51], v250, s[44:47], s21 offen sc1
  v_permlane32_swap_b32 v52, v54
  v_permlane32_swap_b32 v53, v55
  buffer_store_dwordx4 v[52:55], v250, s[44:47], s69 offen sc1
  v_pk_add_f32 v[224:225], v[16:17], v[18:19]
  v_pk_mul_f32 v[226:227], v[16:17], v[16:17]
  v_pk_fma_f32 v[226:227], v[18:19], v[18:19], v[226:227]
  v_pk_add_f32 v[224:225], v[224:225], v[20:21]
  v_pk_fma_f32 v[226:227], v[20:21], v[20:21], v[226:227]
  v_pk_add_f32 v[224:225], v[224:225], v[22:23]
  v_pk_fma_f32 v[226:227], v[22:23], v[22:23], v[226:227]
  v_pk_add_f32 v[224:225], v[224:225], v[24:25]
  v_pk_fma_f32 v[226:227], v[24:25], v[24:25], v[226:227]
  v_pk_add_f32 v[224:225], v[224:225], v[26:27]
  v_pk_fma_f32 v[226:227], v[26:27], v[26:27], v[226:227]
  v_pk_add_f32 v[224:225], v[224:225], v[28:29]
  v_pk_fma_f32 v[226:227], v[28:29], v[28:29], v[226:227]
  v_pk_add_f32 v[224:225], v[224:225], v[30:31]
  v_pk_fma_f32 v[226:227], v[30:31], v[30:31], v[226:227]
  v_add_f32 v224, v224, v225
  v_add_f32 v226, v226, v227
  v_mov_b32 v225, v224
  v_mov_b32 v227, v226
  s_nop 0
  v_permlane32_swap_b32 v224, v225
  v_permlane32_swap_b32 v226, v227
  v_add_f32 v220, v224, v225
  v_add_f32_e64 v221, v226, v227
  buffer_store_dwordx2 v[220:221], v222, s[44:47], s25 offen sc1
  v_pk_add_f32 v[232:233], v[232:233], v[16:17]
  v_pk_add_f32 v[234:235], v[234:235], v[18:19]
  v_pk_add_f32 v[236:237], v[236:237], v[20:21]
  v_pk_add_f32 v[238:239], v[238:239], v[22:23]
  v_pk_add_f32 v[240:241], v[240:241], v[24:25]
  v_pk_add_f32 v[242:243], v[242:243], v[26:27]
  v_pk_add_f32 v[244:245], v[244:245], v[28:29]
  v_pk_add_f32 v[246:247], v[246:247], v[30:31]
  s_mov_b32 m0, s91
  s_nop 0
  buffer_load_dwordx4 v194, s[48:51], s84 offen offset:0 lds
  buffer_load_dwordx4 v195, s[48:51], s84 offen offset:1024 lds
  buffer_load_dwordx4 v196, s[48:51], s84 offen offset:2048 lds
  s_waitcnt vmcnt(3)
  s_barrier
  s_cmp_lg_u32 s64, 0
  s_cbranch_scc1 L_post_26
  buffer_store_dwordx2 v[6:7], v254, s[44:47], 0 offen sc1
L_post_26:
  buffer_load_dwordx4 v197, s[48:51], s84 offen offset:3072 lds
  s_add_u32 m0, s91, 16384
  s_nop 0
  buffer_load_dwordx4 v194, s[48:51], s85 offen offset:0 lds
  buffer_load_dwordx4 v195, s[48:51], s85 offen offset:1024 lds
  s_waitcnt vmcnt(5)
  buffer_load_dwordx4 v196, s[48:51], s85 offen offset:2048 lds
  s_waitcnt vmcnt(5)
  buffer_load_dwordx4 v197, s[48:51], s85 offen offset:3072 lds
  s_waitcnt vmcnt(5)
  s_add_u32 m0, s91, 32768
  s_nop 0
  s_nop 0
  buffer_load_dwordx4 v194, s[48:51], s86 offen offset:0 lds
  s_waitcnt vmcnt(5)
  buffer_load_dwordx4 v195, s[48:51], s86 offen offset:1024 lds
  s_waitcnt vmcnt(5)
  buffer_load_dwordx4 v196, s[48:51], s86 offen offset:2048 lds
  s_waitcnt vmcnt(5)
  buffer_load_dwordx4 v197, s[48:51], s86 offen offset:3072 lds
  s_waitcnt vmcnt(5)
  s_add_u32 m0, s91, 49152
  s_nop 0
  s_nop 0
  buffer_load_dwordx4 v194, s[48:51], s87 offen offset:0 lds
  s_waitcnt vmcnt(5)
  buffer_load_dwordx4 v195, s[48:51], s87 offen offset:1024 lds
  s_waitcnt vmcnt(5)
  buffer_load_dwordx4 v196, s[48:51], s87 offen offset:2048 lds
  s_waitcnt vmcnt(5)
  buffer_load_dwordx4 v197, s[48:51], s87 offen offset:3072 lds
  s_waitcnt vmcnt(5)
  s_add_u32 m0, s91, 65536
  s_nop 0
  s_nop 0
  buffer_load_dwordx4 v194, s[48:51], s88 offen offset:0 lds
  s_waitcnt vmcnt(5)
  buffer_load_dwordx4 v195, s[48:51], s88 offen offset:1024 lds
  s_waitcnt vmcnt(5)
  buffer_load_dwordx4 v196, s[48:51], s88 offen offset:2048 lds
  s_waitcnt vmcnt(5)
  buffer_load_dwordx4 v197, s[48:51], s88 offen offset:3072 lds
  s_mov_b32 s74, 400000
L_sp_27:
  s_buffer_load_dwordx16 s[28:43], s[44:47], s23 offset:188416 glc
  s_waitcnt lgkmcnt(0)
  s_xor_b64 s[28:29], s[28:29], s[0:1]
  s_xor_b64 s[30:31], s[30:31], s[0:1]
  s_xor_b64 s[32:33], s[32:33], s[0:1]
  s_xor_b64 s[34:35], s[34:35], s[0:1]
  s_xor_b64 s[36:37], s[36:37], s[0:1]
  s_xor_b64 s[38:39], s[38:39], s[0:1]
  s_xor_b64 s[40:41], s[40:41], s[0:1]
  s_or_b64 s[28:29], s[28:29], s[40:41]
  s_or_b64 s[28:29], s[28:29], s[38:39]
  s_or_b64 s[28:29], s[28:29], s[36:37]
  s_or_b64 s[28:29], s[28:29], s[34:35]
  s_or_b64 s[28:29], s[28:29], s[32:33]
  s_or_b64 s[28:29], s[28:29], s[30:31]
  s_cbranch_scc0 L_spd_28
  s_sub_u32 s74, s74, 1
  s_cbranch_scc1 L_spd_28
  s_sleep 1
  s_branch L_sp_27
L_spd_28:
  buffer_load_dwordx4 v[80:83], v214, s[44:47], s92 offen sc1
  s_add_u32 s68, s92, 66048
  buffer_load_dwordx4 v[84:87], v214, s[44:47], s68 offen sc1
  s_add_u32 s68, s92, 132096
  buffer_load_dwordx4 v[88:91], v214, s[44:47], s68 offen sc1
  s_add_u32 s68, s92, 198144
  buffer_load_dwordx4 v[92:95], v214, s[44:47], s68 offen sc1
  buffer_load_dwordx4 v[96:99], v214, s[44:47], s93 offen sc1
  s_add_u32 s68, s93, 66048
  buffer_load_dwordx4 v[100:103], v214, s[44:47], s68 offen sc1
  s_barrier
  ds_read_b64_tr_b16 v[144:145], v198 offset:0
  ds_read_b64_tr_b16 v[146:147], v198 offset:1024
  ds_read_b64_tr_b16 v[148:149], v199 offset:0
  ds_read_b64_tr_b16 v[150:151], v199 offset:1024
  s_nop 0
  ds_read_b64_tr_b16 v[152:153], v200 offset:0
  ds_read_b64_tr_b16 v[154:155], v200 offset:1024
  ds_read_b64_tr_b16 v[156:157], v201 offset:0
  ds_read_b64_tr_b16 v[158:159], v201 offset:1024
  s_waitcnt vmcnt(5) lgkmcnt(0)
  v_mfma_f32_32x32x16_bf16 v[16:31], v[144:147], v[80:83], 0
  ds_read_b64_tr_b16 v[160:161], v198 offset:4096
  ds_read_b64_tr_b16 v[162:163], v198 offset:5120
  s_nop 0
  ds_read_b64_tr_b16 v[164:165], v199 offset:4096
  ds_read_b64_tr_b16 v[166:167], v199 offset:5120
  v_mfma_f32_32x32x16_bf16 v[32:47], v[148:151], v[80:83], 0
  ds_read_b64_tr_b16 v[168:169], v200 offset:4096
  ds_read_b64_tr_b16 v[170:171], v200 offset:5120
  ds_read_b64_tr_b16 v[172:173], v201 offset:4096
  ds_read_b64_tr_b16 v[174:175], v201 offset:5120
  v_mfma_f32_32x32x16_bf16 v[48:63], v[152:155], v[80:83], 0
  s_add_u32 s68, s93, 132096
  buffer_load_dwordx4 v[104:107], v214, s[44:47], s68 offen sc1
  v_mfma_f32_32x32x16_bf16 v[64:79], v[156:159], v[80:83], 0
  s_add_u32 s68, s93, 198144
  buffer_load_dwordx4 v[108:111], v214, s[44:47], s68 offen sc1
  s_waitcnt vmcnt(6) lgkmcnt(0)
  v_mfma_f32_32x32x16_bf16 v[16:31], v[160:163], v[84:87], v[16:31]
  ds_read_b64_tr_b16 v[144:145], v198 offset:8192
  s_nop 0
  ds_read_b64_tr_b16 v[146:147], v198 offset:9216
  ds_read_b64_tr_b16 v[148:149], v199 offset:8192
  ds_read_b64_tr_b16 v[150:151], v199 offset:9216
  v_mfma_f32_32x32x16_bf16 v[32:47], v[164:167], v[84:87], v[32:47]
  ds_read_b64_tr_b16 v[152:153], v200 offset:8192
  ds_read_b64_tr_b16 v[154:155], v200 offset:9216
  ds_read_b64_tr_b16 v[156:157], v201 offset:8192
  ds_read_b64_tr_b16 v[158:159], v201 offset:9216
  v_mfma_f32_32x32x16_bf16 v[48:63], v[168:171], v[84:87], v[48:63]
  buffer_load_dwordx4 v[112:115], v214, s[44:47], s94 offen sc1
  v_mfma_f32_32x32x16_bf16 v[64:79], v[172:175], v[84:87], v[64:79]
  s_add_u32 s68, s94, 66048
  buffer_load_dwordx4 v[116:119], v214, s[44:47], s68 offen sc1
  s_waitcnt vmcnt(7) lgkmcnt(0)
  v_mfma_f32_32x32x16_bf16 v[16:31], v[144:147], v[88:91], v[16:31]
  ds_read_b64_tr_b16 v[160:161], v198 offset:12288
  s_nop 0
  ds_read_b64_tr_b16 v[162:163], v198 offset:13312
  ds_read_b64_tr_b16 v[164:165], v199 offset:12288
  ds_read_b64_tr_b16 v[166:167], v199 offset:13312
  v_mfma_f32_32x32x16_bf16 v[32:47], v[148:151], v[88:91], v[32:47]
  ds_read_b64_tr_b16 v[168:169], v200 offset:12288
  ds_read_b64_tr_b16 v[170:171], v200 offset:13312
  ds_read_b64_tr_b16 v[172:173], v201 offset:12288
  ds_read_b64_tr_b16 v[174:175], v201 offset:13312
  v_mfma_f32_32x32x16_bf16 v[48:63], v[152:155], v[88:91], v[48:63]
  s_add_u32 s68, s94, 132096
  buffer_load_dwordx4 v[120:123], v214, s[44:47], s68 offen sc1
  v_mfma_f32_32x32x16_bf16 v[64:79], v[156:159], v[88:91], v[64:79]
  s_add_u32 s68, s94, 198144
  buffer_load_dwordx4 v[124:127], v214, s[44:47], s68 offen sc1
  s_waitcnt vmcnt(8) lgkmcnt(0)
  s_barrier
  v_mfma_f32_32x32x16_bf16 v[16:31], v[160:163], v[92:95], v[16:31]
  ds_read_b64_tr_b16 v[144:145], v198 offset:16384
  ds_read_b64_tr_b16 v[146:147], v198 offset:17408
  ds_read_b64_tr_b16 v[148:149], v199 offset:16384
  ds_read_b64_tr_b16 v[150:151], v199 offset:17408
  v_mfma_f32_32x32x16_bf16 v[32:47], v[164:167], v[92:95], v[32:47]
  ds_read_b64_tr_b16 v[152:153], v200 offset:16384
  ds_read_b64_tr_b16 v[154:155], v200 offset:17408
  ds_read_b64_tr_b16 v[156:157], v201 offset:16384
  ds_read_b64_tr_b16 v[158:159], v201 offset:17408
  v_mfma_f32_32x32x16_bf16 v[48:63], v[168:171], v[92:95], v[48:63]
  s_mov_b32 m0, s91
  s_nop 0
  buffer_load_dwordx4 v194, s[48:51], s89 offen offset:0 lds
  buffer_load_dwordx4 v195, s[48:51], s89 offen offset:1024 lds
  v_mfma_f32_32x32x16_bf16 v[64:79], v[172:175], v[92:95], v[64:79]
  buffer_load_dwordx4 v[128:131], v214, s[44:47], s95 offen sc1
  s_add_u32 s68, s95, 66048
  buffer_load_dwordx4 v[132:135], v214, s[44:47], s68 offen sc1
  s_waitcnt vmcnt(11) lgkmcnt(0)
  v_mfma_f32_32x32x16_bf16 v[16:31], v[144:147], v[96:99], v[16:31]
  ds_read_b64_tr_b16 v[160:161], v198 offset:20480
  ds_read_b64_tr_b16 v[162:163], v198 offset:21504
  ds_read_b64_tr_b16 v[164:165], v199 offset:20480
  ds_read_b64_tr_b16 v[166:167], v199 offset:21504
  v_mfma_f32_32x32x16_bf16 v[32:47], v[148:151], v[96:99], v[32:47]
  s_nop 0
  ds_read_b64_tr_b16 v[168:169], v200 offset:20480
  ds_read_b64_tr_b16 v[170:171], v200 offset:21504
  ds_read_b64_tr_b16 v[172:173], v201 offset:20480
  ds_read_b64_tr_b16 v[174:175], v201 offset:21504
  v_mfma_f32_32x32x16_bf16 v[48:63], v[152:155], v[96:99], v[48:63]
  buffer_load_dwordx4 v196, s[48:51], s89 offen offset:2048 lds
  buffer_load_dwordx4 v197, s[48:51], s89 offen offset:3072 lds
  v_mfma_f32_32x32x16_bf16 v[64:79], v[156:159], v[96:99], v[64:79]
  s_add_u32 s68, s95, 132096
  buffer_load_dwordx4 v[136:139], v214, s[44:47], s68 offen sc1
  s_add_u32 s68, s95, 198144
  buffer_load_dwordx4 v[140:143], v214, s[44:47], s68 offen sc1
  s_waitcnt vmcnt(14) lgkmcnt(0)
  v_mfma_f32_32x32x16_bf16 v[16:31], v[160:163], v[100:103], v[16:31]
  ds_read_b64_tr_b16 v[144:145], v198 offset:24576
  ds_read_b64_tr_b16 v[146:147], v198 offset:25600
  s_nop 0
  ds_read_b64_tr_b16 v[148:149], v199 offset:24576
  ds_read_b64_tr_b16 v[150:151], v199 offset:25600
  v_mfma_f32_32x32x16_bf16 v[32:47], v[164:167], v[100:103], v[32:47]
  ds_read_b64_tr_b16 v[152:153], v200 offset:24576
  ds_read_b64_tr_b16 v[154:155], v200 offset:25600
  ds_read_b64_tr_b16 v[156:157], v201 offset:24576
  ds_read_b64_tr_b16 v[158:159], v201 offset:25600
  v_mfma_f32_32x32x16_bf16 v[48:63], v[168:171], v[100:103], v[48:63]
  buffer_load_dwordx4 v[80:83], v214, s[44:47], s96 offen sc1
  v_mfma_f32_32x32x16_bf16 v[64:79], v[172:175], v[100:103], v[64:79]
  s_add_u32 s68, s96, 66048
  buffer_load_dwordx4 v[84:87], v214, s[44:47], s68 offen sc1
  s_waitcnt vmcnt(15) lgkmcnt(0)
  v_mfma_f32_32x32x16_bf16 v[16:31], v[144:147], v[104:107], v[16:31]
  ds_read_b64_tr_b16 v[160:161], v198 offset:28672
  ds_read_b64_tr_b16 v[162:163], v198 offset:29696
  s_nop 0
  ds_read_b64_tr_b16 v[164:165], v199 offset:28672
  ds_read_b64_tr_b16 v[166:167], v199 offset:29696
  v_mfma_f32_32x32x16_bf16 v[32:47], v[148:151], v[104:107], v[32:47]
  ds_read_b64_tr_b16 v[168:169], v200 offset:28672
  ds_read_b64_tr_b16 v[170:171], v200 offset:29696
  ds_read_b64_tr_b16 v[172:173], v201 offset:28672
  ds_read_b64_tr_b16 v[174:175], v201 offset:29696
  v_mfma_f32_32x32x16_bf16 v[48:63], v[152:155], v[104:107], v[48:63]
  s_add_u32 s68, s96, 132096
  buffer_load_dwordx4 v[88:91], v214, s[44:47], s68 offen sc1
  v_mfma_f32_32x32x16_bf16 v[64:79], v[156:159], v[104:107], v[64:79]
  s_add_u32 s68, s96, 198144
  buffer_load_dwordx4 v[92:95], v214, s[44:47], s68 offen sc1
  s_waitcnt vmcnt(16) lgkmcnt(0)
  s_barrier
  v_mfma_f32_32x32x16_bf16 v[16:31], v[160:163], v[108:111], v[16:31]
  ds_read_b64_tr_b16 v[144:145], v198 offset:32768
  ds_read_b64_tr_b16 v[146:147], v198 offset:33792
  ds_read_b64_tr_b16 v[148:149], v199 offset:32768
  ds_read_b64_tr_b16 v[150:151], v199 offset:33792
  v_mfma_f32_32x32x16_bf16 v[32:47], v[164:167], v[108:111], v[32:47]
  ds_read_b64_tr_b16 v[152:153], v200 offset:32768
  ds_read_b64_tr_b16 v[154:155], v200 offset:33792
  ds_read_b64_tr_b16 v[156:157], v201 offset:32768
  ds_read_b64_tr_b16 v[158:159], v201 offset:33792
  v_mfma_f32_32x32x16_bf16 v[48:63], v[168:171], v[108:111], v[48:63]
  s_add_u32 m0, s91, 16384
  s_nop 0
  buffer_load_dwordx4 v194, s[48:51], s90 offen offset:0 lds
  buffer_load_dwordx4 v195, s[48:51], s90 offen offset:1024 lds
  v_mfma_f32_32x32x16_bf16 v[64:79], v[172:175], v[108:111], v[64:79]
  buffer_load_dwordx4 v[96:99], v214, s[44:47], s97 offen sc1
  s_lshl_b32 s68, s83, 4
  s_add_u32 s68, s68, 376832
  v_and_b32 v10, 1, v1
  v_lshl_add_u32 v10, v10, 3, s68
  buffer_load_dwordx2 v[8:9], v10, s[44:47], 0 offen sc1
  s_waitcnt vmcnt(19) lgkmcnt(0)
  v_mfma_f32_32x32x16_bf16 v[16:31], v[144:147], v[112:115], v[16:31]
  ds_read_b64_tr_b16 v[160:161], v198 offset:36864
  ds_read_b64_tr_b16 v[162:163], v198 offset:37888
  ds_read_b64_tr_b16 v[164:165], v199 offset:36864
  ds_read_b64_tr_b16 v[166:167], v199 offset:37888
  v_mfma_f32_32x32x16_bf16 v[32:47], v[148:151], v[112:115], v[32:47]
  ds_read_b64_tr_b16 v[168:169], v200 offset:36864
  ds_read_b64_tr_b16 v[170:171], v200 offset:37888
  ds_read_b64_tr_b16 v[172:173], v201 offset:36864
  ds_read_b64_tr_b16 v[174:175], v201 offset:37888
  v_mfma_f32_32x32x16_bf16 v[48:63], v[152:155], v[112:115], v[48:63]
  buffer_load_dwordx4 v196, s[48:51], s90 offen offset:2048 lds
  buffer_load_dwordx4 v197, s[48:51], s90 offen offset:3072 lds
  v_mfma_f32_32x32x16_bf16 v[64:79], v[156:159], v[112:115], v[64:79]
  s_add_u32 s68, s97, 66048
  buffer_load_dwordx4 v[100:103], v214, s[44:47], s68 offen sc1
  s_waitcnt vmcnt(21) lgkmcnt(0)
  v_mfma_f32_32x32x16_bf16 v[16:31], v[160:163], v[116:119], v[16:31]
  ds_read_b64_tr_b16 v[144:145], v198 offset:40960
  ds_read_b64_tr_b16 v[146:147], v198 offset:41984
  ds_read_b64_tr_b16 v[148:149], v199 offset:40960
  s_nop 0
  ds_read_b64_tr_b16 v[150:151], v199 offset:41984
  v_mfma_f32_32x32x16_bf16 v[32:47], v[164:167], v[116:119], v[32:47]
  ds_read_b64_tr_b16 v[152:153], v200 offset:40960
  ds_read_b64_tr_b16 v[154:155], v200 offset:41984
  ds_read_b64_tr_b16 v[156:157], v201 offset:40960
  ds_read_b64_tr_b16 v[158:159], v201 offset:41984
  v_mfma_f32_32x32x16_bf16 v[48:63], v[168:171], v[116:119], v[48:63]
  s_add_u32 s68, s97, 132096
  buffer_load_dwordx4 v[104:107], v214, s[44:47], s68 offen sc1
  v_mfma_f32_32x32x16_bf16 v[64:79], v[172:175], v[116:119], v[64:79]
  buffer_load_dwordx2 v[176:177], v215, s[44:47], s79 offen sc1
  s_waitcnt vmcnt(22) lgkmcnt(0)
  v_mfma_f32_32x32x16_bf16 v[16:31], v[144:147], v[120:123], v[16:31]
  ds_read_b64_tr_b16 v[160:161], v198 offset:45056
  ds_read_b64_tr_b16 v[162:163], v198 offset:46080
  ds_read_b64_tr_b16 v[164:165], v199 offset:45056
  s_nop 0
  ds_read_b64_tr_b16 v[166:167], v199 offset:46080
  v_mfma_f32_32x32x16_bf16 v[32:47], v[148:151], v[120:123], v[32:47]
  ds_read_b64_tr_b16 v[168:169], v200 offset:45056
  ds_read_b64_tr_b16 v[170:171], v200 offset:46080
  ds_read_b64_tr_b16 v[172:173], v201 offset:45056
  ds_read_b64_tr_b16 v[174:175], v201 offset:46080
  v_mfma_f32_32x32x16_bf16 v[48:63], v[152:155], v[120:123], v[48:63]
  s_add_u32 s68, s97, 198144
  buffer_load_dwordx4 v[108:111], v214, s[44:47], s68 offen sc1
  v_mfma_f32_32x32x16_bf16 v[64:79], v[156:159], v[120:123], v[64:79]
  s_add_u32 s79, s79, 16384
  buffer_load_dwordx2 v[178:179], v215, s[44:47], s79 offen sc1
  s_waitcnt vmcnt(23) lgkmcnt(0)
  s_barrier
  v_mfma_f32_32x32x16_bf16 v[16:31], v[160:163], v[124:127], v[16:31]
  ds_read_b64_tr_b16 v[144:145], v198 offset:49152
  ds_read_b64_tr_b16 v[146:147], v198 offset:50176
  ds_read_b64_tr_b16 v[148:149], v199 offset:49152
  ds_read_b64_tr_b16 v[150:151], v199 offset:50176
  v_mfma_f32_32x32x16_bf16 v[32:47], v[164:167], v[124:127], v[32:47]
  ds_read_b64_tr_b16 v[152:153], v200 offset:49152
  ds_read_b64_tr_b16 v[154:155], v200 offset:50176
  ds_read_b64_tr_b16 v[156:157], v201 offset:49152
  ds_read_b64_tr_b16 v[158:159], v201 offset:50176
  v_mfma_f32_32x32x16_bf16 v[48:63], v[168:171], v[124:127], v[48:63]
  buffer_load_dwordx4 v[112:115], v214, s[44:47], s98 offen sc1
  v_mfma_f32_32x32x16_bf16 v[64:79], v[172:175], v[124:127], v[64:79]
  s_add_u32 s79, s79, 16384
  buffer_load_dwordx2 v[180:181], v215, s[44:47], s79 offen sc1
  s_waitcnt vmcnt(22) lgkmcnt(0)
  v_mfma_f32_32x32x16_bf16 v[16:31], v[144:147], v[128:131], v[16:31]
  ds_read_b64_tr_b16 v[160:161], v198 offset:53248
  ds_read_b64_tr_b16 v[162:163], v198 offset:54272
  s_nop 0
  ds_read_b64_tr_b16 v[164:165], v199 offset:53248
  ds_read_b64_tr_b16 v[166:167], v199 offset:54272
  v_mfma_f32_32x32x16_bf16 v[32:47], v[148:151], v[128:131], v[32:47]
  ds_read_b64_tr_b16 v[168:169], v200 offset:53248
  ds_read_b64_tr_b16 v[170:171], v200 offset:54272
  ds_read_b64_tr_b16 v[172:173], v201 offset:53248
  ds_read_b64_tr_b16 v[174:175], v201 offset:54272
  v_mfma_f32_32x32x16_bf16 v[48:63], v[152:155], v[128:131], v[48:63]
  s_add_u32 s68, s98, 66048
  buffer_load_dwordx4 v[116:119], v214, s[44:47], s68 offen sc1
  v_mfma_f32_32x32x16_bf16 v[64:79], v[156:159], v[128:131], v[64:79]
  s_add_u32 s79, s79, 16384
  buffer_load_dwordx2 v[182:183], v215, s[44:47], s79 offen sc1
  s_waitcnt vmcnt(23) lgkmcnt(0)
  v_mfma_f32_32x32x16_bf16 v[16:31], v[160:163], v[132:135], v[16:31]
  ds_read_b64_tr_b16 v[144:145], v198 offset:57344
  s_nop 0
  ds_read_b64_tr_b16 v[146:147], v198 offset:58368
  ds_read_b64_tr_b16 v[148:149], v199 offset:57344
  ds_read_b64_tr_b16 v[150:151], v199 offset:58368
  v_mfma_f32_32x32x16_bf16 v[32:47], v[164:167], v[132:135], v[32:47]
  ds_read_b64_tr_b16 v[152:153], v200 offset:57344
  ds_read_b64_tr_b16 v[154:155], v200 offset:58368
  ds_read_b64_tr_b16 v[156:157], v201 offset:57344
  ds_read_b64_tr_b16 v[158:159], v201 offset:58368
  v_mfma_f32_32x32x16_bf16 v[48:63], v[168:171], v[132:135], v[48:63]
  s_add_u32 s68, s98, 132096
  buffer_load_dwordx4 v[120:123], v214, s[44:47], s68 offen sc1
  s_add_u32 s79, s79, 16384
  buffer_load_dwordx2 v[184:185], v215, s[44:47], s79 offen sc1
  v_mfma_f32_32x32x16_bf16 v[64:79], v[172:175], v[132:135], v[64:79]
  s_waitcnt vmcnt(13)
  v_cmp_ne_u64 vcc, v[8:9], v[6:7]
  s_nop 4
  s_cbranch_vccz L_cc_29
  s_mov_b32 s74, 400000
L_po_30:
  buffer_load_dwordx2 v[8:9], v10, s[44:47], 0 offen sc1
  s_waitcnt vmcnt(0)
  v_cmp_ne_u64 vcc, v[8:9], v[6:7]
  s_nop 4
  s_cbranch_vccz L_pod_31
  s_sub_u32 s74, s74, 1
  s_cbranch_scc1 L_pod_31
  s_sleep 1
  s_branch L_po_30
L_pod_31:
L_cc_29:
  s_lshl_b32 s68, s83, 9
  s_add_u32 s68, s68, 20029440
  v_lshlrev_b32 v206, 3, v1
  buffer_load_dwordx2 v[210:211], v206, s[44:47], s68 offen sc1
  s_waitcnt lgkmcnt(0)
  v_mfma_f32_32x32x16_bf16 v[16:31], v[144:147], v[136:139], v[16:31]
  ds_read_b64_tr_b16 v[160:161], v198 offset:61440
  ds_read_b64_tr_b16 v[162:163], v198 offset:62464
  ds_read_b64_tr_b16 v[164:165], v199 offset:61440
  ds_read_b64_tr_b16 v[166:167], v199 offset:62464
  v_mfma_f32_32x32x16_bf16 v[32:47], v[148:151], v[136:139], v[32:47]
  s_nop 0
  ds_read_b64_tr_b16 v[168:169], v200 offset:61440
  ds_read_b64_tr_b16 v[170:171], v200 offset:62464
  ds_read_b64_tr_b16 v[172:173], v201 offset:61440
  ds_read_b64_tr_b16 v[174:175], v201 offset:62464
  v_mfma_f32_32x32x16_bf16 v[48:63], v[152:155], v[136:139], v[48:63]
  s_add_u32 s68, s98, 198144
  buffer_load_dwordx4 v[124:127], v214, s[44:47], s68 offen sc1
  v_mfma_f32_32x32x16_bf16 v[64:79], v[156:159], v[136:139], v[64:79]
  s_add_u32 s79, s79, 16384
  buffer_load_dwordx2 v[186:187], v215, s[44:47], s79 offen sc1
  s_waitcnt lgkmcnt(0)
  s_barrier
  v_add_u32 v198, 0x10000, v198
  v_add_u32 v199, 0x10000, v199
  v_add_u32 v200, 0x10000, v200
  v_add_u32 v201, 0x10000, v201
  v_mfma_f32_32x32x16_bf16 v[16:31], v[160:163], v[140:143], v[16:31]
  ds_read_b64_tr_b16 v[144:145], v198 offset:0
  ds_read_b64_tr_b16 v[146:147], v198 offset:1024
  ds_read_b64_tr_b16 v[148:149], v199 offset:0
  ds_read_b64_tr_b16 v[150:151], v199 offset:1024
  v_mfma_f32_32x32x16_bf16 v[32:47], v[164:167], v[140:143], v[32:47]
  ds_read_b64_tr_b16 v[152:153], v200 offset:0
  ds_read_b64_tr_b16 v[154:155], v200 offset:1024
  ds_read_b64_tr_b16 v[156:157], v201 offset:0
  ds_read_b64_tr_b16 v[158:159], v201 offset:1024
  v_mfma_f32_32x32x16_bf16 v[48:63], v[168:171], v[140:143], v[48:63]
  s_add_u32 s79, s79, 16384
  buffer_load_dwordx2 v[188:189], v215, s[44:47], s79 offen sc1
  v_mfma_f32_32x32x16_bf16 v[64:79], v[172:175], v[140:143], v[64:79]
  s_waitcnt lgkmcnt(0)
  v_mfma_f32_32x32x16_bf16 v[16:31], v[144:147], v[80:83], v[16:31]
  ds_read_b64_tr_b16 v[160:161], v198 offset:4096
  s_nop 0
  ds_read_b64_tr_b16 v[162:163], v198 offset:5120
  ds_read_b64_tr_b16 v[164:165], v199 offset:4096
  ds_read_b64_tr_b16 v[166:167], v199 offset:5120
  v_mfma_f32_32x32x16_bf16 v[32:47], v[148:151], v[80:83], v[32:47]
  ds_read_b64_tr_b16 v[168:169], v200 offset:4096
  ds_read_b64_tr_b16 v[170:171], v200 offset:5120
  ds_read_b64_tr_b16 v[172:173], v201 offset:4096
  ds_read_b64_tr_b16 v[174:175], v201 offset:5120
  v_mfma_f32_32x32x16_bf16 v[48:63], v[152:155], v[80:83], v[48:63]
  s_lshl_b32 s69, s66, 2
  s_add_u32 s69, s69, s64
  s_mul_i32 s70, s69, 14336
  s_mul_i32 s71, s69, 3584
  s_and_b32 s69, s65, 1
  s_mul_i32 s69, s69, 7168
  v_min_u32 v193, 55, v1
  v_lshlrev_b32 v193, 7, v193
  s_add_u32 s72, s70, s69
  buffer_load_dword v192, v193, s[52:55], s72 offen
  v_mfma_f32_32x32x16_bf16 v[64:79], v[156:159], v[80:83], v[64:79]
  s_waitcnt lgkmcnt(0)
  v_mfma_f32_32x32x16_bf16 v[16:31], v[160:163], v[84:87], v[16:31]
  ds_read_b64_tr_b16 v[144:145], v198 offset:8192
  ds_read_b64_tr_b16 v[146:147], v198 offset:9216
  ds_read_b64_tr_b16 v[148:149], v199 offset:8192
  ds_read_b64_tr_b16 v[150:151], v199 offset:9216
  v_mfma_f32_32x32x16_bf16 v[32:47], v[164:167], v[84:87], v[32:47]
  s_nop 0
  ds_read_b64_tr_b16 v[152:153], v200 offset:8192
  ds_read_b64_tr_b16 v[154:155], v200 offset:9216
  ds_read_b64_tr_b16 v[156:157], v201 offset:8192
  ds_read_b64_tr_b16 v[158:159], v201 offset:9216
  v_mfma_f32_32x32x16_bf16 v[48:63], v[168:171], v[84:87], v[48:63]
  v_mfma_f32_32x32x16_bf16 v[64:79], v[172:175], v[84:87], v[64:79]
  s_waitcnt lgkmcnt(0)
  v_mfma_f32_32x32x16_bf16 v[16:31], v[144:147], v[88:91], v[16:31]
  s_nop 0
  ds_read_b64_tr_b16 v[160:161], v198 offset:12288
  ds_read_b64_tr_b16 v[162:163], v198 offset:13312
  ds_read_b64_tr_b16 v[164:165], v199 offset:12288
  ds_read_b64_tr_b16 v[166:167], v199 offset:13312
  v_mfma_f32_32x32x16_bf16 v[32:47], v[148:151], v[88:91], v[32:47]
  ds_read_b64_tr_b16 v[168:169], v200 offset:12288
  ds_read_b64_tr_b16 v[170:171], v200 offset:13312
  ds_read_b64_tr_b16 v[172:173], v201 offset:12288
  ds_read_b64_tr_b16 v[174:175], v201 offset:13312
  v_mfma_f32_32x32x16_bf16 v[48:63], v[152:155], v[88:91], v[48:63]
  s_waitcnt vmcnt(1)
  v_add_f32 v176, v176, v178
  v_add_f32 v177, v177, v179
  v_add_f32 v176, v176, v180
  v_add_f32 v177, v177, v181
  v_mfma_f32_32x32x16_bf16 v[64:79], v[156:159], v[88:91], v[64:79]
  v_add_f32 v176, v176, v182
  v_add_f32 v177, v177, v183
  v_add_f32 v176, v176, v184
  v_add_f32 v177, v177, v185
  s_waitcnt lgkmcnt(0)
  s_barrier
  v_subrev_u32 v198, 0x10000, v198
  v_subrev_u32 v199, 0x10000, v199
  v_subrev_u32 v200, 0x10000, v200
  v_subrev_u32 v201, 0x10000, v201
  v_mfma_f32_32x32x16_bf16 v[16:31], v[160:163], v[92:95], v[16:31]
  ds_read_b64_tr_b16 v[144:145], v198 offset:0
  ds_read_b64_tr_b16 v[146:147], v198 offset:1024
  s_nop 0
  ds_read_b64_tr_b16 v[148:149], v199 offset:0
  ds_read_b64_tr_b16 v[150:151], v199 offset:1024
  v_mfma_f32_32x32x16_bf16 v[32:47], v[164:167], v[92:95], v[32:47]
  ds_read_b64_tr_b16 v[152:153], v200 offset:0
  ds_read_b64_tr_b16 v[154:155], v200 offset:1024
  ds_read_b64_tr_b16 v[156:157], v201 offset:0
  ds_read_b64_tr_b16 v[158:159], v201 offset:1024
  v_mfma_f32_32x32x16_bf16 v[48:63], v[168:171], v[92:95], v[48:63]
  s_sub_u32 s72, s70, s69
  s_add_u32 s72, s72, 7168
  buffer_load_dword v192, v193, s[52:55], s72 offen
  v_add_f32 v176, v176, v186
  v_add_f32 v177, v177, v187
  v_add_f32 v176, v176, v188
  v_add_f32 v177, v177, v189
  v_mfma_f32_32x32x16_bf16 v[64:79], v[172:175], v[92:95], v[64:79]
  v_mov_b32 v178, v176
  v_mov_b32 v179, v177
  s_nop 0
  v_permlane32_swap_b32 v176, v178
  v_permlane32_swap_b32 v177, v179
  s_waitcnt lgkmcnt(0)
  v_mfma_f32_32x32x16_bf16 v[16:31], v[144:147], v[96:99], v[16:31]
  ds_read_b64_tr_b16 v[160:161], v198 offset:4096
  ds_read_b64_tr_b16 v[162:163], v198 offset:5120
  ds_read_b64_tr_b16 v[164:165], v199 offset:4096
  ds_read_b64_tr_b16 v[166:167], v199 offset:5120
  v_mfma_f32_32x32x16_bf16 v[32:47], v[148:151], v[96:99], v[32:47]
  ds_read_b64_tr_b16 v[168:169], v200 offset:4096
  s_nop 0
  ds_read_b64_tr_b16 v[170:171], v200 offset:5120
  ds_read_b64_tr_b16 v[172:173], v201 offset:4096
  ds_read_b64_tr_b16 v[174:175], v201 offset:5120
  v_mfma_f32_32x32x16_bf16 v[48:63], v[152:155], v[96:99], v[48:63]
  v_add_f32 v176, v176, v178
  v_add_f32 v177, v177, v179
  v_mul_f32 v176, 0x3b124925, v176
  v_mul_f32 v177, 0x3b124925, v177
  v_mfma_f32_32x32x16_bf16 v[64:79], v[156:159], v[96:99], v[64:79]
  v_fma_f32 v177, -v176, v176, v177
  v_max_f32 v177, 0, v177
  v_add_f32 v177, 0x3727c5ac, v177
  v_rsq_f32 v12, v177
  v_sub_f32 v14, 0, v176
  s_waitcnt lgkmcnt(0)
  v_mfma_f32_32x32x16_bf16 v[16:31], v[160:163], v[100:103], v[16:31]
  ds_read_b64_tr_b16 v[144:145], v198 offset:8192
  ds_read_b64_tr_b16 v[146:147], v198 offset:9216
  ds_read_b64_tr_b16 v[148:149], v199 offset:8192
  ds_read_b64_tr_b16 v[150:151], v199 offset:9216
  v_mfma_f32_32x32x16_bf16 v[32:47], v[164:167], v[100:103], v[32:47]
  ds_read_b64_tr_b16 v[152:153], v200 offset:8192
  ds_read_b64_tr_b16 v[154:155], v200 offset:9216
  ds_read_b64_tr_b16 v[156:157], v201 offset:8192
  ds_read_b64_tr_b16 v[158:159], v201 offset:9216
  v_mfma_f32_32x32x16_bf16 v[48:63], v[168:171], v[100:103], v[48:63]
  ds_write_b64 v223, v[210:211]
  v_mul_f32 v178, 0xc0135761, v12
  v_mul_f32 v180, v12, v12
  v_rcp_f32 v182, v12
  v_mul_f32 v180, v180, v12
  v_mul_f32 v180, 0xbdd2d3e8, v180
  v_mfma_f32_32x32x16_bf16 v[64:79], v[172:175], v[100:103], v[64:79]
  s_waitcnt lgkmcnt(1)
  v_mfma_f32_32x32x16_bf16 v[16:31], v[144:147], v[104:107], v[16:31]
  ds_read_b64_tr_b16 v[160:161], v198 offset:12288
  ds_read_b64_tr_b16 v[162:163], v198 offset:13312
  ds_read_b64_tr_b16 v[164:165], v199 offset:12288
  ds_read_b64_tr_b16 v[166:167], v199 offset:13312
  v_mfma_f32_32x32x16_bf16 v[32:47], v[148:151], v[104:107], v[32:47]
  ds_read_b64_tr_b16 v[168:169], v200 offset:12288
  ds_read_b64_tr_b16 v[170:171], v200 offset:13312
  ds_read_b64_tr_b16 v[172:173], v201 offset:12288
  ds_read_b64_tr_b16 v[174:175], v201 offset:13312
  v_mfma_f32_32x32x16_bf16 v[48:63], v[152:155], v[104:107], v[48:63]
  ds_read_b128 v[128:131], v202 offset:0
  ds_read_b128 v[132:135], v202 offset:32
  ds_read_b128 v[136:139], v202 offset:64
  ds_read_b128 v[140:143], v202 offset:96
  v_mfma_f32_32x32x16_bf16 v[64:79], v[156:159], v[104:107], v[64:79]
  v_min_u32 v193, 3456, v193
  buffer_load_dword v192, v193, s[56:59], s71 offen
  s_waitcnt lgkmcnt(4)
  s_barrier
  v_mfma_f32_32x32x16_bf16 v[16:31], v[160:163], v[108:111], v[16:31]
  ds_read_b64_tr_b16 v[144:145], v198 offset:16384
  ds_read_b64_tr_b16 v[146:147], v198 offset:17408
  ds_read_b64_tr_b16 v[148:149], v199 offset:16384
  ds_read_b64_tr_b16 v[150:151], v199 offset:17408
  v_mfma_f32_32x32x16_bf16 v[32:47], v[164:167], v[108:111], v[32:47]
  ds_read_b64_tr_b16 v[152:153], v200 offset:16384
  ds_read_b64_tr_b16 v[154:155], v200 offset:17408
  ds_read_b64_tr_b16 v[156:157], v201 offset:16384
  ds_read_b64_tr_b16 v[158:159], v201 offset:17408
  v_mfma_f32_32x32x16_bf16 v[48:63], v[168:171], v[108:111], v[48:63]
  ds_read_b128 v[80:83], v203 offset:0
  ds_read_b128 v[84:87], v203 offset:32
  ds_read_b128 v[88:91], v203 offset:64
  ds_read_b128 v[92:95], v203 offset:96
  v_mfma_f32_32x32x16_bf16 v[64:79], v[172:175], v[108:111], v[64:79]
  s_waitcnt lgkmcnt(4)
  v_mfma_f32_32x32x16_bf16 v[16:31], v[144:147], v[112:115], v[16:31]
  ds_read_b64_tr_b16 v[160:161], v198 offset:20480
  ds_read_b64_tr_b16 v[162:163], v198 offset:21504
  ds_read_b64_tr_b16 v[164:165], v199 offset:20480
  ds_read_b64_tr_b16 v[166:167], v199 offset:21504
  v_mfma_f32_32x32x16_bf16 v[32:47], v[148:151], v[112:115], v[32:47]
  ds_read_b64_tr_b16 v[168:169], v200 offset:20480
  s_nop 0
  ds_read_b64_tr_b16 v[170:171], v200 offset:21504
  ds_read_b64_tr_b16 v[172:173], v201 offset:20480
  ds_read_b64_tr_b16 v[174:175], v201 offset:21504
  v_mfma_f32_32x32x16_bf16 v[48:63], v[152:155], v[112:115], v[48:63]
  v_mfma_f32_32x32x16_bf16 v[64:79], v[156:159], v[112:115], v[64:79]
  s_waitcnt lgkmcnt(0)
  v_mfma_f32_32x32x16_bf16 v[16:31], v[160:163], v[116:119], v[16:31]
  ds_read_b64_tr_b16 v[144:145], v198 offset:24576
  s_nop 0
  ds_read_b64_tr_b16 v[146:147], v198 offset:25600
  ds_read_b64_tr_b16 v[148:149], v199 offset:24576
  ds_read_b64_tr_b16 v[150:151], v199 offset:25600
  v_mfma_f32_32x32x16_bf16 v[32:47], v[164:167], v[116:119], v[32:47]
  ds_read_b64_tr_b16 v[152:153], v200 offset:24576
  ds_read_b64_tr_b16 v[154:155], v200 offset:25600
  ds_read_b64_tr_b16 v[156:157], v201 offset:24576
  ds_read_b64_tr_b16 v[158:159], v201 offset:25600
  v_mfma_f32_32x32x16_bf16 v[48:63], v[168:171], v[116:119], v[48:63]
  ds_read_b128 v[96:99], v204 offset:0
  ds_read_b128 v[100:103], v204 offset:32
  ds_read_b128 v[104:107], v204 offset:64
  ds_read_b128 v[108:111], v204 offset:96
  v_mfma_f32_32x32x16_bf16 v[64:79], v[172:175], v[116:119], v[64:79]
  s_waitcnt lgkmcnt(4)
  v_mfma_f32_32x32x16_bf16 v[16:31], v[144:147], v[120:123], v[16:31]
  s_nop 0
  ds_read_b64_tr_b16 v[160:161], v198 offset:28672
  ds_read_b64_tr_b16 v[162:163], v198 offset:29696
  ds_read_b64_tr_b16 v[164:165], v199 offset:28672
  ds_read_b64_tr_b16 v[166:167], v199 offset:29696
  v_mfma_f32_32x32x16_bf16 v[32:47], v[148:151], v[120:123], v[32:47]
  ds_read_b64_tr_b16 v[168:169], v200 offset:28672
  ds_read_b64_tr_b16 v[170:171], v200 offset:29696
  ds_read_b64_tr_b16 v[172:173], v201 offset:28672
  ds_read_b64_tr_b16 v[174:175], v201 offset:29696
  v_mfma_f32_32x32x16_bf16 v[48:63], v[152:155], v[120:123], v[48:63]
  v_mfma_f32_32x32x16_bf16 v[64:79], v[156:159], v[120:123], v[64:79]
  s_waitcnt lgkmcnt(0)
  v_mfma_f32_32x32x16_bf16 v[16:31], v[160:163], v[124:127], v[16:31]
  v_mfma_f32_32x32x16_bf16 v[32:47], v[164:167], v[124:127], v[32:47]
  v_mfma_f32_32x32x16_bf16 v[48:63], v[168:171], v[124:127], v[48:63]
  v_mfma_f32_32x32x16_bf16 v[64:79], v[172:175], v[124:127], v[64:79]
  s_nop 0
  ds_read_b128 v[112:115], v205 offset:0
  ds_read_b128 v[116:119], v205 offset:32
  ds_read_b128 v[120:123], v205 offset:64
  ds_read_b128 v[124:127], v205 offset:96
  s_nop 4
  v_pk_fma_f32 v[16:17], v[128:129], v[14:15], v[16:17] op_sel_hi:[1,0,1]
  v_pk_fma_f32 v[18:19], v[130:131], v[14:15], v[18:19] op_sel_hi:[1,0,1]
  v_pk_fma_f32 v[20:21], v[132:133], v[14:15], v[20:21] op_sel_hi:[1,0,1]
  s_nop 0
  v_pk_fma_f32 v[22:23], v[134:135], v[14:15], v[22:23] op_sel_hi:[1,0,1]
  v_pk_fma_f32 v[24:25], v[136:137], v[14:15], v[24:25] op_sel_hi:[1,0,1]
  v_pk_fma_f32 v[26:27], v[138:139], v[14:15], v[26:27] op_sel_hi:[1,0,1]
  v_pk_fma_f32 v[28:29], v[140:141], v[14:15], v[28:29] op_sel_hi:[1,0,1]
  v_pk_fma_f32 v[30:31], v[142:143], v[14:15], v[30:31] op_sel_hi:[1,0,1]
  v_pk_mul_f32 v[144:145], v[16:17], v[16:17]
  v_pk_mul_f32 v[146:147], v[18:19], v[18:19]
  v_pk_mul_f32 v[148:149], v[20:21], v[20:21]
  v_pk_mul_f32 v[150:151], v[22:23], v[22:23]
  v_pk_mul_f32 v[152:153], v[24:25], v[24:25]
  v_pk_mul_f32 v[154:155], v[26:27], v[26:27]
  v_pk_mul_f32 v[156:157], v[28:29], v[28:29]
  v_pk_mul_f32 v[158:159], v[30:31], v[30:31]
  v_pk_fma_f32 v[144:145], v[144:145], v[180:181], v[178:179] op_sel_hi:[1,0,0]
  v_pk_fma_f32 v[146:147], v[146:147], v[180:181], v[178:179] op_sel_hi:[1,0,0]
  v_pk_fma_f32 v[148:149], v[148:149], v[180:181], v[178:179] op_sel_hi:[1,0,0]
  v_pk_fma_f32 v[150:151], v[150:151], v[180:181], v[178:179] op_sel_hi:[1,0,0]
  v_pk_fma_f32 v[152:153], v[152:153], v[180:181], v[178:179] op_sel_hi:[1,0,0]
  v_pk_fma_f32 v[154:155], v[154:155], v[180:181], v[178:179] op_sel_hi:[1,0,0]
  v_pk_fma_f32 v[156:157], v[156:157], v[180:181], v[178:179] op_sel_hi:[1,0,0]
  v_pk_fma_f32 v[158:159], v[158:159], v[180:181], v[178:179] op_sel_hi:[1,0,0]
  s_waitcnt lgkmcnt(0)
  s_barrier
  v_pk_mul_f32 v[144:145], v[144:145], v[16:17]
  v_pk_mul_f32 v[146:147], v[146:147], v[18:19]
  v_pk_mul_f32 v[148:149], v[148:149], v[20:21]
  v_pk_mul_f32 v[150:151], v[150:151], v[22:23]
  v_pk_mul_f32 v[152:153], v[152:153], v[24:25]
  v_pk_mul_f32 v[154:155], v[154:155], v[26:27]
  v_pk_mul_f32 v[156:157], v[156:157], v[28:29]
  v_pk_mul_f32 v[158:159], v[158:159], v[30:31]
  v_exp_f32 v144, v144
  v_exp_f32 v145, v145
  v_exp_f32 v146, v146
  v_exp_f32 v147, v147
  v_exp_f32 v148, v148
  v_exp_f32 v149, v149
  v_exp_f32 v150, v150
  v_exp_f32 v151, v151
  s_mov_b32 m0, s18
  s_nop 0
  buffer_load_dwordx4 v248, s[52:55], s11 offen offset:0 lds
  buffer_load_dwordx4 v249, s[52:55], s11 offen offset:1024 lds
  v_exp_f32 v152, v152
  v_exp_f32 v153, v153
  v_exp_f32 v154, v154
  v_exp_f32 v155, v155
  v_exp_f32 v156, v156
  v_exp_f32 v157, v157
  v_exp_f32 v158, v158
  v_exp_f32 v159, v159
  v_pk_fma_f32 v[144:145], v[144:145], v[182:183], v[182:183] op_sel_hi:[1,0,0]
  v_pk_fma_f32 v[146:147], v[146:147], v[182:183], v[182:183] op_sel_hi:[1,0,0]
  v_pk_fma_f32 v[148:149], v[148:149], v[182:183], v[182:183] op_sel_hi:[1,0,0]
  v_pk_fma_f32 v[150:151], v[150:151], v[182:183], v[182:183] op_sel_hi:[1,0,0]
  v_pk_fma_f32 v[152:153], v[152:153], v[182:183], v[182:183] op_sel_hi:[1,0,0]
  v_pk_fma_f32 v[154:155], v[154:155], v[182:183], v[182:183] op_sel_hi:[1,0,0]
  v_pk_fma_f32 v[156:157], v[156:157], v[182:183], v[182:183] op_sel_hi:[1,0,0]
  v_pk_fma_f32 v[158:159], v[158:159], v[182:183], v[182:183] op_sel_hi:[1,0,0]
  v_rcp_f32 v144, v144
  v_rcp_f32 v145, v145
  v_rcp_f32 v146, v146
  v_rcp_f32 v147, v147
  v_rcp_f32 v148, v148
  v_rcp_f32 v149, v149
  v_rcp_f32 v150, v150
  v_rcp_f32 v151, v151
  v_rcp_f32 v152, v152
  v_rcp_f32 v153, v153
  s_add_u32 m0, s18, 2048
  s_add_u32 s73, s11, 14336
  buffer_load_dwordx4 v248, s[52:55], s73 offen offset:0 lds
  buffer_load_dwordx4 v249, s[52:55], s73 offen offset:1024 lds
  v_rcp_f32 v154, v154
  v_rcp_f32 v155, v155
  v_rcp_f32 v156, v156
  v_rcp_f32 v157, v157
  v_rcp_f32 v158, v158
  v_rcp_f32 v159, v159
  v_pk_mul_f32 v[16:17], v[16:17], v[144:145]
  v_pk_mul_f32 v[18:19], v[18:19], v[146:147]
  v_pk_mul_f32 v[20:21], v[20:21], v[148:149]
  v_pk_mul_f32 v[22:23], v[22:23], v[150:151]
  v_pk_mul_f32 v[24:25], v[24:25], v[152:153]
  v_pk_mul_f32 v[26:27], v[26:27], v[154:155]
  v_pk_mul_f32 v[28:29], v[28:29], v[156:157]
  v_pk_mul_f32 v[30:31], v[30:31], v[158:159]
  v_cvt_pk_bf16_f32 v160, v16, v17
  v_cvt_pk_bf16_f32 v161, v18, v19
  v_cvt_pk_bf16_f32 v162, v20, v21
  v_cvt_pk_bf16_f32 v163, v22, v23
  v_cvt_pk_bf16_f32 v164, v24, v25
  v_cvt_pk_bf16_f32 v165, v26, v27
  v_cvt_pk_bf16_f32 v166, v28, v29
  v_cvt_pk_bf16_f32 v167, v30, v31
  s_add_u32 s69, s80, 66048
  buffer_store_dwordx4 v[160:163], v214, s[44:47], s80 offen sc1
  buffer_store_dwordx4 v[164:167], v214, s[44:47], s69 offen sc1
  v_pk_fma_f32 v[32:33], v[80:81], v[14:15], v[32:33] op_sel_hi:[1,0,1]
  v_pk_fma_f32 v[34:35], v[82:83], v[14:15], v[34:35] op_sel_hi:[1,0,1]
  v_pk_fma_f32 v[36:37], v[84:85], v[14:15], v[36:37] op_sel_hi:[1,0,1]
  v_pk_fma_f32 v[38:39], v[86:87], v[14:15], v[38:39] op_sel_hi:[1,0,1]
  v_pk_fma_f32 v[40:41], v[88:89], v[14:15], v[40:41] op_sel_hi:[1,0,1]
  v_pk_fma_f32 v[42:43], v[90:91], v[14:15], v[42:43] op_sel_hi:[1,0,1]
  v_pk_fma_f32 v[44:45], v[92:93], v[14:15], v[44:45] op_sel_hi:[1,0,1]
  v_pk_fma_f32 v[46:47], v[94:95], v[14:15], v[46:47] op_sel_hi:[1,0,1]
  v_pk_mul_f32 v[144:145], v[32:33], v[32:33]
  v_pk_mul_f32 v[146:147], v[34:35], v[34:35]
  v_pk_mul_f32 v[148:149], v[36:37], v[36:37]
  v_pk_mul_f32 v[150:151], v[38:39], v[38:39]
  v_pk_mul_f32 v[152:153], v[40:41], v[40:41]
  v_pk_mul_f32 v[154:155], v[42:43], v[42:43]
  v_pk_mul_f32 v[156:157], v[44:45], v[44:45]
  v_pk_mul_f32 v[158:159], v[46:47], v[46:47]
  v_pk_fma_f32 v[144:145], v[144:145], v[180:181], v[178:179] op_sel_hi:[1,0,0]
  v_pk_fma_f32 v[146:147], v[146:147], v[180:181], v[178:179] op_sel_hi:[1,0,0]
  v_pk_fma_f32 v[148:149], v[148:149], v[180:181], v[178:179] op_sel_hi:[1,0,0]
  v_pk_fma_f32 v[150:151], v[150:151], v[180:181], v[178:179] op_sel_hi:[1,0,0]
  v_pk_fma_f32 v[152:153], v[152:153], v[180:181], v[178:179] op_sel_hi:[1,0,0]
  v_pk_fma_f32 v[154:155], v[154:155], v[180:181], v[178:179] op_sel_hi:[1,0,0]
  v_pk_fma_f32 v[156:157], v[156:157], v[180:181], v[178:179] op_sel_hi:[1,0,0]
  v_pk_fma_f32 v[158:159], v[158:159], v[180:181], v[178:179] op_sel_hi:[1,0,0]
  s_add_u32 m0, s18, 4096
  s_add_u32 s73, s11, 28672
  buffer_load_dwordx4 v248, s[52:55], s73 offen offset:0 lds
  buffer_load_dwordx4 v249, s[52:55], s73 offen offset:1024 lds
  v_pk_mul_f32 v[144:145], v[144:145], v[32:33]
  v_pk_mul_f32 v[146:147], v[146:147], v[34:35]
  v_pk_mul_f32 v[148:149], v[148:149], v[36:37]
  v_pk_mul_f32 v[150:151], v[150:151], v[38:39]
  v_pk_mul_f32 v[152:153], v[152:153], v[40:41]
  v_pk_mul_f32 v[154:155], v[154:155], v[42:43]
  v_pk_mul_f32 v[156:157], v[156:157], v[44:45]
  v_pk_mul_f32 v[158:159], v[158:159], v[46:47]
  v_exp_f32 v144, v144
  v_exp_f32 v145, v145
  v_exp_f32 v146, v146
  v_exp_f32 v147, v147
  v_exp_f32 v148, v148
  v_exp_f32 v149, v149
  v_exp_f32 v150, v150
  v_exp_f32 v151, v151
  v_exp_f32 v152, v152
  v_exp_f32 v153, v153
  v_exp_f32 v154, v154
  v_exp_f32 v155, v155
  v_exp_f32 v156, v156
  v_exp_f32 v157, v157
  v_exp_f32 v158, v158
  v_exp_f32 v159, v159
  v_pk_fma_f32 v[144:145], v[144:145], v[182:183], v[182:183] op_sel_hi:[1,0,0]
  v_pk_fma_f32 v[146:147], v[146:147], v[182:183], v[182:183] op_sel_hi:[1,0,0]
  v_pk_fma_f32 v[148:149], v[148:149], v[182:183], v[182:183] op_sel_hi:[1,0,0]
  v_pk_fma_f32 v[150:151], v[150:151], v[182:183], v[182:183] op_sel_hi:[1,0,0]
  v_pk_fma_f32 v[152:153], v[152:153], v[182:183], v[182:183] op_sel_hi:[1,0,0]
  v_pk_fma_f32 v[154:155], v[154:155], v[182:183], v[182:183] op_sel_hi:[1,0,0]
  v_pk_fma_f32 v[156:157], v[156:157], v[182:183], v[182:183] op_sel_hi:[1,0,0]
  v_pk_fma_f32 v[158:159], v[158:159], v[182:183], v[182:183] op_sel_hi:[1,0,0]
  s_add_u32 m0, s18, 6144
  s_add_u32 s73, s11, 43008
  buffer_load_dwordx4 v248, s[52:55], s73 offen offset:0 lds
  buffer_load_dwordx4 v249, s[52:55], s73 offen offset:1024 lds
  v_rcp_f32 v144, v144
  v_rcp_f32 v145, v145
  v_rcp_f32 v146, v146
  v_rcp_f32 v147, v147
  v_rcp_f32 v148, v148
  v_rcp_f32 v149, v149
  v_rcp_f32 v150, v150
  v_rcp_f32 v151, v151
  v_rcp_f32 v152, v152
  v_rcp_f32 v153, v153
  v_rcp_f32 v154, v154
  v_rcp_f32 v155, v155
  v_rcp_f32 v156, v156
  v_rcp_f32 v157, v157
  v_rcp_f32 v158, v158
  v_rcp_f32 v159, v159
  v_pk_mul_f32 v[32:33], v[32:33], v[144:145]
  v_pk_mul_f32 v[34:35], v[34:35], v[146:147]
  v_pk_mul_f32 v[36:37], v[36:37], v[148:149]
  v_pk_mul_f32 v[38:39], v[38:39], v[150:151]
  v_pk_mul_f32 v[40:41], v[40:41], v[152:153]
  v_pk_mul_f32 v[42:43], v[42:43], v[154:155]
  v_pk_mul_f32 v[44:45], v[44:45], v[156:157]
  v_pk_mul_f32 v[46:47], v[46:47], v[158:159]
  s_add_u32 m0, s18, 8192
  s_nop 0
  buffer_load_dwordx4 v248, s[52:55], s12 offen offset:0 lds
  buffer_load_dwordx4 v249, s[52:55], s12 offen offset:1024 lds
  v_cvt_pk_bf16_f32 v168, v32, v33
  v_cvt_pk_bf16_f32 v169, v34, v35
  v_cvt_pk_bf16_f32 v170, v36, v37
  v_cvt_pk_bf16_f32 v171, v38, v39
  s_nop 0
  v_cvt_pk_bf16_f32 v172, v40, v41
  v_cvt_pk_bf16_f32 v173, v42, v43
  v_cvt_pk_bf16_f32 v174, v44, v45
  v_cvt_pk_bf16_f32 v175, v46, v47
  s_add_u32 s69, s81, 66048
  buffer_store_dwordx4 v[168:171], v214, s[44:47], s81 offen sc1
  buffer_store_dwordx4 v[172:175], v214, s[44:47], s69 offen sc1
  v_pk_fma_f32 v[48:49], v[96:97], v[14:15], v[48:49] op_sel_hi:[1,0,1]
  v_pk_fma_f32 v[50:51], v[98:99], v[14:15], v[50:51] op_sel_hi:[1,0,1]
  v_pk_fma_f32 v[52:53], v[100:101], v[14:15], v[52:53] op_sel_hi:[1,0,1]
  v_pk_fma_f32 v[54:55], v[102:103], v[14:15], v[54:55] op_sel_hi:[1,0,1]
  v_pk_fma_f32 v[56:57], v[104:105], v[14:15], v[56:57] op_sel_hi:[1,0,1]
  v_pk_fma_f32 v[58:59], v[106:107], v[14:15], v[58:59] op_sel_hi:[1,0,1]
  v_pk_fma_f32 v[60:61], v[108:109], v[14:15], v[60:61] op_sel_hi:[1,0,1]
  v_pk_fma_f32 v[62:63], v[110:111], v[14:15], v[62:63] op_sel_hi:[1,0,1]
  v_pk_mul_f32 v[144:145], v[48:49], v[48:49]
  v_pk_mul_f32 v[146:147], v[50:51], v[50:51]
  v_pk_mul_f32 v[148:149], v[52:53], v[52:53]
  v_pk_mul_f32 v[150:151], v[54:55], v[54:55]
  v_pk_mul_f32 v[152:153], v[56:57], v[56:57]
  v_pk_mul_f32 v[154:155], v[58:59], v[58:59]
  v_pk_mul_f32 v[156:157], v[60:61], v[60:61]
  v_pk_mul_f32 v[158:159], v[62:63], v[62:63]
  v_pk_fma_f32 v[144:145], v[144:145], v[180:181], v[178:179] op_sel_hi:[1,0,0]
  v_pk_fma_f32 v[146:147], v[146:147], v[180:181], v[178:179] op_sel_hi:[1,0,0]
  v_pk_fma_f32 v[148:149], v[148:149], v[180:181], v[178:179] op_sel_hi:[1,0,0]
  v_pk_fma_f32 v[150:151], v[150:151], v[180:181], v[178:179] op_sel_hi:[1,0,0]
  v_pk_fma_f32 v[152:153], v[152:153], v[180:181], v[178:179] op_sel_hi:[1,0,0]
  v_pk_fma_f32 v[154:155], v[154:155], v[180:181], v[178:179] op_sel_hi:[1,0,0]
  v_pk_fma_f32 v[156:157], v[156:157], v[180:181], v[178:179] op_sel_hi:[1,0,0]
  v_pk_fma_f32 v[158:159], v[158:159], v[180:181], v[178:179] op_sel_hi:[1,0,0]
  v_pk_mul_f32 v[144:145], v[144:145], v[48:49]
  v_pk_mul_f32 v[146:147], v[146:147], v[50:51]
  v_pk_mul_f32 v[148:149], v[148:149], v[52:53]
  v_pk_mul_f32 v[150:151], v[150:151], v[54:55]
  v_pk_mul_f32 v[152:153], v[152:153], v[56:57]
  v_pk_mul_f32 v[154:155], v[154:155], v[58:59]
  v_pk_mul_f32 v[156:157], v[156:157], v[60:61]
  v_pk_mul_f32 v[158:159], v[158:159], v[62:63]
  v_exp_f32 v144, v144
  v_exp_f32 v145, v145
  v_exp_f32 v146, v146
  v_exp_f32 v147, v147
  v_exp_f32 v148, v148
  v_exp_f32 v149, v149
  v_exp_f32 v150, v150
  v_exp_f32 v151, v151
  s_add_u32 m0, s18, 10240
  s_add_u32 s73, s12, 14336
  buffer_load_dwordx4 v248, s[52:55], s73 offen offset:0 lds
  buffer_load_dwordx4 v249, s[52:55], s73 offen offset:1024 lds
  v_exp_f32 v152, v152
  v_exp_f32 v153, v153
  v_exp_f32 v154, v154
  v_exp_f32 v155, v155
  v_exp_f32 v156, v156
  v_exp_f32 v157, v157
  v_exp_f32 v158, v158
  v_exp_f32 v159, v159
  v_pk_fma_f32 v[144:145], v[144:145], v[182:183], v[182:183] op_sel_hi:[1,0,0]
  v_pk_fma_f32 v[146:147], v[146:147], v[182:183], v[182:183] op_sel_hi:[1,0,0]
  v_pk_fma_f32 v[148:149], v[148:149], v[182:183], v[182:183] op_sel_hi:[1,0,0]
  v_pk_fma_f32 v[150:151], v[150:151], v[182:183], v[182:183] op_sel_hi:[1,0,0]
  v_pk_fma_f32 v[152:153], v[152:153], v[182:183], v[182:183] op_sel_hi:[1,0,0]
  v_pk_fma_f32 v[154:155], v[154:155], v[182:183], v[182:183] op_sel_hi:[1,0,0]
  v_pk_fma_f32 v[156:157], v[156:157], v[182:183], v[182:183] op_sel_hi:[1,0,0]
  v_pk_fma_f32 v[158:159], v[158:159], v[182:183], v[182:183] op_sel_hi:[1,0,0]
  v_rcp_f32 v144, v144
  v_rcp_f32 v145, v145
  v_rcp_f32 v146, v146
  v_rcp_f32 v147, v147
  v_rcp_f32 v148, v148
  v_rcp_f32 v149, v149
  v_rcp_f32 v150, v150
  v_rcp_f32 v151, v151
  v_rcp_f32 v152, v152
  v_rcp_f32 v153, v153
  s_add_u32 m0, s18, 12288
  s_add_u32 s73, s12, 28672
  buffer_load_dwordx4 v248, s[52:55], s73 offen offset:0 lds
  buffer_load_dwordx4 v249, s[52:55], s73 offen offset:1024 lds
  v_rcp_f32 v154, v154
  v_rcp_f32 v155, v155
  v_rcp_f32 v156, v156
  v_rcp_f32 v157, v157
  v_rcp_f32 v158, v158
  v_rcp_f32 v159, v159
  v_pk_mul_f32 v[48:49], v[48:49], v[144:145]
  v_pk_mul_f32 v[50:51], v[50:51], v[146:147]
  v_pk_mul_f32 v[52:53], v[52:53], v[148:149]
  v_pk_mul_f32 v[54:55], v[54:55], v[150:151]
  v_pk_mul_f32 v[56:57], v[56:57], v[152:153]
  v_pk_mul_f32 v[58:59], v[58:59], v[154:155]
  v_pk_mul_f32 v[60:61], v[60:61], v[156:157]
  v_pk_mul_f32 v[62:63], v[62:63], v[158:159]
  v_cvt_pk_bf16_f32 v160, v48, v49
  v_cvt_pk_bf16_f32 v161, v50, v51
  v_cvt_pk_bf16_f32 v162, v52, v53
  v_cvt_pk_bf16_f32 v163, v54, v55
  v_cvt_pk_bf16_f32 v164, v56, v57
  v_cvt_pk_bf16_f32 v165, v58, v59
  v_cvt_pk_bf16_f32 v166, v60, v61
  v_cvt_pk_bf16_f32 v167, v62, v63
  s_add_u32 s69, s99, 66048
  buffer_store_dwordx4 v[160:163], v214, s[44:47], s99 offen sc1
  buffer_store_dwordx4 v[164:167], v214, s[44:47], s69 offen sc1
  v_pk_fma_f32 v[64:65], v[112:113], v[14:15], v[64:65] op_sel_hi:[1,0,1]
  v_pk_fma_f32 v[66:67], v[114:115], v[14:15], v[66:67] op_sel_hi:[1,0,1]
  v_pk_fma_f32 v[68:69], v[116:117], v[14:15], v[68:69] op_sel_hi:[1,0,1]
  v_pk_fma_f32 v[70:71], v[118:119], v[14:15], v[70:71] op_sel_hi:[1,0,1]
  v_pk_fma_f32 v[72:73], v[120:121], v[14:15], v[72:73] op_sel_hi:[1,0,1]
  v_pk_fma_f32 v[74:75], v[122:123], v[14:15], v[74:75] op_sel_hi:[1,0,1]
  v_pk_fma_f32 v[76:77], v[124:125], v[14:15], v[76:77] op_sel_hi:[1,0,1]
  v_pk_fma_f32 v[78:79], v[126:127], v[14:15], v[78:79] op_sel_hi:[1,0,1]
  v_pk_mul_f32 v[144:145], v[64:65], v[64:65]
  v_pk_mul_f32 v[146:147], v[66:67], v[66:67]
  v_pk_mul_f32 v[148:149], v[68:69], v[68:69]
  v_pk_mul_f32 v[150:151], v[70:71], v[70:71]
  v_pk_mul_f32 v[152:153], v[72:73], v[72:73]
  v_pk_mul_f32 v[154:155], v[74:75], v[74:75]
  v_pk_mul_f32 v[156:157], v[76:77], v[76:77]
  v_pk_mul_f32 v[158:159], v[78:79], v[78:79]
  v_pk_fma_f32 v[144:145], v[144:145], v[180:181], v[178:179] op_sel_hi:[1,0,0]
  v_pk_fma_f32 v[146:147], v[146:147], v[180:181], v[178:179] op_sel_hi:[1,0,0]
  v_pk_fma_f32 v[148:149], v[148:149], v[180:181], v[178:179] op_sel_hi:[1,0,0]
  v_pk_fma_f32 v[150:151], v[150:151], v[180:181], v[178:179] op_sel_hi:[1,0,0]
  v_pk_fma_f32 v[152:153], v[152:153], v[180:181], v[178:179] op_sel_hi:[1,0,0]
  v_pk_fma_f32 v[154:155], v[154:155], v[180:181], v[178:179] op_sel_hi:[1,0,0]
  v_pk_fma_f32 v[156:157], v[156:157], v[180:181], v[178:179] op_sel_hi:[1,0,0]
  v_pk_fma_f32 v[158:159], v[158:159], v[180:181], v[178:179] op_sel_hi:[1,0,0]
  s_add_u32 m0, s18, 14336
  s_add_u32 s73, s12, 43008
  buffer_load_dwordx4 v248, s[52:55], s73 offen offset:0 lds
  buffer_load_dwordx4 v249, s[52:55], s73 offen offset:1024 lds
  v_pk_mul_f32 v[144:145], v[144:145], v[64:65]
  v_pk_mul_f32 v[146:147], v[146:147], v[66:67]
  v_pk_mul_f32 v[148:149], v[148:149], v[68:69]
  v_pk_mul_f32 v[150:151], v[150:151], v[70:71]
  v_pk_mul_f32 v[152:153], v[152:153], v[72:73]
  v_pk_mul_f32 v[154:155], v[154:155], v[74:75]
  v_pk_mul_f32 v[156:157], v[156:157], v[76:77]
  v_pk_mul_f32 v[158:159], v[158:159], v[78:79]
  v_exp_f32 v144, v144
  v_exp_f32 v145, v145
  v_exp_f32 v146, v146
  v_exp_f32 v147, v147
  v_exp_f32 v148, v148
  v_exp_f32 v149, v149
  v_exp_f32 v150, v150
  v_exp_f32 v151, v151
  v_exp_f32 v152, v152
  v_exp_f32 v153, v153
  v_exp_f32 v154, v154
  v_exp_f32 v155, v155
  v_exp_f32 v156, v156
  v_exp_f32 v157, v157
  v_exp_f32 v158, v158
  v_exp_f32 v159, v159
  v_pk_fma_f32 v[144:145], v[144:145], v[182:183], v[182:183] op_sel_hi:[1,0,0]
  v_pk_fma_f32 v[146:147], v[146:147], v[182:183], v[182:183] op_sel_hi:[1,0,0]
  v_pk_fma_f32 v[148:149], v[148:149], v[182:183], v[182:183] op_sel_hi:[1,0,0]
  v_pk_fma_f32 v[150:151], v[150:151], v[182:183], v[182:183] op_sel_hi:[1,0,0]
  v_pk_fma_f32 v[152:153], v[152:153], v[182:183], v[182:183] op_sel_hi:[1,0,0]
  v_pk_fma_f32 v[154:155], v[154:155], v[182:183], v[182:183] op_sel_hi:[1,0,0]
  v_pk_fma_f32 v[156:157], v[156:157], v[182:183], v[182:183] op_sel_hi:[1,0,0]
  v_pk_fma_f32 v[158:159], v[158:159], v[182:183], v[182:183] op_sel_hi:[1,0,0]
  s_add_u32 m0, s18, 16384
  s_nop 0
  s_nop 0
  buffer_load_dwordx4 v248, s[52:55], s13 offen offset:0 lds
  buffer_load_dwordx4 v249, s[52:55], s13 offen offset:1024 lds
  v_rcp_f32 v144, v144
  v_rcp_f32 v145, v145
  v_rcp_f32 v146, v146
  v_rcp_f32 v147, v147
  v_rcp_f32 v148, v148
  v_rcp_f32 v149, v149
  v_rcp_f32 v150, v150
  v_rcp_f32 v151, v151
  v_rcp_f32 v152, v152
  v_rcp_f32 v153, v153
  v_rcp_f32 v154, v154
  v_rcp_f32 v155, v155
  v_rcp_f32 v156, v156
  v_rcp_f32 v157, v157
  v_rcp_f32 v158, v158
  v_rcp_f32 v159, v159
  v_pk_mul_f32 v[64:65], v[64:65], v[144:145]
  v_pk_mul_f32 v[66:67], v[66:67], v[146:147]
  v_pk_mul_f32 v[68:69], v[68:69], v[148:149]
  v_pk_mul_f32 v[70:71], v[70:71], v[150:151]
  v_pk_mul_f32 v[72:73], v[72:73], v[152:153]
  v_pk_mul_f32 v[74:75], v[74:75], v[154:155]
  v_pk_mul_f32 v[76:77], v[76:77], v[156:157]
  v_pk_mul_f32 v[78:79], v[78:79], v[158:159]
  s_add_u32 m0, s18, 18432
  s_add_u32 s73, s13, 14336
  buffer_load_dwordx4 v248, s[52:55], s73 offen offset:0 lds
  buffer_load_dwordx4 v249, s[52:55], s73 offen offset:1024 lds
  v_cvt_pk_bf16_f32 v168, v64, v65
  v_cvt_pk_bf16_f32 v169, v66, v67
  v_cvt_pk_bf16_f32 v170, v68, v69
  v_cvt_pk_bf16_f32 v171, v70, v71
  v_cvt_pk_bf16_f32 v172, v72, v73
  v_cvt_pk_bf16_f32 v173, v74, v75
  v_cvt_pk_bf16_f32 v174, v76, v77
  v_cvt_pk_bf16_f32 v175, v78, v79
  s_add_u32 s69, s3, 66048
  buffer_store_dwordx4 v[168:171], v214, s[44:47], s3 offen sc1
  buffer_store_dwordx4 v[172:175], v214, s[44:47], s69 offen sc1
  v_mov_b32 v16, v232
  v_mov_b32 v17, v233
  v_mov_b32 v18, v234
  v_mov_b32 v19, v235
  v_mov_b32 v20, v236
  v_mov_b32 v21, v237
  v_mov_b32 v22, v238
  v_mov_b32 v23, v239
  v_mov_b32 v24, v240
  v_mov_b32 v25, v241
  v_mov_b32 v26, v242
  v_mov_b32 v27, v243
  v_mov_b32 v28, v244
  v_mov_b32 v29, v245
  v_mov_b32 v30, v246
  v_mov_b32 v31, v247
  s_waitcnt vmcnt(26)
  ds_read_b64_tr_b16 v[144:145], v252 offset:0
  ds_read_b64_tr_b16 v[146:147], v252 offset:1024
  ds_read_b64_tr_b16 v[148:149], v253 offset:0
  ds_read_b64_tr_b16 v[150:151], v253 offset:1024
  s_waitcnt vmcnt(24)
  ds_read_b64_tr_b16 v[152:153], v252 offset:2048
  ds_read_b64_tr_b16 v[154:155], v252 offset:3072
  ds_read_b64_tr_b16 v[156:157], v253 offset:2048
  ds_read_b64_tr_b16 v[158:159], v253 offset:3072
  s_waitcnt vmcnt(20)
  ds_read_b64_tr_b16 v[160:161], v252 offset:4096
  ds_read_b64_tr_b16 v[162:163], v252 offset:5120
  ds_read_b64_tr_b16 v[164:165], v253 offset:4096
  ds_read_b64_tr_b16 v[166:167], v253 offset:5120
  s_waitcnt lgkmcnt(4)
  s_waitcnt vmcnt(18)
  s_nop 0
  ds_read_b64_tr_b16 v[168:169], v252 offset:6144
  ds_read_b64_tr_b16 v[170:171], v252 offset:7168
  ds_read_b64_tr_b16 v[172:173], v253 offset:6144
  ds_read_b64_tr_b16 v[174:175], v253 offset:7168
  s_waitcnt vmcnt(16)
  ds_read_b64_tr_b16 v[176:177], v252 offset:8192
  ds_read_b64_tr_b16 v[178:179], v252 offset:9216
  ds_read_b64_tr_b16 v[180:181], v253 offset:8192
  s_nop 0
  ds_read_b64_tr_b16 v[182:183], v253 offset:9216
  s_waitcnt lgkmcnt(4)
  s_waitcnt vmcnt(12)
  ds_read_b64_tr_b16 v[184:185], v252 offset:10240
  ds_read_b64_tr_b16 v[186:187], v252 offset:11264
  ds_read_b64_tr_b16 v[188:189], v253 offset:10240
  ds_read_b64_tr_b16 v[190:191], v253 offset:11264
  s_waitcnt vmcnt(10)
  ds_read_b64_tr_b16 v[192:193], v252 offset:12288
  s_nop 0
  ds_read_b64_tr_b16 v[194:195], v252 offset:13312
  ds_read_b64_tr_b16 v[196:197], v253 offset:12288
  ds_read_b64_tr_b16 v[198:199], v253 offset:13312
  s_waitcnt lgkmcnt(4)
  s_waitcnt vmcnt(6)
  ds_read_b64_tr_b16 v[200:201], v252 offset:14336
  ds_read_b64_tr_b16 v[202:203], v252 offset:15360
  ds_read_b64_tr_b16 v[204:205], v253 offset:14336
  ds_read_b64_tr_b16 v[206:207], v253 offset:15360
  s_add_u32 s69, s22, 303104
  v_and_b32_e64 v224, 7, v1
  v_lshl_add_u32 v231, v224, 3, s69
  s_waitcnt lgkmcnt(0)
  s_waitcnt vmcnt(0)
  s_barrier
  s_cmp_lg_u32 s64, 0
  s_cbranch_scc1 L_post_32
  buffer_store_dwordx2 v[6:7], v255, s[44:47], 0 offen sc1
L_post_32:
  s_mov_b32 m0, s18
  s_add_u32 s73, s13, 28672
  buffer_load_dwordx4 v248, s[52:55], s73 offen offset:0 lds
  buffer_load_dwordx4 v249, s[52:55], s73 offen offset:1024 lds
  s_add_u32 m0, s18, 2048
  s_add_u32 s73, s13, 43008
  buffer_load_dwordx4 v248, s[52:55], s73 offen offset:0 lds
  buffer_load_dwordx4 v249, s[52:55], s73 offen offset:1024 lds
  s_add_u32 m0, s18, 4096
  s_nop 0
  s_nop 0
  buffer_load_dwordx4 v248, s[52:55], s14 offen offset:0 lds
  buffer_load_dwordx4 v249, s[52:55], s14 offen offset:1024 lds
  s_add_u32 m0, s18, 6144
  s_add_u32 s73, s14, 14336
  buffer_load_dwordx4 v248, s[52:55], s73 offen offset:0 lds
  buffer_load_dwordx4 v249, s[52:55], s73 offen offset:1024 lds
  s_add_u32 m0, s18, 8192
  s_add_u32 s73, s14, 28672
  buffer_load_dwordx4 v248, s[52:55], s73 offen offset:0 lds
  buffer_load_dwordx4 v249, s[52:55], s73 offen offset:1024 lds
  s_add_u32 m0, s18, 10240
  s_add_u32 s73, s14, 43008
  buffer_load_dwordx4 v248, s[52:55], s73 offen offset:0 lds
  buffer_load_dwordx4 v249, s[52:55], s73 offen offset:1024 lds
  s_add_u32 m0, s18, 12288
  s_nop 0
  s_nop 0
  buffer_load_dwordx4 v248, s[52:55], s15 offen offset:0 lds
  buffer_load_dwordx4 v249, s[52:55], s15 offen offset:1024 lds
  s_add_u32 m0, s18, 14336
  s_add_u32 s73, s15, 14336
  buffer_load_dwordx4 v248, s[52:55], s73 offen offset:0 lds
  buffer_load_dwordx4 v249, s[52:55], s73 offen offset:1024 lds
  s_mov_b32 s74, 400000
L_sp_33:
  s_buffer_load_dwordx8 s[28:35], s[44:47], s22 offset:245760 glc
  s_waitcnt lgkmcnt(0)
  s_xor_b64 s[28:29], s[28:29], s[0:1]
  s_xor_b64 s[30:31], s[30:31], s[0:1]
  s_xor_b64 s[32:33], s[32:33], s[0:1]
  s_xor_b64 s[34:35], s[34:35], s[0:1]
  s_or_b64 s[28:29], s[28:29], s[34:35]
  s_or_b64 s[28:29], s[28:29], s[32:33]
  s_or_b64 s[28:29], s[28:29], s[30:31]
  s_cbranch_scc0 L_spd_34
  s_sub_u32 s74, s74, 1
  s_cbranch_scc1 L_spd_34
  s_sleep 1
  s_branch L_sp_33
L_spd_34:
  buffer_load_dwordx4 v[80:83], v250, s[44:47], s4 offen sc1
  s_nop 0
  buffer_load_dwordx4 v[84:87], v251, s[44:47], s4 offen sc1
  s_add_u32 s72, s4, 66048
  buffer_load_dwordx4 v[88:91], v250, s[44:47], s72 offen sc1
  buffer_load_dwordx4 v[92:95], v251, s[44:47], s72 offen sc1
  s_add_u32 s72, s4, 132096
  buffer_load_dwordx4 v[96:99], v250, s[44:47], s72 offen sc1
  buffer_load_dwordx4 v[100:103], v251, s[44:47], s72 offen sc1
  s_add_u32 s72, s4, 198144
  buffer_load_dwordx4 v[104:107], v250, s[44:47], s72 offen sc1
  buffer_load_dwordx4 v[108:111], v251, s[44:47], s72 offen sc1
  s_waitcnt vmcnt(6)
  v_mfma_f32_32x32x16_bf16 v[16:31], v[144:147], v[80:83], v[16:31]
  buffer_load_dwordx4 v[112:115], v250, s[44:47], s5 offen sc1
  buffer_load_dwordx4 v[116:119], v251, s[44:47], s5 offen sc1
  v_mfma_f32_32x32x16_bf16 v[32:47], v[148:151], v[80:83], 0
  s_add_u32 s72, s5, 66048
  s_nop 0
  buffer_load_dwordx4 v[120:123], v250, s[44:47], s72 offen sc1
  buffer_load_dwordx4 v[124:127], v251, s[44:47], s72 offen sc1
  v_mfma_f32_32x32x16_bf16 v[48:63], v[144:147], v[84:87], 0
  v_mfma_f32_32x32x16_bf16 v[64:79], v[148:151], v[84:87], 0
  s_waitcnt vmcnt(8)
  v_mfma_f32_32x32x16_bf16 v[16:31], v[152:155], v[88:91], v[16:31]
  s_add_u32 s72, s5, 132096
  buffer_load_dwordx4 v[128:131], v250, s[44:47], s72 offen sc1
  s_nop 0
  buffer_load_dwordx4 v[132:135], v251, s[44:47], s72 offen sc1
  v_mfma_f32_32x32x16_bf16 v[32:47], v[156:159], v[88:91], v[32:47]
  s_add_u32 s72, s5, 198144
  buffer_load_dwordx4 v[136:139], v250, s[44:47], s72 offen sc1
  buffer_load_dwordx4 v[140:143], v251, s[44:47], s72 offen sc1
  v_mfma_f32_32x32x16_bf16 v[48:63], v[152:155], v[92:95], v[48:63]
  v_mfma_f32_32x32x16_bf16 v[64:79], v[156:159], v[92:95], v[64:79]
  s_waitcnt vmcnt(10)
  s_nop 0
  v_mfma_f32_32x32x16_bf16 v[16:31], v[160:163], v[96:99], v[16:31]
  buffer_load_dwordx4 v[80:83], v250, s[44:47], s6 offen sc1
  buffer_load_dwordx4 v[84:87], v251, s[44:47], s6 offen sc1
  v_mfma_f32_32x32x16_bf16 v[32:47], v[164:167], v[96:99], v[32:47]
  s_add_u32 s72, s6, 66048
  buffer_load_dwordx4 v[88:91], v250, s[44:47], s72 offen sc1
  buffer_load_dwordx4 v[92:95], v251, s[44:47], s72 offen sc1
  v_mfma_f32_32x32x16_bf16 v[48:63], v[160:163], v[100:103], v[48:63]
  v_mfma_f32_32x32x16_bf16 v[64:79], v[164:167], v[100:103], v[64:79]
  s_waitcnt vmcnt(12)
  v_mfma_f32_32x32x16_bf16 v[16:31], v[168:171], v[104:107], v[16:31]
  s_add_u32 s72, s6, 132096
  buffer_load_dwordx4 v[96:99], v250, s[44:47], s72 offen sc1
  buffer_load_dwordx4 v[100:103], v251, s[44:47], s72 offen sc1
  v_mfma_f32_32x32x16_bf16 v[32:47], v[172:175], v[104:107], v[32:47]
  v_mfma_f32_32x32x16_bf16 v[48:63], v[168:171], v[108:111], v[48:63]
  s_nop 0
  v_mfma_f32_32x32x16_bf16 v[64:79], v[172:175], v[108:111], v[64:79]
  s_waitcnt vmcnt(12)
  v_mfma_f32_32x32x16_bf16 v[16:31], v[176:179], v[112:115], v[16:31]
  s_add_u32 s72, s6, 198144
  buffer_load_dwordx4 v[104:107], v250, s[44:47], s72 offen sc1
  buffer_load_dwordx4 v[108:111], v251, s[44:47], s72 offen sc1
  v_mfma_f32_32x32x16_bf16 v[32:47], v[180:183], v[112:115], v[32:47]
  v_mfma_f32_32x32x16_bf16 v[48:63], v[176:179], v[116:119], v[48:63]
  s_nop 0
  v_mfma_f32_32x32x16_bf16 v[64:79], v[180:183], v[116:119], v[64:79]
  s_waitcnt vmcnt(12)
  v_mfma_f32_32x32x16_bf16 v[16:31], v[184:187], v[120:123], v[16:31]
  buffer_load_dwordx4 v[112:115], v250, s[44:47], s7 offen sc1
  buffer_load_dwordx4 v[116:119], v251, s[44:47], s7 offen sc1
  v_mfma_f32_32x32x16_bf16 v[32:47], v[188:191], v[120:123], v[32:47]
  v_mfma_f32_32x32x16_bf16 v[48:63], v[184:187], v[124:127], v[48:63]
  v_mfma_f32_32x32x16_bf16 v[64:79], v[188:191], v[124:127], v[64:79]
  s_waitcnt vmcnt(12)
  v_mfma_f32_32x32x16_bf16 v[16:31], v[192:195], v[128:131], v[16:31]
  s_add_u32 s72, s7, 66048
  buffer_load_dwordx4 v[120:123], v250, s[44:47], s72 offen sc1
  buffer_load_dwordx4 v[124:127], v251, s[44:47], s72 offen sc1
  v_mfma_f32_32x32x16_bf16 v[32:47], v[196:199], v[128:131], v[32:47]
  v_mfma_f32_32x32x16_bf16 v[48:63], v[192:195], v[132:135], v[48:63]
  v_mfma_f32_32x32x16_bf16 v[64:79], v[196:199], v[132:135], v[64:79]
  s_waitcnt vmcnt(12)
  s_nop 0
  v_mfma_f32_32x32x16_bf16 v[16:31], v[200:203], v[136:139], v[16:31]
  ds_read_b64_tr_b16 v[208:209], v252 offset:16384
  ds_read_b64_tr_b16 v[210:211], v252 offset:17408
  ds_read_b64_tr_b16 v[212:213], v253 offset:16384
  ds_read_b64_tr_b16 v[214:215], v253 offset:17408
  v_mfma_f32_32x32x16_bf16 v[32:47], v[204:207], v[136:139], v[32:47]
  s_add_u32 s72, s7, 132096
  buffer_load_dwordx4 v[128:131], v250, s[44:47], s72 offen sc1
  buffer_load_dwordx4 v[132:135], v251, s[44:47], s72 offen sc1
  v_mfma_f32_32x32x16_bf16 v[48:63], v[200:203], v[140:143], v[48:63]
  v_mfma_f32_32x32x16_bf16 v[64:79], v[204:207], v[140:143], v[64:79]
  s_waitcnt vmcnt(12) lgkmcnt(0)
  v_mfma_f32_32x32x16_bf16 v[16:31], v[208:211], v[80:83], v[16:31]
  ds_read_b64_tr_b16 v[216:217], v252 offset:18432
  ds_read_b64_tr_b16 v[218:219], v252 offset:19456
  ds_read_b64_tr_b16 v[220:221], v253 offset:18432
  s_nop 0
  ds_read_b64_tr_b16 v[222:223], v253 offset:19456
  v_mfma_f32_32x32x16_bf16 v[32:47], v[212:215], v[80:83], v[32:47]
  s_add_u32 s72, s7, 198144
  buffer_load_dwordx4 v[136:139], v250, s[44:47], s72 offen sc1
  buffer_load_dwordx4 v[140:143], v251, s[44:47], s72 offen sc1
  v_mfma_f32_32x32x16_bf16 v[48:63], v[208:211], v[84:87], v[48:63]
  s_add_u32 m0, s18, 16384
  s_add_u32 s73, s15, 28672
  buffer_load_dwordx4 v248, s[52:55], s73 offen offset:0 lds
  buffer_load_dwordx4 v249, s[52:55], s73 offen offset:1024 lds
  v_mfma_f32_32x32x16_bf16 v[64:79], v[212:215], v[84:87], v[64:79]
  s_waitcnt vmcnt(14) lgkmcnt(0)
  v_mfma_f32_32x32x16_bf16 v[16:31], v[216:219], v[88:91], v[16:31]
  ds_read_b64_tr_b16 v[208:209], v252 offset:0
  ds_read_b64_tr_b16 v[210:211], v252 offset:1024
  ds_read_b64_tr_b16 v[212:213], v253 offset:0
  s_nop 0
  ds_read_b64_tr_b16 v[214:215], v253 offset:1024
  v_mfma_f32_32x32x16_bf16 v[32:47], v[220:223], v[88:91], v[32:47]
  buffer_load_dwordx4 v[80:83], v250, s[44:47], s8 offen sc1
  buffer_load_dwordx4 v[84:87], v251, s[44:47], s8 offen sc1
  v_mfma_f32_32x32x16_bf16 v[48:63], v[216:219], v[92:95], v[48:63]
  s_add_u32 m0, s18, 18432
  s_add_u32 s73, s15, 43008
  buffer_load_dwordx4 v248, s[52:55], s73 offen offset:0 lds
  buffer_load_dwordx4 v249, s[52:55], s73 offen offset:1024 lds
  v_mfma_f32_32x32x16_bf16 v[64:79], v[220:223], v[92:95], v[64:79]
  s_waitcnt vmcnt(16) lgkmcnt(0)
  v_mfma_f32_32x32x16_bf16 v[16:31], v[208:211], v[96:99], v[16:31]
  ds_read_b64_tr_b16 v[216:217], v252 offset:2048
  ds_read_b64_tr_b16 v[218:219], v252 offset:3072
  ds_read_b64_tr_b16 v[220:221], v253 offset:2048
  ds_read_b64_tr_b16 v[222:223], v253 offset:3072
  s_nop 0
  v_mfma_f32_32x32x16_bf16 v[32:47], v[212:215], v[96:99], v[32:47]
  s_add_u32 s72, s8, 66048
  buffer_load_dwordx4 v[88:91], v250, s[44:47], s72 offen sc1
  buffer_load_dwordx4 v[92:95], v251, s[44:47], s72 offen sc1
  v_mfma_f32_32x32x16_bf16 v[48:63], v[208:211], v[100:103], v[48:63]
  s_mov_b32 m0, s18
  s_nop 0
  buffer_load_dwordx4 v248, s[52:55], s16 offen offset:0 lds
  buffer_load_dwordx4 v249, s[52:55], s16 offen offset:1024 lds
  v_mfma_f32_32x32x16_bf16 v[64:79], v[212:215], v[100:103], v[64:79]
  s_waitcnt vmcnt(18) lgkmcnt(0)
  v_mfma_f32_32x32x16_bf16 v[16:31], v[216:219], v[104:107], v[16:31]
  ds_read_b64_tr_b16 v[208:209], v252 offset:4096
  ds_read_b64_tr_b16 v[210:211], v252 offset:5120
  ds_read_b64_tr_b16 v[212:213], v253 offset:4096
  ds_read_b64_tr_b16 v[214:215], v253 offset:5120
  v_mfma_f32_32x32x16_bf16 v[32:47], v[220:223], v[104:107], v[32:47]
  s_nop 0
  s_add_u32 s72, s8, 132096
  buffer_load_dwordx4 v[96:99], v250, s[44:47], s72 offen sc1
  buffer_load_dwordx4 v[100:103], v251, s[44:47], s72 offen sc1
  v_mfma_f32_32x32x16_bf16 v[48:63], v[216:219], v[108:111], v[48:63]
  s_add_u32 m0, s18, 2048
  s_add_u32 s73, s16, 14336
  buffer_load_dwordx4 v248, s[52:55], s73 offen offset:0 lds
  buffer_load_dwordx4 v249, s[52:55], s73 offen offset:1024 lds
  v_mfma_f32_32x32x16_bf16 v[64:79], v[220:223], v[108:111], v[64:79]
  s_waitcnt vmcnt(20) lgkmcnt(0)
  v_mfma_f32_32x32x16_bf16 v[16:31], v[208:211], v[112:115], v[16:31]
  ds_read_b64_tr_b16 v[216:217], v252 offset:6144
  ds_read_b64_tr_b16 v[218:219], v252 offset:7168
  ds_read_b64_tr_b16 v[220:221], v253 offset:6144
  ds_read_b64_tr_b16 v[222:223], v253 offset:7168
  v_mfma_f32_32x32x16_bf16 v[32:47], v[212:215], v[112:115], v[32:47]
  s_nop 0
  s_add_u32 s72, s8, 198144
  buffer_load_dwordx4 v[104:107], v250, s[44:47], s72 offen sc1
  buffer_load_dwordx4 v[108:111], v251, s[44:47], s72 offen sc1
  v_mfma_f32_32x32x16_bf16 v[48:63], v[208:211], v[116:119], v[48:63]
  s_add_u32 m0, s18, 4096
  s_add_u32 s73, s16, 28672
  buffer_load_dwordx4 v248, s[52:55], s73 offen offset:0 lds
  buffer_load_dwordx4 v249, s[52:55], s73 offen offset:1024 lds
  v_mfma_f32_32x32x16_bf16 v[64:79], v[212:215], v[116:119], v[64:79]
  s_waitcnt vmcnt(22) lgkmcnt(0)
  v_mfma_f32_32x32x16_bf16 v[16:31], v[216:219], v[120:123], v[16:31]
  ds_read_b64_tr_b16 v[208:209], v252 offset:8192
  ds_read_b64_tr_b16 v[210:211], v252 offset:9216
  ds_read_b64_tr_b16 v[212:213], v253 offset:8192
  ds_read_b64_tr_b16 v[214:215], v253 offset:9216
  v_mfma_f32_32x32x16_bf16 v[32:47], v[220:223], v[120:123], v[32:47]
  s_nop 0
  buffer_load_dwordx4 v[112:115], v250, s[44:47], s9 offen sc1
  buffer_load_dwordx4 v[116:119], v251, s[44:47], s9 offen sc1
  v_mfma_f32_32x32x16_bf16 v[48:63], v[216:219], v[124:127], v[48:63]
  s_add_u32 m0, s18, 6144
  s_add_u32 s73, s16, 43008
  buffer_load_dwordx4 v248, s[52:55], s73 offen offset:0 lds
  buffer_load_dwordx4 v249, s[52:55], s73 offen offset:1024 lds
  v_mfma_f32_32x32x16_bf16 v[64:79], v[220:223], v[124:127], v[64:79]
  s_waitcnt vmcnt(24) lgkmcnt(0)
  v_mfma_f32_32x32x16_bf16 v[16:31], v[208:211], v[128:131], v[16:31]
  ds_read_b64_tr_b16 v[216:217], v252 offset:10240
  ds_read_b64_tr_b16 v[218:219], v252 offset:11264
  ds_read_b64_tr_b16 v[220:221], v253 offset:10240
  ds_read_b64_tr_b16 v[222:223], v253 offset:11264
  v_mfma_f32_32x32x16_bf16 v[32:47], v[212:215], v[128:131], v[32:47]
  s_add_u32 s72, s9, 66048
  s_nop 0
  buffer_load_dwordx4 v[120:123], v250, s[44:47], s72 offen sc1
  buffer_load_dwordx4 v[124:127], v251, s[44:47], s72 offen sc1
  v_mfma_f32_32x32x16_bf16 v[48:63], v[208:211], v[132:135], v[48:63]
  s_add_u32 m0, s18, 8192
  s_nop 0
  buffer_load_dwordx4 v248, s[52:55], s17 offen offset:0 lds
  buffer_load_dwordx4 v249, s[52:55], s17 offen offset:1024 lds
  v_mfma_f32_32x32x16_bf16 v[64:79], v[212:215], v[132:135], v[64:79]
  s_waitcnt vmcnt(26) lgkmcnt(0)
  v_mfma_f32_32x32x16_bf16 v[16:31], v[216:219], v[136:139], v[16:31]
  ds_read_b64_tr_b16 v[208:209], v252 offset:12288
  ds_read_b64_tr_b16 v[210:211], v252 offset:13312
  ds_read_b64_tr_b16 v[212:213], v253 offset:12288
  ds_read_b64_tr_b16 v[214:215], v253 offset:13312
  v_mfma_f32_32x32x16_bf16 v[32:47], v[220:223], v[136:139], v[32:47]
  s_add_u32 s72, s9, 132096
  buffer_load_dwordx4 v[128:131], v250, s[44:47], s72 offen sc1
  buffer_load_dwordx4 v[132:135], v251, s[44:47], s72 offen sc1
  v_mfma_f32_32x32x16_bf16 v[48:63], v[216:219], v[140:143], v[48:63]
  s_add_u32 m0, s18, 10240
  s_add_u32 s73, s17, 14336
  buffer_load_dwordx4 v248, s[52:55], s73 offen offset:0 lds
  buffer_load_dwordx4 v249, s[52:55], s73 offen offset:1024 lds
  v_mfma_f32_32x32x16_bf16 v[64:79], v[220:223], v[140:143], v[64:79]
  s_waitcnt vmcnt(26) lgkmcnt(0)
  s_nop 0
  v_mfma_f32_32x32x16_bf16 v[16:31], v[208:211], v[80:83], v[16:31]
  ds_read_b64_tr_b16 v[216:217], v252 offset:14336
  ds_read_b64_tr_b16 v[218:219], v252 offset:15360
  ds_read_b64_tr_b16 v[220:221], v253 offset:14336
  ds_read_b64_tr_b16 v[222:223], v253 offset:15360
  v_mfma_f32_32x32x16_bf16 v[32:47], v[212:215], v[80:83], v[32:47]
  s_add_u32 s72, s9, 198144
  buffer_load_dwordx4 v[136:139], v250, s[44:47], s72 offen sc1
  buffer_load_dwordx4 v[140:143], v251, s[44:47], s72 offen sc1
  v_mfma_f32_32x32x16_bf16 v[48:63], v[208:211], v[84:87], v[48:63]
  s_add_u32 m0, s18, 12288
  s_add_u32 s73, s17, 28672
  buffer_load_dwordx4 v248, s[52:55], s73 offen offset:0 lds
  buffer_load_dwordx4 v249, s[52:55], s73 offen offset:1024 lds
  v_mfma_f32_32x32x16_bf16 v[64:79], v[212:215], v[84:87], v[64:79]
  s_waitcnt vmcnt(26) lgkmcnt(0)
  s_nop 0
  v_mfma_f32_32x32x16_bf16 v[16:31], v[216:219], v[88:91], v[16:31]
  ds_read_b64_tr_b16 v[208:209], v252 offset:16384
  ds_read_b64_tr_b16 v[210:211], v252 offset:17408
  ds_read_b64_tr_b16 v[212:213], v253 offset:16384
  ds_read_b64_tr_b16 v[214:215], v253 offset:17408
  v_mfma_f32_32x32x16_bf16 v[32:47], v[220:223], v[88:91], v[32:47]
  buffer_load_dwordx4 v[80:83], v250, s[44:47], s10 offen sc1
  buffer_load_dwordx4 v[84:87], v251, s[44:47], s10 offen sc1
  v_mfma_f32_32x32x16_bf16 v[48:63], v[216:219], v[92:95], v[48:63]
  s_add_u32 m0, s18, 14336
  s_add_u32 s73, s17, 43008
  buffer_load_dwordx4 v248, s[52:55], s73 offen offset:0 lds
  buffer_load_dwordx4 v249, s[52:55], s73 offen offset:1024 lds
  v_mfma_f32_32x32x16_bf16 v[64:79], v[220:223], v[92:95], v[64:79]
  s_waitcnt vmcnt(26) lgkmcnt(0)
  v_mfma_f32_32x32x16_bf16 v[16:31], v[208:211], v[96:99], v[16:31]
  s_nop 0
  ds_read_b64_tr_b16 v[216:217], v252 offset:18432
  ds_read_b64_tr_b16 v[218:219], v252 offset:19456
  ds_read_b64_tr_b16 v[220:221], v253 offset:18432
  ds_read_b64_tr_b16 v[222:223], v253 offset:19456
  v_mfma_f32_32x32x16_bf16 v[32:47], v[212:215], v[96:99], v[32:47]
  s_add_u32 s72, s10, 66048
  buffer_load_dwordx4 v[88:91], v250, s[44:47], s72 offen sc1
  buffer_load_dwordx4 v[92:95], v251, s[44:47], s72 offen sc1
  v_mfma_f32_32x32x16_bf16 v[48:63], v[208:211], v[100:103], v[48:63]
  s_add_u32 m0, s18, 16384
  s_nop 0
  buffer_load_dwordx4 v248, s[56:59], s19 offen offset:0 lds
  buffer_load_dwordx4 v249, s[56:59], s19 offen offset:1024 lds
  v_mfma_f32_32x32x16_bf16 v[64:79], v[212:215], v[100:103], v[64:79]
  s_waitcnt vmcnt(26) lgkmcnt(0)
  v_mfma_f32_32x32x16_bf16 v[16:31], v[216:219], v[104:107], v[16:31]
  ds_read_b64_tr_b16 v[208:209], v252 offset:0
  ds_read_b64_tr_b16 v[210:211], v252 offset:1024
  ds_read_b64_tr_b16 v[212:213], v253 offset:0
  ds_read_b64_tr_b16 v[214:215], v253 offset:1024
  v_mfma_f32_32x32x16_bf16 v[32:47], v[220:223], v[104:107], v[32:47]
  s_add_u32 s72, s10, 132096
  buffer_load_dwordx4 v[96:99], v250, s[44:47], s72 offen sc1
  buffer_load_dwordx4 v[100:103], v251, s[44:47], s72 offen sc1
  v_mfma_f32_32x32x16_bf16 v[48:63], v[216:219], v[108:111], v[48:63]
  s_add_u32 m0, s18, 18432
  s_add_u32 s73, s19, 14336
  buffer_load_dwordx4 v248, s[56:59], s73 offen offset:0 lds
  buffer_load_dwordx4 v249, s[56:59], s73 offen offset:1024 lds
  v_mfma_f32_32x32x16_bf16 v[64:79], v[220:223], v[108:111], v[64:79]
  s_waitcnt vmcnt(26) lgkmcnt(0)
  v_mfma_f32_32x32x16_bf16 v[16:31], v[208:211], v[112:115], v[16:31]
  ds_read_b64_tr_b16 v[216:217], v252 offset:2048
  s_nop 0
  ds_read_b64_tr_b16 v[218:219], v252 offset:3072
  ds_read_b64_tr_b16 v[220:221], v253 offset:2048
  ds_read_b64_tr_b16 v[222:223], v253 offset:3072
  v_mfma_f32_32x32x16_bf16 v[32:47], v[212:215], v[112:115], v[32:47]
  buffer_load_dwordx2 v[8:9], v231, s[44:47], 0 offen sc1
  v_mfma_f32_32x32x16_bf16 v[48:63], v[208:211], v[116:119], v[48:63]
  s_add_u32 s72, s10, 198144
  buffer_load_dwordx4 v[104:107], v250, s[44:47], s72 offen sc1
  buffer_load_dwordx4 v[108:111], v251, s[44:47], s72 offen sc1
  v_mfma_f32_32x32x16_bf16 v[64:79], v[212:215], v[116:119], v[64:79]
  s_mov_b32 m0, s18
  s_add_u32 s73, s19, 25088
  buffer_load_dwordx4 v248, s[56:59], s73 offen offset:0 lds
  buffer_load_dwordx4 v249, s[56:59], s73 offen offset:1024 lds
  s_waitcnt vmcnt(27) lgkmcnt(0)
  v_mfma_f32_32x32x16_bf16 v[16:31], v[216:219], v[120:123], v[16:31]
  ds_read_b64_tr_b16 v[208:209], v252 offset:4096
  ds_read_b64_tr_b16 v[210:211], v252 offset:5120
  ds_read_b64_tr_b16 v[212:213], v253 offset:4096
  ds_read_b64_tr_b16 v[214:215], v253 offset:5120
  v_mfma_f32_32x32x16_bf16 v[32:47], v[220:223], v[120:123], v[32:47]
  s_add_u32 m0, s18, 2048
  s_add_u32 s73, s19, 39424
  buffer_load_dwordx4 v248, s[56:59], s73 offen offset:0 lds
  buffer_load_dwordx4 v249, s[56:59], s73 offen offset:1024 lds
  v_mfma_f32_32x32x16_bf16 v[48:63], v[216:219], v[124:127], v[48:63]
  v_mfma_f32_32x32x16_bf16 v[64:79], v[220:223], v[124:127], v[64:79]
  s_waitcnt vmcnt(25) lgkmcnt(0)
  v_mfma_f32_32x32x16_bf16 v[16:31], v[208:211], v[128:131], v[16:31]
  ds_read_b64_tr_b16 v[216:217], v252 offset:6144
  ds_read_b64_tr_b16 v[218:219], v252 offset:7168
  ds_read_b64_tr_b16 v[220:221], v253 offset:6144
  ds_read_b64_tr_b16 v[222:223], v253 offset:7168
  s_nop 0
  v_mfma_f32_32x32x16_bf16 v[32:47], v[212:215], v[128:131], v[32:47]
  s_add_u32 m0, s18, 4096
  s_add_u32 s73, s19, 50176
  buffer_load_dwordx4 v248, s[56:59], s73 offen offset:0 lds
  buffer_load_dwordx4 v249, s[56:59], s73 offen offset:1024 lds
  v_mfma_f32_32x32x16_bf16 v[48:63], v[208:211], v[132:135], v[48:63]
  v_mfma_f32_32x32x16_bf16 v[64:79], v[212:215], v[132:135], v[64:79]
  s_waitcnt vmcnt(8)
  v_cmp_ne_u64 vcc, v[8:9], v[6:7]
  s_nop 4
  s_cbranch_vccnz L_B4_late
  s_waitcnt lgkmcnt(0)
  v_mfma_f32_32x32x16_bf16 v[16:31], v[216:219], v[136:139], v[16:31]
  ds_read_b64_tr_b16 v[208:209], v252 offset:8192
  ds_read_b64_tr_b16 v[210:211], v252 offset:9216
  ds_read_b64_tr_b16 v[212:213], v253 offset:8192
  ds_read_b64_tr_b16 v[214:215], v253 offset:9216
  v_mfma_f32_32x32x16_bf16 v[32:47], v[220:223], v[136:139], v[32:47]
  s_nop 0
  buffer_load_dwordx4 v[112:115], v250, s[44:47], s20 offen sc1
  buffer_load_dwordx4 v[116:119], v251, s[44:47], s20 offen sc1
  v_mfma_f32_32x32x16_bf16 v[48:63], v[216:219], v[140:143], v[48:63]
  s_add_u32 s72, s20, 66048
  buffer_load_dwordx4 v[120:123], v250, s[44:47], s72 offen sc1
  buffer_load_dwordx4 v[124:127], v251, s[44:47], s72 offen sc1
  v_mfma_f32_32x32x16_bf16 v[64:79], v[220:223], v[140:143], v[64:79]
  s_add_u32 m0, s18, 6144
  s_add_u32 s73, s19, 64512
  buffer_load_dwordx4 v248, s[56:59], s73 offen offset:0 lds
  buffer_load_dwordx4 v249, s[56:59], s73 offen offset:1024 lds
  s_waitcnt lgkmcnt(0)
  v_mfma_f32_32x32x16_bf16 v[16:31], v[208:211], v[80:83], v[16:31]
  ds_read_b64_tr_b16 v[216:217], v252 offset:10240
  ds_read_b64_tr_b16 v[218:219], v252 offset:11264
  ds_read_b64_tr_b16 v[220:221], v253 offset:10240
  s_nop 0
  ds_read_b64_tr_b16 v[222:223], v253 offset:11264
  v_mfma_f32_32x32x16_bf16 v[32:47], v[212:215], v[80:83], v[32:47]
  s_add_u32 s72, s20, 132096
  buffer_load_dwordx4 v[128:131], v250, s[44:47], s72 offen sc1
  buffer_load_dwordx4 v[132:135], v251, s[44:47], s72 offen sc1
  v_mfma_f32_32x32x16_bf16 v[48:63], v[208:211], v[84:87], v[48:63]
  s_add_u32 s72, s20, 198144
  buffer_load_dwordx4 v[136:139], v250, s[44:47], s72 offen sc1
  buffer_load_dwordx4 v[140:143], v251, s[44:47], s72 offen sc1
  v_mfma_f32_32x32x16_bf16 v[64:79], v[212:215], v[84:87], v[64:79]
  s_add_u32 m0, s18, 8192
  s_add_u32 s73, s19, 75264
  buffer_load_dwordx4 v248, s[56:59], s73 offen offset:0 lds
  buffer_load_dwordx4 v249, s[56:59], s73 offen offset:1024 lds
  s_waitcnt lgkmcnt(0)
  v_mfma_f32_32x32x16_bf16 v[16:31], v[216:219], v[88:91], v[16:31]
  s_nop 0
  ds_read_b64_tr_b16 v[208:209], v252 offset:12288
  ds_read_b64_tr_b16 v[210:211], v252 offset:13312
  ds_read_b64_tr_b16 v[212:213], v253 offset:12288
  ds_read_b64_tr_b16 v[214:215], v253 offset:13312
  v_mfma_f32_32x32x16_bf16 v[32:47], v[220:223], v[88:91], v[32:47]
  s_add_u32 s72, s20, 264192
  buffer_load_dwordx4 v[80:83], v250, s[44:47], s72 offen sc1
  buffer_load_dwordx4 v[84:87], v251, s[44:47], s72 offen sc1
  v_mfma_f32_32x32x16_bf16 v[48:63], v[216:219], v[92:95], v[48:63]
  s_add_u32 m0, s18, 10240
  s_add_u32 s73, s19, 89600
  buffer_load_dwordx4 v248, s[56:59], s73 offen offset:0 lds
  buffer_load_dwordx4 v249, s[56:59], s73 offen offset:1024 lds
  v_mfma_f32_32x32x16_bf16 v[64:79], v[220:223], v[92:95], v[64:79]
  s_waitcnt lgkmcnt(0)
  v_mfma_f32_32x32x16_bf16 v[16:31], v[208:211], v[96:99], v[16:31]
  s_nop 0
  ds_read_b64_tr_b16 v[216:217], v252 offset:14336
  ds_read_b64_tr_b16 v[218:219], v252 offset:15360
  ds_read_b64_tr_b16 v[220:221], v253 offset:14336
  ds_read_b64_tr_b16 v[222:223], v253 offset:15360
  v_mfma_f32_32x32x16_bf16 v[32:47], v[212:215], v[96:99], v[32:47]
  s_add_u32 s72, s20, 330240
  buffer_load_dwordx4 v[88:91], v250, s[44:47], s72 offen sc1
  buffer_load_dwordx4 v[92:95], v251, s[44:47], s72 offen sc1
  v_mfma_f32_32x32x16_bf16 v[48:63], v[208:211], v[100:103], v[48:63]
  v_mfma_f32_32x32x16_bf16 v[64:79], v[212:215], v[100:103], v[64:79]
  s_waitcnt vmcnt(24) lgkmcnt(0)
  v_mfma_f32_32x32x16_bf16 v[16:31], v[216:219], v[104:107], v[16:31]
  ds_read_b64_tr_b16 v[144:145], v252 offset:16384
  ds_read_b64_tr_b16 v[146:147], v252 offset:17408
  ds_read_b64_tr_b16 v[212:213], v253 offset:16384
  ds_read_b64_tr_b16 v[214:215], v253 offset:17408
  s_nop 0
  v_mfma_f32_32x32x16_bf16 v[32:47], v[220:223], v[104:107], v[32:47]
  s_add_u32 s72, s20, 396288
  buffer_load_dwordx4 v[96:99], v250, s[44:47], s72 offen sc1
  buffer_load_dwordx4 v[100:103], v251, s[44:47], s72 offen sc1
  v_mfma_f32_32x32x16_bf16 v[48:63], v[216:219], v[108:111], v[48:63]
  v_mfma_f32_32x32x16_bf16 v[64:79], v[220:223], v[108:111], v[64:79]
  s_waitcnt vmcnt(18) lgkmcnt(0)
  v_mfma_f32_32x32x16_bf16 v[32:47], v[212:215], v[112:115], v[32:47]
  s_nop 0
  ds_read_b64_tr_b16 v[148:149], v252 offset:18432
  ds_read_b64_tr_b16 v[150:151], v252 offset:19456
  ds_read_b64_tr_b16 v[220:221], v253 offset:18432
  ds_read_b64_tr_b16 v[222:223], v253 offset:19456
  v_mfma_f32_32x32x16_bf16 v[48:63], v[144:147], v[116:119], v[48:63]
  s_add_u32 s72, s20, 462336
  buffer_load_dwordx4 v[104:107], v250, s[44:47], s72 offen sc1
  buffer_load_dwordx4 v[108:111], v251, s[44:47], s72 offen sc1
  v_mfma_f32_32x32x16_bf16 v[64:79], v[212:215], v[116:119], v[64:79]
  s_waitcnt vmcnt(18) lgkmcnt(0)
  v_mfma_f32_32x32x16_bf16 v[32:47], v[220:223], v[120:123], v[32:47]
  ds_read_b64_tr_b16 v[152:153], v252 offset:0
  ds_read_b64_tr_b16 v[154:155], v252 offset:1024
  ds_read_b64_tr_b16 v[212:213], v253 offset:0
  ds_read_b64_tr_b16 v[214:215], v253 offset:1024
  v_mfma_f32_32x32x16_bf16 v[48:63], v[148:151], v[124:127], v[48:63]
  s_nop 0
  v_mfma_f32_32x32x16_bf16 v[64:79], v[220:223], v[124:127], v[64:79]
  s_waitcnt vmcnt(14) lgkmcnt(0)
  v_mfma_f32_32x32x16_bf16 v[32:47], v[212:215], v[128:131], v[32:47]
  ds_read_b64_tr_b16 v[156:157], v252 offset:2048
  ds_read_b64_tr_b16 v[158:159], v252 offset:3072
  ds_read_b64_tr_b16 v[220:221], v253 offset:2048
  ds_read_b64_tr_b16 v[222:223], v253 offset:3072
  v_mfma_f32_32x32x16_bf16 v[48:63], v[152:155], v[132:135], v[48:63]
  s_nop 0
  v_mfma_f32_32x32x16_bf16 v[64:79], v[212:215], v[132:135], v[64:79]
  s_waitcnt vmcnt(12) lgkmcnt(0)
  v_mfma_f32_32x32x16_bf16 v[32:47], v[220:223], v[136:139], v[32:47]
  ds_read_b64_tr_b16 v[160:161], v252 offset:4096
  ds_read_b64_tr_b16 v[162:163], v252 offset:5120
  ds_read_b64_tr_b16 v[212:213], v253 offset:4096
  ds_read_b64_tr_b16 v[214:215], v253 offset:5120
  v_mfma_f32_32x32x16_bf16 v[48:63], v[156:159], v[140:143], v[48:63]
  s_nop 0
  v_mfma_f32_32x32x16_bf16 v[64:79], v[220:223], v[140:143], v[64:79]
  s_waitcnt vmcnt(8) lgkmcnt(0)
  v_mfma_f32_32x32x16_bf16 v[32:47], v[212:215], v[80:83], v[32:47]
  ds_read_b64_tr_b16 v[164:165], v252 offset:6144
  ds_read_b64_tr_b16 v[166:167], v252 offset:7168
  ds_read_b64_tr_b16 v[220:221], v253 offset:6144
  ds_read_b64_tr_b16 v[222:223], v253 offset:7168
  v_mfma_f32_32x32x16_bf16 v[48:63], v[160:163], v[84:87], v[48:63]
  s_nop 0
  v_mfma_f32_32x32x16_bf16 v[64:79], v[212:215], v[84:87], v[64:79]
  s_waitcnt vmcnt(4) lgkmcnt(0)
  v_mfma_f32_32x32x16_bf16 v[32:47], v[220:223], v[88:91], v[32:47]
  ds_read_b64_tr_b16 v[168:169], v252 offset:8192
  ds_read_b64_tr_b16 v[170:171], v252 offset:9216
  ds_read_b64_tr_b16 v[212:213], v253 offset:8192
  ds_read_b64_tr_b16 v[214:215], v253 offset:9216
  v_mfma_f32_32x32x16_bf16 v[48:63], v[164:167], v[92:95], v[48:63]
  s_nop 0
  v_mfma_f32_32x32x16_bf16 v[64:79], v[220:223], v[92:95], v[64:79]
  s_waitcnt vmcnt(2) lgkmcnt(0)
  v_mfma_f32_32x32x16_bf16 v[32:47], v[212:215], v[96:99], v[32:47]
  ds_read_b64_tr_b16 v[172:173], v252 offset:10240
  ds_read_b64_tr_b16 v[174:175], v252 offset:11264
  ds_read_b64_tr_b16 v[220:221], v253 offset:10240
  ds_read_b64_tr_b16 v[222:223], v253 offset:11264
  v_mfma_f32_32x32x16_bf16 v[48:63], v[168:171], v[100:103], v[48:63]
  s_nop 0
  v_mfma_f32_32x32x16_bf16 v[64:79], v[212:215], v[100:103], v[64:79]
  s_waitcnt vmcnt(0) lgkmcnt(0)
  v_mfma_f32_32x32x16_bf16 v[32:47], v[220:223], v[104:107], v[32:47]
  v_mfma_f32_32x32x16_bf16 v[48:63], v[172:175], v[108:111], v[48:63]
  v_mfma_f32_32x32x16_bf16 v[64:79], v[220:223], v[108:111], v[64:79]
  s_branch L_B4_join
L_B4_late:
  s_waitcnt lgkmcnt(0)
  v_mfma_f32_32x32x16_bf16 v[16:31], v[216:219], v[136:139], v[16:31]
  ds_read_b64_tr_b16 v[208:209], v252 offset:8192
  s_nop 0
  ds_read_b64_tr_b16 v[210:211], v252 offset:9216
  ds_read_b64_tr_b16 v[212:213], v253 offset:8192
  ds_read_b64_tr_b16 v[214:215], v253 offset:9216
  v_mfma_f32_32x32x16_bf16 v[32:47], v[220:223], v[136:139], v[32:47]
  s_add_u32 m0, s18, 6144
  s_add_u32 s73, s19, 64512
  buffer_load_dwordx4 v248, s[56:59], s73 offen offset:0 lds
  buffer_load_dwordx4 v249, s[56:59], s73 offen offset:1024 lds
  v_mfma_f32_32x32x16_bf16 v[48:63], v[216:219], v[140:143], v[48:63]
  v_mfma_f32_32x32x16_bf16 v[64:79], v[220:223], v[140:143], v[64:79]
  s_waitcnt lgkmcnt(0)
  v_mfma_f32_32x32x16_bf16 v[16:31], v[208:211], v[80:83], v[16:31]
  ds_read_b64_tr_b16 v[216:217], v252 offset:10240
  ds_read_b64_tr_b16 v[218:219], v252 offset:11264
  ds_read_b64_tr_b16 v[220:221], v253 offset:10240
  ds_read_b64_tr_b16 v[222:223], v253 offset:11264
  s_nop 0
  v_mfma_f32_32x32x16_bf16 v[32:47], v[212:215], v[80:83], v[32:47]
  s_add_u32 m0, s18, 8192
  s_add_u32 s73, s19, 75264
  buffer_load_dwordx4 v248, s[56:59], s73 offen offset:0 lds
  buffer_load_dwordx4 v249, s[56:59], s73 offen offset:1024 lds
  v_mfma_f32_32x32x16_bf16 v[48:63], v[208:211], v[84:87], v[48:63]
  v_mfma_f32_32x32x16_bf16 v[64:79], v[212:215], v[84:87], v[64:79]
  s_waitcnt lgkmcnt(0)
  s_nop 0
  v_mfma_f32_32x32x16_bf16 v[16:31], v[216:219], v[88:91], v[16:31]
  ds_read_b64_tr_b16 v[208:209], v252 offset:12288
  ds_read_b64_tr_b16 v[210:211], v252 offset:13312
  ds_read_b64_tr_b16 v[212:213], v253 offset:12288
  ds_read_b64_tr_b16 v[214:215], v253 offset:13312
  v_mfma_f32_32x32x16_bf16 v[32:47], v[220:223], v[88:91], v[32:47]
  s_add_u32 m0, s18, 10240
  s_add_u32 s73, s19, 89600
  buffer_load_dwordx4 v248, s[56:59], s73 offen offset:0 lds
  buffer_load_dwordx4 v249, s[56:59], s73 offen offset:1024 lds
  v_mfma_f32_32x32x16_bf16 v[48:63], v[216:219], v[92:95], v[48:63]
  v_mfma_f32_32x32x16_bf16 v[64:79], v[220:223], v[92:95], v[64:79]
  s_waitcnt lgkmcnt(0)
  v_mfma_f32_32x32x16_bf16 v[16:31], v[208:211], v[96:99], v[16:31]
  ds_read_b64_tr_b16 v[216:217], v252 offset:14336
  ds_read_b64_tr_b16 v[218:219], v252 offset:15360
  s_nop 0
  ds_read_b64_tr_b16 v[220:221], v253 offset:14336
  ds_read_b64_tr_b16 v[222:223], v253 offset:15360
  v_mfma_f32_32x32x16_bf16 v[32:47], v[212:215], v[96:99], v[32:47]
  v_mfma_f32_32x32x16_bf16 v[48:63], v[208:211], v[100:103], v[48:63]
  v_mfma_f32_32x32x16_bf16 v[64:79], v[212:215], v[100:103], v[64:79]
  s_waitcnt vmcnt(12) lgkmcnt(0)
  v_mfma_f32_32x32x16_bf16 v[16:31], v[216:219], v[104:107], v[16:31]
  ds_read_b64_tr_b16 v[144:145], v252 offset:16384
  s_nop 0
  ds_read_b64_tr_b16 v[146:147], v252 offset:17408
  ds_read_b64_tr_b16 v[212:213], v253 offset:16384
  ds_read_b64_tr_b16 v[214:215], v253 offset:17408
  v_mfma_f32_32x32x16_bf16 v[32:47], v[220:223], v[104:107], v[32:47]
  v_mfma_f32_32x32x16_bf16 v[48:63], v[216:219], v[108:111], v[48:63]
  v_mfma_f32_32x32x16_bf16 v[64:79], v[220:223], v[108:111], v[64:79]
  s_mov_b32 s74, 400000
L_sp_35:
  s_buffer_load_dwordx16 s[28:43], s[44:47], s22 offset:303104 glc
  s_waitcnt lgkmcnt(0)
  s_xor_b64 s[28:29], s[28:29], s[0:1]
  s_xor_b64 s[30:31], s[30:31], s[0:1]
  s_xor_b64 s[32:33], s[32:33], s[0:1]
  s_xor_b64 s[34:35], s[34:35], s[0:1]
  s_xor_b64 s[36:37], s[36:37], s[0:1]
  s_xor_b64 s[38:39], s[38:39], s[0:1]
  s_xor_b64 s[40:41], s[40:41], s[0:1]
  s_xor_b64 s[42:43], s[42:43], s[0:1]
  s_or_b64 s[28:29], s[28:29], s[42:43]
  s_or_b64 s[28:29], s[28:29], s[40:41]
  s_or_b64 s[28:29], s[28:29], s[38:39]
  s_or_b64 s[28:29], s[28:29], s[36:37]
  s_or_b64 s[28:29], s[28:29], s[34:35]
  s_or_b64 s[28:29], s[28:29], s[32:33]
  s_or_b64 s[28:29], s[28:29], s[30:31]
  s_cbranch_scc0 L_spd_36
  s_sub_u32 s74, s74, 1
  s_cbranch_scc1 L_spd_36
  s_sleep 1
  s_branch L_sp_35
L_spd_36:
  buffer_load_dwordx4 v[112:115], v250, s[44:47], s20 offen sc1
  buffer_load_dwordx4 v[116:119], v251, s[44:47], s20 offen sc1
  s_add_u32 s72, s20, 66048
  buffer_load_dwordx4 v[120:123], v250, s[44:47], s72 offen sc1
  buffer_load_dwordx4 v[124:127], v251, s[44:47], s72 offen sc1
  s_nop 0
  s_add_u32 s72, s20, 132096
  buffer_load_dwordx4 v[128:131], v250, s[44:47], s72 offen sc1
  buffer_load_dwordx4 v[132:135], v251, s[44:47], s72 offen sc1
  s_add_u32 s72, s20, 198144
  buffer_load_dwordx4 v[136:139], v250, s[44:47], s72 offen sc1
  buffer_load_dwordx4 v[140:143], v251, s[44:47], s72 offen sc1
  s_add_u32 s72, s20, 264192
  buffer_load_dwordx4 v[80:83], v250, s[44:47], s72 offen sc1
  buffer_load_dwordx4 v[84:87], v251, s[44:47], s72 offen sc1
  s_add_u32 s72, s20, 330240
  buffer_load_dwordx4 v[88:91], v250, s[44:47], s72 offen sc1
  buffer_load_dwordx4 v[92:95], v251, s[44:47], s72 offen sc1
  s_add_u32 s72, s20, 396288
  buffer_load_dwordx4 v[96:99], v250, s[44:47], s72 offen sc1
  buffer_load_dwordx4 v[100:103], v251, s[44:47], s72 offen sc1
  s_add_u32 s72, s20, 462336
  buffer_load_dwordx4 v[104:107], v250, s[44:47], s72 offen sc1
  buffer_load_dwordx4 v[108:111], v251, s[44:47], s72 offen sc1
  s_waitcnt vmcnt(14)
  v_mfma_f32_32x32x16_bf16 v[32:47], v[212:215], v[112:115], v[32:47]
  ds_read_b64_tr_b16 v[148:149], v252 offset:18432
  ds_read_b64_tr_b16 v[150:151], v252 offset:19456
  ds_read_b64_tr_b16 v[220:221], v253 offset:18432
  ds_read_b64_tr_b16 v[222:223], v253 offset:19456
  s_nop 0
  v_mfma_f32_32x32x16_bf16 v[48:63], v[144:147], v[116:119], v[48:63]
  v_mfma_f32_32x32x16_bf16 v[64:79], v[212:215], v[116:119], v[64:79]
  s_waitcnt vmcnt(12) lgkmcnt(0)
  v_mfma_f32_32x32x16_bf16 v[32:47], v[220:223], v[120:123], v[32:47]
  ds_read_b64_tr_b16 v[152:153], v252 offset:0
  ds_read_b64_tr_b16 v[154:155], v252 offset:1024
  ds_read_b64_tr_b16 v[212:213], v253 offset:0
  ds_read_b64_tr_b16 v[214:215], v253 offset:1024
  s_nop 0
  v_mfma_f32_32x32x16_bf16 v[48:63], v[148:151], v[124:127], v[48:63]
  v_mfma_f32_32x32x16_bf16 v[64:79], v[220:223], v[124:127], v[64:79]
  s_waitcnt vmcnt(10) lgkmcnt(0)
  v_mfma_f32_32x32x16_bf16 v[32:47], v[212:215], v[128:131], v[32:47]
  ds_read_b64_tr_b16 v[156:157], v252 offset:2048
  ds_read_b64_tr_b16 v[158:159], v252 offset:3072
  ds_read_b64_tr_b16 v[220:221], v253 offset:2048
  ds_read_b64_tr_b16 v[222:223], v253 offset:3072
  s_nop 0
  v_mfma_f32_32x32x16_bf16 v[48:63], v[152:155], v[132:135], v[48:63]
  v_mfma_f32_32x32x16_bf16 v[64:79], v[212:215], v[132:135], v[64:79]
  s_waitcnt vmcnt(8) lgkmcnt(0)
  v_mfma_f32_32x32x16_bf16 v[32:47], v[220:223], v[136:139], v[32:47]
  ds_read_b64_tr_b16 v[160:161], v252 offset:4096
  ds_read_b64_tr_b16 v[162:163], v252 offset:5120
  ds_read_b64_tr_b16 v[212:213], v253 offset:4096
  ds_read_b64_tr_b16 v[214:215], v253 offset:5120
  s_nop 0
  v_mfma_f32_32x32x16_bf16 v[48:63], v[156:159], v[140:143], v[48:63]
  v_mfma_f32_32x32x16_bf16 v[64:79], v[220:223], v[140:143], v[64:79]
  s_waitcnt vmcnt(6) lgkmcnt(0)
  v_mfma_f32_32x32x16_bf16 v[32:47], v[212:215], v[80:83], v[32:47]
  ds_read_b64_tr_b16 v[164:165], v252 offset:6144
  ds_read_b64_tr_b16 v[166:167], v252 offset:7168
  ds_read_b64_tr_b16 v[220:221], v253 offset:6144
  ds_read_b64_tr_b16 v[222:223], v253 offset:7168
  s_nop 0
  v_mfma_f32_32x32x16_bf16 v[48:63], v[160:163], v[84:87], v[48:63]
  v_mfma_f32_32x32x16_bf16 v[64:79], v[212:215], v[84:87], v[64:79]
  s_waitcnt vmcnt(4) lgkmcnt(0)
  v_mfma_f32_32x32x16_bf16 v[32:47], v[220:223], v[88:91], v[32:47]
  ds_read_b64_tr_b16 v[168:169], v252 offset:8192
  ds_read_b64_tr_b16 v[170:171], v252 offset:9216
  ds_read_b64_tr_b16 v[212:213], v253 offset:8192
  ds_read_b64_tr_b16 v[214:215], v253 offset:9216
  s_nop 0
  v_mfma_f32_32x32x16_bf16 v[48:63], v[164:167], v[92:95], v[48:63]
  v_mfma_f32_32x32x16_bf16 v[64:79], v[220:223], v[92:95], v[64:79]
  s_waitcnt vmcnt(2) lgkmcnt(0)
  v_mfma_f32_32x32x16_bf16 v[32:47], v[212:215], v[96:99], v[32:47]
  ds_read_b64_tr_b16 v[172:173], v252 offset:10240
  ds_read_b64_tr_b16 v[174:175], v252 offset:11264
  ds_read_b64_tr_b16 v[220:221], v253 offset:10240
  ds_read_b64_tr_b16 v[222:223], v253 offset:11264
  s_nop 0
  v_mfma_f32_32x32x16_bf16 v[48:63], v[168:171], v[100:103], v[48:63]
  v_mfma_f32_32x32x16_bf16 v[64:79], v[212:215], v[100:103], v[64:79]
  s_waitcnt vmcnt(0) lgkmcnt(0)
  v_mfma_f32_32x32x16_bf16 v[32:47], v[220:223], v[104:107], v[32:47]
  v_mfma_f32_32x32x16_bf16 v[48:63], v[172:175], v[108:111], v[48:63]
  v_mfma_f32_32x32x16_bf16 v[64:79], v[220:223], v[108:111], v[64:79]
L_B4_join:
  v_add_u32 v224, s18, v11
  v_mul_u32_u24 v226, 896, v2
  v_lshl_add_u32 v226, v3, 4, v226
  v_mfma_f32_32x32x16_bf16 v[16:31], v[144:147], v[112:115], v[16:31]
  v_mfma_f32_32x32x16_bf16 v[16:31], v[148:151], v[120:123], v[16:31]
  v_mfma_f32_32x32x16_bf16 v[16:31], v[152:155], v[128:131], v[16:31]
  s_nop 3
  ds_write_b128 v224, v[32:35] offset:0
  ds_write_b128 v224, v[36:39] offset:1024
  v_mfma_f32_32x32x16_bf16 v[16:31], v[156:159], v[136:139], v[16:31]
  ds_write_b128 v224, v[40:43] offset:2048
  s_nop 0
  ds_write_b128 v224, v[44:47] offset:3072
  v_mfma_f32_32x32x16_bf16 v[16:31], v[160:163], v[80:83], v[16:31]
  ds_write_b128 v224, v[48:51] offset:4096
  ds_write_b128 v224, v[52:55] offset:5120
  v_mfma_f32_32x32x16_bf16 v[16:31], v[164:167], v[88:91], v[16:31]
  ds_write_b128 v224, v[56:59] offset:6144
  ds_write_b128 v224, v[60:63] offset:7168
  v_mfma_f32_32x32x16_bf16 v[16:31], v[168:171], v[96:99], v[16:31]
  ds_write_b128 v224, v[64:67] offset:8192
  ds_write_b128 v224, v[68:71] offset:9216
  v_mfma_f32_32x32x16_bf16 v[16:31], v[172:175], v[104:107], v[16:31]
  ds_write_b128 v224, v[72:75] offset:10240
  ds_write_b128 v224, v[76:79] offset:11264
  s_waitcnt lgkmcnt(0)
  s_barrier
  s_xor_b32 s68, s64, 1
  s_mul_i32 s68, s68, 20480
  v_add_u32 v225, s68, v11
  ds_read_b128 v[32:35], v225 offset:0
  ds_read_b128 v[36:39], v225 offset:1024
  ds_read_b128 v[40:43], v225 offset:2048
  ds_read_b128 v[44:47], v225 offset:3072
  s_xor_b32 s68, s64, 2
  s_mul_i32 s68, s68, 20480
  v_add_u32 v225, s68, v11
  ds_read_b128 v[48:51], v225 offset:4096
  ds_read_b128 v[52:55], v225 offset:5120
  ds_read_b128 v[56:59], v225 offset:6144
  ds_read_b128 v[60:63], v225 offset:7168
  s_xor_b32 s68, s64, 3
  s_mul_i32 s68, s68, 20480
  v_add_u32 v225, s68, v11
  ds_read_b128 v[64:67], v225 offset:8192
  ds_read_b128 v[68:71], v225 offset:9216
  ds_read_b128 v[72:75], v225 offset:10240
  ds_read_b128 v[76:79], v225 offset:11264
  s_waitcnt lgkmcnt(8)
  v_pk_add_f32 v[16:17], v[16:17], v[32:33]
  v_pk_add_f32 v[18:19], v[18:19], v[34:35]
  v_pk_add_f32 v[20:21], v[20:21], v[36:37]
  v_pk_add_f32 v[22:23], v[22:23], v[38:39]
  v_pk_add_f32 v[24:25], v[24:25], v[40:41]
  v_pk_add_f32 v[26:27], v[26:27], v[42:43]
  v_pk_add_f32 v[28:29], v[28:29], v[44:45]
  s_nop 0
  v_pk_add_f32 v[30:31], v[30:31], v[46:47]
  s_waitcnt lgkmcnt(4)
  v_pk_add_f32 v[16:17], v[16:17], v[48:49]
  v_pk_add_f32 v[18:19], v[18:19], v[50:51]
  v_pk_add_f32 v[20:21], v[20:21], v[52:53]
  v_pk_add_f32 v[22:23], v[22:23], v[54:55]
  v_pk_add_f32 v[24:25], v[24:25], v[56:57]
  v_pk_add_f32 v[26:27], v[26:27], v[58:59]
  s_nop 0
  v_pk_add_f32 v[28:29], v[28:29], v[60:61]
  v_pk_add_f32 v[30:31], v[30:31], v[62:63]
  s_waitcnt lgkmcnt(0)
  v_pk_add_f32 v[16:17], v[16:17], v[64:65]
  v_pk_add_f32 v[18:19], v[18:19], v[66:67]
  v_pk_add_f32 v[20:21], v[20:21], v[68:69]
  v_pk_add_f32 v[22:23], v[22:23], v[70:71]
  v_pk_add_f32 v[24:25], v[24:25], v[72:73]
  s_nop 0
  v_pk_add_f32 v[26:27], v[26:27], v[74:75]
  v_pk_add_f32 v[28:29], v[28:29], v[76:77]
  v_pk_add_f32 v[30:31], v[30:31], v[78:79]
  v_cvt_pk_bf16_f32 v80, v16, v17
  v_cvt_pk_bf16_f32 v81, v18, v19
  v_cvt_pk_bf16_f32 v82, v20, v21
  v_cvt_pk_bf16_f32 v83, v22, v23
  v_cvt_pk_bf16_f32 v84, v24, v25
  v_cvt_pk_bf16_f32 v85, v26, v27
  v_cvt_pk_bf16_f32 v86, v28, v29
  v_cvt_pk_bf16_f32 v87, v30, v31
  v_permlane32_swap_b32 v80, v82
  v_permlane32_swap_b32 v81, v83
  buffer_store_dwordx4 v[80:83], v226, s[60:63], s24 offen offset:0
  v_permlane32_swap_b32 v84, v86
  v_permlane32_swap_b32 v85, v87
  buffer_store_dwordx4 v[84:87], v226, s[60:63], s24 offen offset:32
L_end:
  s_endpgm
L_helper:
  s_setprio 1
  s_and_b32 s68, s2, 255
  s_lshl_b32 s68, s68, 6
  s_mov_b32 s74, 400000
L_sp_37:
  s_buffer_load_dwordx2 s[70:71], s[44:47], s68 offset:393216 glc
  s_waitcnt lgkmcnt(0)
  s_xor_b64 s[70:71], s[70:71], s[0:1]
  s_cbranch_scc0 L_spd_38
  s_sub_u32 s74, s74, 1
  s_cbranch_scc1 L_spd_38
  s_sleep 1
  s_branch L_sp_37
L_spd_38:
  s_and_b32 s72, s2, 255
  s_sub_u32 s72, s72, 224
  s_cmp_ge_u32 s72, 28
  s_cbranch_scc1 L_nocs
  s_mul_i32 s68, s64, 401408
  s_lshl_b32 s69, s72, 7
  s_add_u32 s68, s68, s69
  v_lshrrev_b32 v224, 3, v1
  v_mul_u32_u24 v224, 3584, v224
  v_and_b32 v225, 7, v1
  v_lshl_add_u32 v224, v225, 4, v224
  buffer_load_dwordx4 v[16:19], v224, s[48:51], s68 offen
  s_add_u32 s68, s68, 28672
  buffer_load_dwordx4 v[20:23], v224, s[48:51], s68 offen
  s_add_u32 s68, s68, 28672
  buffer_load_dwordx4 v[24:27], v224, s[48:51], s68 offen
  s_add_u32 s68, s68, 28672
  buffer_load_dwordx4 v[28:31], v224, s[48:51], s68 offen
  s_add_u32 s68, s68, 28672
  buffer_load_dwordx4 v[32:35], v224, s[48:51], s68 offen
  s_add_u32 s68, s68, 28672
  buffer_load_dwordx4 v[36:39], v224, s[48:51], s68 offen
  s_add_u32 s68, s68, 28672
  buffer_load_dwordx4 v[40:43], v224, s[48:51], s68 offen
  s_add_u32 s68, s68, 28672
  s_waitcnt vmcnt(6)
  buffer_load_dwordx4 v[44:47], v224, s[48:51], s68 offen
  s_add_u32 s68, s68, 28672
  s_waitcnt vmcnt(6)
  buffer_load_dwordx4 v[48:51], v224, s[48:51], s68 offen
  s_add_u32 s68, s68, 28672
  s_waitcnt vmcnt(6)
  buffer_load_dwordx4 v[52:55], v224, s[48:51], s68 offen
  s_add_u32 s68, s68, 28672
  s_waitcnt vmcnt(6)
  buffer_load_dwordx4 v[56:59], v224, s[48:51], s68 offen
  s_add_u32 s68, s68, 28672
  s_waitcnt vmcnt(6)
  s_nop 0
  buffer_load_dwordx4 v[60:63], v224, s[48:51], s68 offen
  s_add_u32 s68, s68, 28672
  s_waitcnt vmcnt(6)
  buffer_load_dwordx4 v[64:67], v224, s[48:51], s68 offen
  s_add_u32 s68, s68, 28672
  s_waitcnt vmcnt(6)
  buffer_load_dwordx4 v[68:71], v224, s[48:51], s68 offen
  s_waitcnt vmcnt(6)
  v_mov_b32 v80, 0
  v_mov_b32 v81, 0
  v_mov_b32 v82, 0
  v_mov_b32 v83, 0
  v_mov_b32 v84, 0
  v_mov_b32 v85, 0
  v_mov_b32 v86, 0
  v_mov_b32 v87, 0
  v_lshlrev_b32 v226, 16, v16
  v_and_b32 v227, 0xffff0000, v16
  v_pk_add_f32 v[80:81], v[80:81], v[226:227]
  v_lshlrev_b32 v226, 16, v17
  v_and_b32 v227, 0xffff0000, v17
  v_pk_add_f32 v[82:83], v[82:83], v[226:227]
  v_lshlrev_b32 v226, 16, v18
  v_and_b32 v227, 0xffff0000, v18
  v_pk_add_f32 v[84:85], v[84:85], v[226:227]
  v_lshlrev_b32 v226, 16, v19
  v_and_b32 v227, 0xffff0000, v19
  v_pk_add_f32 v[86:87], v[86:87], v[226:227]
  v_lshlrev_b32 v226, 16, v20
  v_and_b32 v227, 0xffff0000, v20
  v_pk_add_f32 v[80:81], v[80:81], v[226:227]
  v_lshlrev_b32_e64 v226, 16, v21
  v_and_b32 v227, 0xffff0000, v21
  v_pk_add_f32 v[82:83], v[82:83], v[226:227]
  v_lshlrev_b32 v226, 16, v22
  v_and_b32 v227, 0xffff0000, v22
  v_pk_add_f32 v[84:85], v[84:85], v[226:227]
  v_lshlrev_b32 v226, 16, v23
  v_and_b32 v227, 0xffff0000, v23
  v_pk_add_f32 v[86:87], v[86:87], v[226:227]
  v_lshlrev_b32_e64 v226, 16, v24
  v_and_b32 v227, 0xffff0000, v24
  v_pk_add_f32 v[80:81], v[80:81], v[226:227]
  v_lshlrev_b32 v226, 16, v25
  v_and_b32 v227, 0xffff0000, v25
  v_pk_add_f32 v[82:83], v[82:83], v[226:227]
  v_lshlrev_b32 v226, 16, v26
  v_and_b32 v227, 0xffff0000, v26
  v_pk_add_f32 v[84:85], v[84:85], v[226:227]
  v_lshlrev_b32_e64 v226, 16, v27
  v_and_b32 v227, 0xffff0000, v27
  v_pk_add_f32 v[86:87], v[86:87], v[226:227]
  v_lshlrev_b32 v226, 16, v28
  v_and_b32 v227, 0xffff0000, v28
  v_pk_add_f32 v[80:81], v[80:81], v[226:227]
  v_lshlrev_b32 v226, 16, v29
  v_and_b32 v227, 0xffff0000, v29
  v_pk_add_f32 v[82:83], v[82:83], v[226:227]
  v_lshlrev_b32_e64 v226, 16, v30
  v_and_b32 v227, 0xffff0000, v30
  v_pk_add_f32 v[84:85], v[84:85], v[226:227]
  v_lshlrev_b32 v226, 16, v31
  v_and_b32 v227, 0xffff0000, v31
  v_pk_add_f32 v[86:87], v[86:87], v[226:227]
  v_lshlrev_b32 v226, 16, v32
  v_and_b32 v227, 0xffff0000, v32
  v_pk_add_f32 v[80:81], v[80:81], v[226:227]
  v_lshlrev_b32_e64 v226, 16, v33
  v_and_b32 v227, 0xffff0000, v33
  v_pk_add_f32 v[82:83], v[82:83], v[226:227]
  v_lshlrev_b32 v226, 16, v34
  v_and_b32 v227, 0xffff0000, v34
  v_pk_add_f32 v[84:85], v[84:85], v[226:227]
  v_lshlrev_b32 v226, 16, v35
  v_and_b32 v227, 0xffff0000, v35
  v_pk_add_f32 v[86:87], v[86:87], v[226:227]
  v_lshlrev_b32_e64 v226, 16, v36
  v_and_b32 v227, 0xffff0000, v36
  v_pk_add_f32 v[80:81], v[80:81], v[226:227]
  v_lshlrev_b32 v226, 16, v37
  v_and_b32 v227, 0xffff0000, v37
  v_pk_add_f32 v[82:83], v[82:83], v[226:227]
  v_lshlrev_b32 v226, 16, v38
  v_and_b32 v227, 0xffff0000, v38
  v_pk_add_f32 v[84:85], v[84:85], v[226:227]
  v_lshlrev_b32_e64 v226, 16, v39
  v_and_b32 v227, 0xffff0000, v39
  v_pk_add_f32 v[86:87], v[86:87], v[226:227]
  v_lshlrev_b32 v226, 16, v40
  v_and_b32 v227, 0xffff0000, v40
  v_pk_add_f32 v[80:81], v[80:81], v[226:227]
  v_lshlrev_b32 v226, 16, v41
  v_and_b32 v227, 0xffff0000, v41
  v_pk_add_f32 v[82:83], v[82:83], v[226:227]
  v_lshlrev_b32_e64 v226, 16, v42
  v_and_b32 v227, 0xffff0000, v42
  v_pk_add_f32 v[84:85], v[84:85], v[226:227]
  v_lshlrev_b32 v226, 16, v43
  v_and_b32 v227, 0xffff0000, v43
  v_pk_add_f32 v[86:87], v[86:87], v[226:227]
  v_lshlrev_b32 v226, 16, v44
  v_and_b32 v227, 0xffff0000, v44
  v_pk_add_f32 v[80:81], v[80:81], v[226:227]
  v_lshlrev_b32_e64 v226, 16, v45
  v_and_b32 v227, 0xffff0000, v45
  v_pk_add_f32 v[82:83], v[82:83], v[226:227]
  v_lshlrev_b32 v226, 16, v46
  v_and_b32 v227, 0xffff0000, v46
  v_pk_add_f32 v[84:85], v[84:85], v[226:227]
  v_lshlrev_b32 v226, 16, v47
  v_and_b32 v227, 0xffff0000, v47
  v_pk_add_f32 v[86:87], v[86:87], v[226:227]
  s_waitcnt vmcnt(5)
  v_lshlrev_b32 v226, 16, v48
  v_and_b32 v227, 0xffff0000, v48
  v_pk_add_f32 v[80:81], v[80:81], v[226:227]
  v_lshlrev_b32 v226, 16, v49
  v_and_b32 v227, 0xffff0000, v49
  v_pk_add_f32 v[82:83], v[82:83], v[226:227]
  v_lshlrev_b32 v226, 16, v50
  v_and_b32 v227, 0xffff0000, v50
  v_pk_add_f32 v[84:85], v[84:85], v[226:227]
  v_lshlrev_b32_e64 v226, 16, v51
  v_and_b32 v227, 0xffff0000, v51
  v_pk_add_f32 v[86:87], v[86:87], v[226:227]
  s_waitcnt vmcnt(4)
  v_lshlrev_b32 v226, 16, v52
  v_and_b32 v227, 0xffff0000, v52
  v_pk_add_f32 v[80:81], v[80:81], v[226:227]
  v_lshlrev_b32 v226, 16, v53
  v_and_b32 v227, 0xffff0000, v53
  v_pk_add_f32 v[82:83], v[82:83], v[226:227]
  v_lshlrev_b32 v226, 16, v54
  v_and_b32 v227, 0xffff0000, v54
  v_pk_add_f32 v[84:85], v[84:85], v[226:227]
  v_lshlrev_b32 v226, 16, v55
  v_and_b32 v227, 0xffff0000, v55
  v_pk_add_f32 v[86:87], v[86:87], v[226:227]
  s_waitcnt vmcnt(3)
  v_lshlrev_b32 v226, 16, v56
  v_and_b32 v227, 0xffff0000, v56
  v_pk_add_f32 v[80:81], v[80:81], v[226:227]
  v_lshlrev_b32 v226, 16, v57
  v_and_b32 v227, 0xffff0000, v57
  v_pk_add_f32 v[82:83], v[82:83], v[226:227]
  v_lshlrev_b32 v226, 16, v58
  v_and_b32 v227, 0xffff0000, v58
  v_pk_add_f32 v[84:85], v[84:85], v[226:227]
  v_lshlrev_b32 v226, 16, v59
  v_and_b32 v227, 0xffff0000, v59
  v_pk_add_f32 v[86:87], v[86:87], v[226:227]
  s_waitcnt vmcnt(2)
  v_lshlrev_b32 v226, 16, v60
  v_and_b32 v227, 0xffff0000, v60
  v_pk_add_f32 v[80:81], v[80:81], v[226:227]
  v_lshlrev_b32 v226, 16, v61
  v_and_b32 v227, 0xffff0000, v61
  v_pk_add_f32 v[82:83], v[82:83], v[226:227]
  v_lshlrev_b32 v226, 16, v62
  v_and_b32 v227, 0xffff0000, v62
  v_pk_add_f32 v[84:85], v[84:85], v[226:227]
  v_lshlrev_b32_e64 v226, 16, v63
  v_and_b32 v227, 0xffff0000, v63
  v_pk_add_f32 v[86:87], v[86:87], v[226:227]
  s_waitcnt vmcnt(1)
  v_lshlrev_b32 v226, 16, v64
  v_and_b32 v227, 0xffff0000, v64
  v_pk_add_f32 v[80:81], v[80:81], v[226:227]
  v_lshlrev_b32 v226, 16, v65
  v_and_b32 v227, 0xffff0000, v65
  v_pk_add_f32 v[82:83], v[82:83], v[226:227]
  v_lshlrev_b32 v226, 16, v66
  v_and_b32 v227, 0xffff0000, v66
  v_pk_add_f32 v[84:85], v[84:85], v[226:227]
  v_lshlrev_b32 v226, 16, v67
  v_and_b32 v227, 0xffff0000, v67
  v_pk_add_f32 v[86:87], v[86:87], v[226:227]
  s_waitcnt vmcnt(0)
  v_lshlrev_b32 v226, 16, v68
  v_and_b32 v227, 0xffff0000, v68
  v_pk_add_f32 v[80:81], v[80:81], v[226:227]
  v_lshlrev_b32 v226, 16, v69
  v_and_b32 v227, 0xffff0000, v69
  v_pk_add_f32 v[82:83], v[82:83], v[226:227]
  v_lshlrev_b32 v226, 16, v70
  v_and_b32 v227, 0xffff0000, v70
  v_pk_add_f32 v[84:85], v[84:85], v[226:227]
  v_lshlrev_b32 v226, 16, v71
  v_and_b32 v227, 0xffff0000, v71
  v_pk_add_f32 v[86:87], v[86:87], v[226:227]
  v_add_f32_dpp v80, v80, v80 row_ror:8 row_mask:0xf bank_mask:0xf
  v_add_f32_dpp v81, v81, v81 row_ror:8 row_mask:0xf bank_mask:0xf
  v_add_f32_dpp v82, v82, v82 row_ror:8 row_mask:0xf bank_mask:0xf
  v_add_f32_dpp v83, v83, v83 row_ror:8 row_mask:0xf bank_mask:0xf
  v_add_f32_dpp v84, v84, v84 row_ror:8 row_mask:0xf bank_mask:0xf
  v_add_f32_dpp v85, v85, v85 row_ror:8 row_mask:0xf bank_mask:0xf
  v_add_f32_dpp v86, v86, v86 row_ror:8 row_mask:0xf bank_mask:0xf
  v_add_f32_dpp v87, v87, v87 row_ror:8 row_mask:0xf bank_mask:0xf
  v_mov_b32 v88, v80
  v_mov_b32 v89, v81
  v_mov_b32 v90, v82
  v_mov_b32 v91, v83
  v_mov_b32 v92, v84
  v_mov_b32 v93, v85
  v_mov_b32 v94, v86
  v_mov_b32 v95, v87
  v_permlane16_swap_b32 v80, v88
  v_permlane16_swap_b32 v81, v89
  v_permlane16_swap_b32 v82, v90
  v_permlane16_swap_b32 v83, v91
  v_permlane16_swap_b32 v84, v92
  v_permlane16_swap_b32 v85, v93
  v_permlane16_swap_b32 v86, v94
  v_permlane16_swap_b32 v87, v95
  v_add_f32 v80, v80, v88
  v_add_f32 v81, v81, v89
  v_add_f32 v82, v82, v90
  v_add_f32 v83, v83, v91
  v_add_f32 v84, v84, v92
  v_add_f32 v85, v85, v93
  v_add_f32 v86, v86, v94
  v_add_f32 v87, v87, v95
  v_mov_b32 v88, v80
  v_mov_b32 v89, v81
  v_mov_b32 v90, v82
  v_mov_b32 v91, v83
  v_mov_b32 v92, v84
  v_mov_b32 v93, v85
  v_mov_b32 v94, v86
  v_mov_b32 v95, v87
  v_permlane32_swap_b32 v80, v88
  v_permlane32_swap_b32 v81, v89
  v_permlane32_swap_b32 v82, v90
  v_permlane32_swap_b32 v83, v91
  v_permlane32_swap_b32 v84, v92
  v_permlane32_swap_b32 v85, v93
  v_permlane32_swap_b32 v86, v94
  v_permlane32_swap_b32 v87, v95
  v_add_f32 v80, v80, v88
  v_add_f32 v81, v81, v89
  v_add_f32 v82, v82, v90
  v_add_f32 v83, v83, v91
  v_add_f32 v84, v84, v92
  v_add_f32 v85, v85, v93
  v_add_f32 v86, v86, v94
  v_add_f32 v87, v87, v95
  s_lshl_b32 s68, s64, 8
  v_lshlrev_b32 v225, 5, v225
  v_add_u32 v226, s68, v225
  ds_write_b128 v226, v[80:83]
  ds_write_b128 v226, v[84:87] offset:16
  s_waitcnt lgkmcnt(0)
  s_barrier
  v_lshlrev_b32 v226, 2, v1
  ds_read_b32 v80, v226 offset:0
  ds_read_b32 v81, v226 offset:256
  ds_read_b32 v82, v226 offset:512
  ds_read_b32 v83, v226 offset:768
  s_waitcnt lgkmcnt(0)
  v_add_f32 v80, v80, v81
  v_add_f32 v82, v82, v83
  v_add_f32 v80, v80, v82
  s_lshl_b32 s68, s72, 8
  s_add_u32 s68, s68, 20029440
  s_lshl_b32 s69, s72, 3
  s_add_u32 s69, s69, 376832
  s_cmp_lg_u32 s64, 0
  s_cbranch_scc1 L_nocs
  buffer_store_dword v80, v226, s[44:47], s68 offen sc1
  s_waitcnt vmcnt(0)
  s_cmp_lg_u32 s64, 0
  s_cbranch_scc1 L_pub_39
  s_mov_b64 exec, 1
  buffer_store_dwordx2 v[6:7], v4, s[44:47], s69 offen sc1
  s_mov_b64 exec, -1
L_pub_39:
L_nocs:
  s_and_b32 s68, s2, 255
  s_cmp_lg_u32 s68, 255
  s_cbranch_scc1 L_end
  s_lshl_b32 s68, s64, 12
  s_add_u32 s68, s68, 393216
  v_lshl_add_u32 v10, v1, 6, s68
  s_nop 0
  s_mov_b32 s74, 400000
L_po_40:
  buffer_load_dwordx2 v[8:9], v10, s[44:47], 0 offen sc1
  s_waitcnt vmcnt(0)
  v_cmp_ne_u64 vcc, v[8:9], v[6:7]
  s_nop 4
  s_cbranch_vccz L_pod_41
  s_sub_u32 s74, s74, 1
  s_cbranch_scc1 L_pod_41
  s_sleep 32
  s_branch L_po_40
L_pod_41:
  s_barrier
  s_cmp_lg_u32 s64, 0
  s_cbranch_scc1 L_end
  v_mov_b32 v8, 0
  v_mov_b32 v9, 0
  s_mov_b64 exec, 1
  buffer_store_dwordx2 v[8:9], v4, s[32:35], 0 offen sc1
  s_endpgm
L_code_end:
.section .rodata,"a"
.p2align 6
.amdhsa_kernel parallel_sum__mha_block__mixer_s_mlp__prompt_kernel
  .amdhsa_next_free_vgpr 256
  .amdhsa_next_free_sgpr 102
  .amdhsa_accum_offset 256
  .amdhsa_group_segment_fixed_size 0
  .amdhsa_kernarg_size 88
  .amdhsa_user_sgpr_count 2
  .amdhsa_user_sgpr_kernarg_segment_ptr 1
  .amdhsa_system_sgpr_workgroup_id_x 1
.end_amdhsa_kernel
```
